```python
import torch

def _softmax(x, axis=-1):
    return torch.softmax(x, dim=axis)
def _gelu(x):
    return torch.nn.functional.gelu(x, approximate="tanh")
def _silu(x):
    return torch.nn.functional.silu(x)
def _sigmoid(x):
    return torch.sigmoid(x)
def _layernorm(x, axis=-1, eps=1e-5):
    m = x.mean(dim=axis, keepdim=True)
    v = x.var(dim=axis, keepdim=True, unbiased=False)
    return (x - m) / torch.sqrt(v + eps)
def _scatter_add(tgt, idx, src, axis=0):
    return tgt.clone().index_add_(axis, idx, src)
def _segment_sum(src, seg, n):
    out = torch.zeros((n,) + src.shape[1:], dtype=src.dtype)
    return out.index_add_(0, seg, src)
def _pad(x, pw):
    flat = tuple(v for pair in reversed(pw) for v in pair)
    return torch.nn.functional.pad(x, flat)

kernel_name = 'interleave_layers__linear_attn_block__dense_activation_squared_relu__prompt'

def setup_inputs():

    _w = (lambda a: (lambda t: t.to(torch.bfloat16) if t.is_floating_point() else t)(torch.as_tensor(a)))
    def _A_setup():
        B, S, D = 1, 2048, 640
        return {
            "x": _w((lambda *s: torch.randn(*s, dtype=torch.bfloat16) * 0.05)(B, S, D)),
            "wqkv": _w((lambda *s: torch.randn(*s, dtype=torch.bfloat16) * 0.1)(D, 3 * D)),
            "wo": _w((lambda *s: torch.randn(*s, dtype=torch.bfloat16) * 0.05)(D, D)),
        }
    _A_in = _A_setup()

    def _B_setup():
        B, S, D, F = 1, 2048, 640, 1728
        return {
            "x": _w((lambda *s: torch.randn(*s, dtype=torch.bfloat16) * 0.05)(B, S, D)),
            "w1": _w((lambda *s: torch.randn(*s, dtype=torch.bfloat16) * 0.05)(D, F)),
            "b1": _w((lambda *s: torch.randn(*s, dtype=torch.bfloat16) * 0.2)(F)),
            "w2": _w((lambda *s: torch.randn(*s, dtype=torch.bfloat16) * 0.05)(F, D)),
            "b2": _w((lambda *s: torch.randn(*s, dtype=torch.bfloat16) * 0.8)(D)),
        }
    _B_in = _B_setup()

    return {
        "A_x": _A_in["x"],
        "A_wqkv": _A_in["wqkv"],
        "A_wo": _A_in["wo"],
        "B_x": _B_in["x"],
        "B_w1": _B_in["w1"],
        "B_b1": _B_in["b1"],
        "B_w2": _B_in["w2"],
        "B_b2": _B_in["b2"],
    }

def reference(A_x, A_wqkv, A_wo, B_x, B_w1, B_b1, B_w2, B_b2):
    def _A_ref(x, wqkv, wo):
        B, S, D = x.shape
        H = 32; Dh = D // H
        qkv = (lambda x, *d: x.permute(*d))((x @ wqkv).reshape(B, S, 3, H, Dh), 2, 0, 3, 1, 4)
        q, k, v = qkv[0], qkv[1], qkv[2]
        phi = lambda t: torch.where(t > 0, t + 1, torch.exp(t)) + 1e-6
        pq, pk = phi(q), phi(k)
        kv = torch.einsum("bhsd,bhse->bhde", pk, v)
        z = torch.einsum("bhsd->bhd", pk)
        num = torch.einsum("bhqd,bhde->bhqe", pq, kv)
        den = torch.einsum("bhqd,bhd->bhq", pq, z)[..., None] + 1e-6
        o = num / den
        return (lambda x, *d: x.permute(*d))(o, 0, 2, 1, 3).reshape(B, S, D) @ wo

    def _B_ref(x, w1, b1, w2, b2):
        h = torch.einsum("bsd,df->bsf", x, w1) + b1
        zero = torch.zeros_like(h)
        r = torch.where(h > zero, h, zero)
        h = r * r
        out = torch.einsum("bsf,fd->bsd", h, w2) + b2
        return out

    x = A_x
    x = x + _A_ref(_layernorm(x, axis=-1), A_wqkv, A_wo)
    x = x + _B_ref(_layernorm(x, axis=-1), B_w1, B_b1, B_w2, B_b2)
    x = x + _A_ref(_layernorm(x, axis=-1), A_wqkv, A_wo)
    x = x + _B_ref(_layernorm(x, axis=-1), B_w1, B_b1, B_w2, B_b2)
    return x
```

```asm
; @launch grid=(256,1,1) block=(256,1,1) lds=163840
.amdgcn_target "amdgcn-amd-amdhsa--gfx950"
.text
.globl interleave_layers__linear_attn_block__dense_activation_squared_relu__prompt_kernel
.p2align 8
.type interleave_layers__linear_attn_block__dense_activation_squared_relu__prompt_kernel,@function
interleave_layers__linear_attn_block__dense_activation_squared_relu__prompt_kernel:
  s_cmp_ge_u32 s2, 256
  s_cbranch_scc1 main_end
  s_load_dwordx16 s[64:79], s[0:1], 0
  s_load_dwordx2 s[80:81], s[0:1], 64
  s_load_dwordx2 s[82:83], s[0:1], 80
  s_getpc_b64 s[88:89]
main_pc:
  s_bfe_u32 s41, s2, 131075
  v_and_b32 v250, 15, v0
  s_lshl_b32 s41, s41, 4
  v_add_lshl_u32 v250, v250, s41, 7
  s_sub_u32 s88, s88, main_pc-interleave_layers__linear_attn_block__dense_activation_squared_relu__prompt_kernel
  s_subb_u32 s89, s89, 0
  global_load_dword v49, v250, s[88:89]
  v_lshrrev_b32 v248, 6, v0
  v_and_b32 v1, 63, v0
  v_readfirstlane_b32 s24, v248
  s_lshr_b32 s42, s2, 3
  s_mul_i32 s42, s42, 1792
  s_add_u32 s42, s42, 8192
  v_lshl_add_u32 v250, v0, 3, s42
  v_min_u32 v250, 57340, v250
  global_load_dword v49, v250, s[88:89]
  v_lshlrev_b32 v4, 4, v1
  v_and_b32 v2, 15, v1
  v_lshrrev_b32 v3, 4, v1
  v_mov_b32 v252, 1073741824
  s_and_b32 s41, s2, 7
  s_lshl_b32 s41, s41, 1
  s_lshr_b32 s42, s2, 7
  s_add_u32 s25, s41, s42
  s_bfe_u32 s26, s2, 262147
  v_lshrrev_b32 v249, 3, v1
  v_and_b32 v251, 7, v1
  v_mul_u32_u24 v248, 1280, v251
  v_lshl_add_u32 v96, v249, 4, v248
  v_lshrrev_b32 v250, 4, v1
  v_lshl_add_u32 v97, v250, 7, v96
  v_lshlrev_b32 v184, 8, v249
  v_lshl_add_u32 v184, v251, 4, v184
  s_lshl_b32 s44, s25, 4
  s_add_u32 s44, s44, s26
  s_mul_i32 s44, s44, 10240
  s_mul_i32 s43, s24, 3
  s_waitcnt lgkmcnt(0)
  s_mov_b32 s16, s64
  s_mov_b32 s17, s65
  s_mov_b32 s18, 2621440
  s_mov_b32 s19, 0x00020000
  s_add_u32 s90, s43, 0
  s_cmp_ge_u32 s90, 8
  s_cselect_b64 vcc, -1, 0
  s_cselect_b32 s41, 40, 10
  s_cselect_b32 s42, -312, 0
  v_cndmask_b32 v248, v96, v97, vcc
  s_mul_i32 s41, s41, s90
  s_add_u32 s41, s41, s42
  s_lshl_b32 s41, s41, 4
  s_add_u32 s41, s41, s44
  s_cmp_ge_u32 s90, 10
  s_cselect_b32 s41, 1073741824, s41
  s_cselect_b32 s90, 524288, s90
  buffer_load_dwordx4 v[160:163], v248, s[16:19], s41 offen
  s_add_u32 s91, s43, 1
  s_cmp_ge_u32 s91, 8
  s_cselect_b64 vcc, -1, 0
  s_cselect_b32 s41, 40, 10
  s_cselect_b32 s42, -312, 0
  v_cndmask_b32 v249, v96, v97, vcc
  s_mul_i32 s41, s41, s91
  s_add_u32 s41, s41, s42
  s_lshl_b32 s41, s41, 4
  s_add_u32 s41, s41, s44
  s_cmp_ge_u32 s91, 10
  s_cselect_b32 s41, 1073741824, s41
  s_cselect_b32 s91, 524288, s91
  buffer_load_dwordx4 v[164:167], v249, s[16:19], s41 offen
  s_add_u32 s94, s43, 2
  s_cmp_ge_u32 s94, 8
  s_cselect_b64 vcc, -1, 0
  s_cselect_b32 s41, 40, 10
  s_cselect_b32 s42, -312, 0
  v_cndmask_b32 v248, v96, v97, vcc
  s_mul_i32 s41, s41, s94
  s_add_u32 s41, s41, s42
  s_lshl_b32 s41, s41, 4
  s_add_u32 s41, s41, s44
  s_cmp_ge_u32 s94, 10
  s_cselect_b32 s41, 1073741824, s41
  s_cselect_b32 s94, 524288, s94
  buffer_load_dwordx4 v[180:183], v248, s[16:19], s41 offen
  s_lshr_b32 s93, s25, 1
  s_and_b32 s7, s25, 1
  s_lshl_b32 s7, s7, 2
  s_add_u32 s7, s7, s24
  s_mov_b32 s4, 688542336
  s_mov_b32 s5, 0
  s_mul_i32 s41, s7, 10
  s_lshr_b32 s41, s4, s41
  s_and_b32 s41, s41, 1023
  s_cmp_eq_u32 s7, 3
  s_cselect_b32 s41, 1280, s41
  s_cmp_eq_u32 s7, 4
  s_cselect_b32 s41, 1300, s41
  s_cmp_eq_u32 s7, 5
  s_cselect_b32 s41, 0, s41
  s_cmp_eq_u32 s7, 6
  s_cselect_b32 s41, 1, s41
  s_cmp_eq_u32 s7, 7
  s_cselect_b32 s41, 32, s41
  s_mul_i32 s42, s26, 40
  s_add_u32 s41, s41, s42
  v_add_u32 v128, s41, v2
  v_add_u32 v131, v128, v2
  s_sub_u32 s42, s7, 5
  s_cmp_lt_u32 s42, 2
  s_cselect_b64 vcc, -1, 0
  v_cndmask_b32 v128, v128, v131, vcc
  v_lshrrev_b32 v131, 3, v2
  v_mul_u32_u24 v131, 600, v131
  v_lshrrev_b32 v132, 2, v2
  v_lshl_add_u32 v131, v132, 4, v131
  v_add3_u32 v131, v131, v2, s41
  s_cmp_eq_u32 s7, 2
  s_cselect_b64 vcc, -1, 0
  v_cndmask_b32 v128, v128, v131, vcc
  v_lshlrev_b32 v128, 1, v128
  s_cmp_eq_u32 s7, 7
  s_cselect_b32 s42, 8, 16
  v_cmp_le_u32 vcc, s42, v2
  s_mov_b32 s56, 3840
  s_nop 0
  v_cndmask_b32 v128, v128, v252, vcc
  s_mov_b32 s43, 30720
  v_mad_u32_u24 v129, v3, s43, v128
  v_and_b32 v131, 1, v3
  v_lshrrev_b32 v132, 1, v3
  v_lshl_add_u32 v134, v131, 1, v132
  s_mov_b32 s43, 15360
  v_mad_u32_u24 v130, v134, s43, v128
  s_mov_b32 s84, s66
  s_mov_b32 s85, s67
  s_mov_b32 s86, 2457600
  s_mov_b32 s87, 0x00020000
  s_mul_i32 s42, s93, 80
  s_mul_i32 s46, s42, s56
  buffer_load_ushort v64, v129, s[84:87], s46 offen
  s_add_u32 s46, s46, s56
  buffer_load_ushort v65, v129, s[84:87], s46 offen
  s_add_u32 s46, s46, s56
  buffer_load_ushort v66, v129, s[84:87], s46 offen
  s_add_u32 s46, s46, s56
  buffer_load_ushort v67, v129, s[84:87], s46 offen
  s_add_u32 s46, s46, s56
  buffer_load_ushort v68, v129, s[84:87], s46 offen
  s_add_u32 s46, s46, s56
  buffer_load_ushort v69, v129, s[84:87], s46 offen
  s_add_u32 s46, s46, s56
  buffer_load_ushort v70, v129, s[84:87], s46 offen
  s_add_u32 s46, s46, s56
  buffer_load_ushort v71, v129, s[84:87], s46 offen
  s_add_u32 s41, s42, 32
  s_mul_i32 s46, s41, s56
  buffer_load_ushort v72, v129, s[84:87], s46 offen
  s_add_u32 s46, s46, s56
  buffer_load_ushort v73, v129, s[84:87], s46 offen
  s_add_u32 s46, s46, s56
  buffer_load_ushort v74, v129, s[84:87], s46 offen
  s_add_u32 s46, s46, s56
  buffer_load_ushort v75, v129, s[84:87], s46 offen
  s_add_u32 s46, s46, s56
  buffer_load_ushort v76, v129, s[84:87], s46 offen
  s_add_u32 s46, s46, s56
  buffer_load_ushort v77, v129, s[84:87], s46 offen
  s_add_u32 s46, s46, s56
  buffer_load_ushort v78, v129, s[84:87], s46 offen
  s_add_u32 s46, s46, s56
  buffer_load_ushort v79, v129, s[84:87], s46 offen
  s_add_u32 s41, s42, 64
  s_mul_i32 s46, s41, s56
  buffer_load_ushort v80, v130, s[84:87], s46 offen
  s_add_u32 s46, s46, s56
  buffer_load_ushort v81, v130, s[84:87], s46 offen
  s_add_u32 s46, s46, s56
  buffer_load_ushort v82, v130, s[84:87], s46 offen
  s_add_u32 s46, s46, s56
  buffer_load_ushort v83, v130, s[84:87], s46 offen
  s_mov_b32 s8, s82
  s_mov_b32 s9, s83
  s_mov_b32 s10, 22052864
  s_mov_b32 s11, 0x00020000
  s_load_dword s92, s[82:83], 16384
  s_mov_b32 s41, 0x3f803f80
  v_mov_b32 v30, s41
  s_and_b32 s27, s26, 7
  s_lshr_b32 s28, s26, 3
  s_mov_b32 s20, s78
  s_mov_b32 s21, s79
  s_mov_b32 s22, 1280
  s_mov_b32 s23, 0x00020000
  s_mov_b32 s12, s80
  s_mov_b32 s13, s81
  s_mov_b32 s14, 2621440
  s_mov_b32 s15, 0x00020000
  s_and_b32 s29, s24, 1
  s_lshl_b32 s30, s24, 11
  s_mul_i32 s41, s26, 172032
  s_add_u32 s31, s41, 65536
  s_mul_i32 s41, s27, 106496
  s_add_u32 s32, s41, 2818048
  s_mul_i32 s41, s26, 155648
  s_add_u32 s33, s41, 3670016
  s_mul_i32 s41, s27, 278528
  s_add_u32 s34, s41, 6160384
  v_add_u32 v11, s30, v4
  s_mul_i32 s35, s25, 163840
  s_mul_i32 s36, s25, 442368
  s_lshl_b32 s37, s25, 13
  s_mul_i32 s41, s24, 40960
  v_add_u32 v12, s41, v4
  v_add_u32 v13, 20480, v12
  v_lshlrev_b32 v240, 11, v3
  v_lshl_add_u32 v240, v2, 3, v240
  s_lshl_b32 s41, s24, 8
  v_add_u32 v18, s41, v240
  s_mov_b32 s63, 0x3acccccd
  v_mov_b32 v5, v4
  v_add_u32 v6, 65536, v4
  v_add_u32 v7, 131072, v4
  s_lshl_b32 s41, s29, 10
  v_add_u32 v8, s41, v5
  v_add_u32 v9, s41, v6
  v_add_u32 v10, s41, v7
  v_lshlrev_b32 v244, 4, v0
  v_mov_b32 v248, 0
  v_mov_b32 v249, 0
  v_mov_b32 v250, 0
  v_mov_b32 v251, 0
  ds_write_b128 v244, v[248:251]
  ds_write_b128 v244, v[248:251] offset:4096
  s_lshl_b32 s51, s28, 2
  s_add_u32 s51, s51, s24
  s_xor_b32 s42, s51, 1
  s_mul_i32 s41, s51, 20480
  s_mul_i32 s43, s29, 10240
  s_add_u32 s41, s41, s43
  v_add_u32 v14, s41, v4
  s_mul_i32 s41, s51, 55296
  s_mul_i32 s43, s29, 27648
  s_add_u32 s41, s41, s43
  v_add_u32 v16, s41, v4
  s_mul_i32 s41, s42, 20480
  s_mul_i32 s43, s29, 10240
  s_add_u32 s41, s41, s43
  v_add_u32 v15, s41, v4
  s_mul_i32 s41, s42, 55296
  s_mul_i32 s43, s29, 27648
  s_add_u32 s41, s41, s43
  v_add_u32 v17, s41, v4
  v_lshrrev_b32 v240, 1, v3
  v_and_b32 v241, 1, v3
  v_lshlrev_b32 v242, 4, v2
  v_lshl_add_u32 v243, v240, 8, v242
  v_lshl_add_u32 v243, v241, 3, v243
  s_mul_i32 s41, s51, 20480
  v_add_u32 v32, s41, v4
  v_add_u32 v33, s41, v243
  s_mul_i32 s41, s24, 110592
  v_add_u32 v34, s41, v4
  s_cmp_ge_u32 s26, 12
  s_cselect_b32 s41, 1073741824, s41
  v_add_u32 v35, s41, v243
  s_mul_i32 s41, s24, 40960
  v_lshl_add_u32 v243, v3, 3, v242
  v_add_u32 v31, s41, v243
  v_cmp_gt_u32 vcc, 2, v3
  v_mov_b32 v243, 1073741824
  s_nop 0
  v_cndmask_b32 v31, v243, v31, vcc
  s_lshl_b32 s41, s51, 7
  v_lshl_add_u32 v243, v2, 3, s41
  v_lshl_add_u32 v19, v240, 2, v243
  s_lshl_b32 s41, s24, 7
  s_add_u32 s41, s41, 6400
  v_lshl_add_u32 v25, v3, 4, s41
  v_lshl_add_u32 v26, v2, 2, s41
  s_lshl_b32 s41, s51, 6
  s_add_u32 s41, s41, 6400
  v_lshl_add_u32 v27, v2, 2, s41
  v_lshlrev_b32 v243, 4, v3
  v_add_u32 v24, 6272, v243
  v_cmp_gt_u32 vcc, 10, v2
  v_add_u32 v243, 6144, v243
  s_nop 0
  v_cndmask_b32 v23, v24, v243, vcc
  s_lshl_b32 s41, s25, 3
  s_add_u32 s41, s41, s51
  s_mul_i32 s41, s41, 20480
  s_mul_i32 s42, s27, 160
  s_add_u32 s41, s41, s42
  v_mul_u32_u24 v243, 1280, v2
  v_add_u32 v243, s41, v243
  v_lshl_add_u32 v28, v3, 4, v243
  v_lshl_add_u32 v29, v3, 3, v243
  s_mul_i32 s41, s24, 5120
  v_add_u32 v39, s41, v4
  v_lshlrev_b32 v36, 2, v2
  v_and_b32 v38, 7, v1
  s_lshl_b32 s41, s27, 3
  v_add_lshl_u32 v38, v38, s41, 7
  v_mov_b32 v52, 0x3f317218
  v_mov_b32 v54, 0x358637bd
  s_mov_b32 s48, 0x00ff00ff
  s_mov_b32 s49, 0x00ff00ff
  s_lshl_b32 s41, s25, 8
  s_add_u32 s38, s41, 0
  s_add_u32 s39, s41, 4096
  s_lshl_b32 s41, s26, 8
  s_add_u32 s40, s41, 8192
  s_lshl_b32 s41, s27, 11
  s_add_u32 s54, s35, s41
  s_lshr_b32 s41, s27, 1
  s_lshl_b32 s41, s41, 10
  s_and_b32 s42, s27, 1
  s_lshl_b32 s42, s42, 9
  s_add_u32 s41, s41, s42
  s_add_u32 s41, s41, 16384
  s_add_u32 s55, s35, s41
  s_lshl_b32 s41, s27, 10
  s_add_u32 s56, s37, s41
  s_lshl_b32 s41, s26, 10
  s_add_u32 s57, s35, s41
  s_lshl_b32 s41, s26, 8
  s_add_u32 s41, s41, 16384
  s_add_u32 s58, s35, s41
  s_mul_i32 s41, s26, 3072
  s_add_u32 s59, s36, s41
  s_lshl_b32 s41, s26, 9
  s_add_u32 s41, s41, 49152
  s_add_u32 s60, s36, s41
  s_mul_i32 s61, s26, 28672
  s_getreg_b32 s62, hwreg(HW_REG_XCC_ID, 0, 4)
  s_and_b32 s62, s62, 7
  s_add_u32 s62, s62, 8
  s_waitcnt lgkmcnt(0)
  s_add_u32 s62, s62, s92
  s_mov_b32 s47, 0
  s_mov_b32 s41, 52429
  v_mul_u32_u24 v240, s41, v0
  v_lshrrev_b32 v240, 18, v240
  v_mul_u32_u24 v243, 5, v240
  v_sub_u32 v243, v0, v243
  v_cmp_le_u32 vcc, 21, v240
  s_nop 1
  v_cndmask_b32 v241, 0, 1, vcc
  v_mul_u32_u24 v242, 21, v241
  v_sub_u32 v242, v240, v242
  v_cmp_le_u32 s[100:101], 16, v242
  v_cmp_eq_u32 s[88:89], 4, v243
  s_nop 0
  v_cndmask_b32 v246, 0, 1, s[100:101]
  v_lshl_add_u32 v246, v241, 1, v246
  v_add_u32 v247, 4, v241
  v_cndmask_b32 v247, v247, 6, s[100:101]
  v_cndmask_b32 v246, v246, v247, s[88:89]
  v_cndmask_b32 v247, v243, v241, s[88:89]
  v_lshl_add_u32 v100, v241, 2, v242
  v_subrev_u32 v100, 8, v100
  v_cndmask_b32 v100, v242, v100, s[100:101]
  v_cmp_eq_u32 vcc, 20, v242
  s_nop 1
  v_cndmask_b32 v100, v100, 0, vcc
  v_lshl_add_u32 v247, v247, 4, v100
  v_lshlrev_b32 v247, 4, v247
  v_lshl_add_u32 v20, v246, 10, v247
  v_mul_u32_u24 v246, 5, v241
  v_add_u32 v246, v246, v243
  v_cmp_le_u32 s[88:89], 8, v246
  v_lshrrev_b32 v247, 1, v246
  v_subrev_u32 v100, 8, v246
  v_cndmask_b32 v247, v247, v100, s[88:89]
  v_and_b32 v100, 1, v246
  v_cndmask_b32 v100, v100, 0, s[88:89]
  v_lshlrev_b32 v100, 3, v100
  v_cndmask_b32 v246, 0, 1, s[88:89]
  v_lshl_add_u32 v101, v241, 1, v246
  v_lshl_add_u32 v101, v101, 2, v247
  v_lshl_add_u32 v101, v101, 4, v100
  v_add_u32 v101, 6144, v101
  v_mul_u32_u24 v244, 20, v241
  v_add_u32 v244, v244, v242
  v_cmp_le_u32 s[100:101], 32, v244
  v_and_b32 v245, 1, v244
  s_nop 0
  v_cndmask_b32 v245, v245, 2, s[100:101]
  v_lshl_add_u32 v246, v245, 1, v246
  v_lshrrev_b32 v245, 1, v244
  v_subrev_u32 v244, 32, v244
  v_cndmask_b32 v244, v245, v244, s[100:101]
  v_lshl_add_u32 v244, v247, 4, v244
  v_lshl_add_u32 v244, v244, 4, v100
  v_lshl_add_u32 v244, v246, 10, v244
  v_cndmask_b32 v244, v244, v101, vcc
  v_cmp_gt_u32 vcc, 210, v0
  v_mov_b32 v245, 6912
  s_nop 0
  v_cndmask_b32 v21, v245, v244, vcc
  v_cndmask_b32 v20, 0, v20, vcc
  v_lshlrev_b32 v244, 3, v0
  v_mov_b32 v245, 1073741824
  v_cndmask_b32 v22, v245, v244, vcc
  v_and_b32 v244, -16, v244
  v_and_b32 v240, 1, v0
  v_mul_u32_u24 v240, 14336, v240
  v_add_u32 v244, v244, v240
  v_cndmask_b32 v37, v245, v244, vcc
  s_mov_b32 s84, s74
  s_mov_b32 s85, s75
  s_mov_b32 s86, 3456
  s_mov_b32 s87, 0x00020000
  s_lshl_b32 s101, s28, 4
  s_add_u32 s101, s101, s25
  s_cmp_eq_u32 s101, 15
  s_cselect_b32 s41, 39, 127
  s_mul_i32 s101, s101, 3
  s_add_u32 s101, s101, s24
  s_add_u32 s101, s101, 39
  s_cmp_ge_u32 s101, 97
  s_cselect_b32 s42, 97, 0
  s_sub_u32 s101, s101, s42
  s_cmp_eq_u32 s24, 0
  s_cselect_b32 s101, s41, s101
  v_lshrrev_b32 v131, 1, v3
  v_and_b32 v132, 1, v3
  v_mov_b32 v189, v4
  s_mov_b32 s71, 1073741824
  s_cmp_ge_u32 s101, 55
  s_cbranch_scc1 job_w2_2
  s_cmp_ge_u32 s101, 40
  s_cbranch_scc1 job_wo_1
  s_mov_b32 s96, s72
  s_mov_b32 s97, s73
  s_mov_b32 s98, 2211840
  s_mov_b32 s99, 0x00020000
  s_and_b32 s88, s101, 3
  s_lshr_b32 s89, s101, 2
  s_cmp_ge_u32 s89, 5
  s_cselect_b32 s41, 5, 0
  s_cselect_b32 s101, 8, 0
  s_sub_u32 s89, s89, s41
  s_add_u32 s101, s101, s27
  s_mul_i32 s44, s101, 112
  s_max_u32 s42, s101, 12
  s_sub_u32 s42, s42, 12
  s_lshl_b32 s42, s42, 4
  s_sub_u32 s44, s44, s42
  s_lshl_b32 s41, s88, 5
  s_add_u32 s41, s41, s44
  s_lshl_b32 s41, s41, 1
  s_mov_b32 s70, 1024
  s_cmp_lt_u32 s88, 3
  s_cselect_b64 vcc, -1, 0
  s_cselect_b32 s70, s70, 1073741824
  v_lshlrev_b32 v128, 2, v2
  v_and_b32 v129, 14, v2
  v_lshlrev_b32 v129, 1, v129
  v_cndmask_b32 v128, v129, v128, vcc
  v_add_u32 v128, s41, v128
  v_and_b32 v129, 1, v2
  v_cndmask_b32 v129, v129, 0, vcc
  s_mov_b32 s41, 0x02020202
  v_mul_lo_u32 v129, v129, s41
  v_add_u32 v169, 0x05040100, v129
  s_mov_b32 s100, 3456
  s_mov_b32 s43, 27648
  v_mul_u32_u24 v129, s43, v3
  s_mov_b32 s43, 276480
  v_mul_u32_u24 v130, s43, v131
  s_mov_b32 s43, 27648
  v_mad_u32_u24 v130, v132, s43, v130
  s_cmp_lt_u32 s89, 4
  s_cselect_b64 vcc, -1, 0
  v_cndmask_b32 v168, v130, v129, vcc
  s_lshl_b32 s41, s88, 4
  s_add_u32 s41, s41, s101
  s_cmp_ge_u32 s41, 60
  s_cselect_b64 vcc, -1, 0
  v_cndmask_b32 v128, v128, v252, vcc
  s_mul_i32 s41, s89, 160
  s_add_u32 s41, s41, 0
  s_cmp_eq_u32 s89, 4
  s_cselect_b32 s3, 64, s41
  s_mul_i32 s41, s89, 160
  s_add_u32 s41, s41, 32
  s_cmp_eq_u32 s89, 4
  s_cselect_b32 s4, 224, s41
  s_mul_i32 s41, s89, 160
  s_add_u32 s41, s41, 80
  s_cmp_eq_u32 s89, 4
  s_cselect_b32 s5, 384, s41
  s_mul_i32 s41, s89, 160
  s_add_u32 s41, s41, 112
  s_cmp_eq_u32 s89, 4
  s_cselect_b32 s6, 544, s41
  s_cmp_lt_u32 s88, 2
  s_cselect_b32 s79, 4, 3
  s_cselect_b32 s44, 0, 80
  s_lshl_b32 s41, s88, 1
  s_add_u32 s44, s44, s41
  s_mul_i32 s42, s101, 152
  s_add_u32 s44, s44, s42
  s_add_u32 s44, s44, 3584
  s_lshl_b32 s41, s89, 2
  s_add_u32 s41, s41, 0
  s_mul_i32 s41, s41, s79
  s_add_u32 s41, s41, s44
  s_lshl_b32 s64, s41, 10
  s_lshl_b32 s41, s89, 2
  s_add_u32 s41, s41, 1
  s_mul_i32 s41, s41, s79
  s_add_u32 s41, s41, s44
  s_lshl_b32 s65, s41, 10
  s_lshl_b32 s41, s89, 2
  s_add_u32 s41, s41, 2
  s_mul_i32 s41, s41, s79
  s_add_u32 s41, s41, s44
  s_lshl_b32 s66, s41, 10
  s_lshl_b32 s41, s89, 2
  s_add_u32 s41, s41, 3
  s_mul_i32 s41, s41, s79
  s_add_u32 s41, s41, s44
  s_lshl_b32 s67, s41, 10
  s_mul_i32 s43, s79, 20
  s_add_u32 s43, s43, s44
  s_lshl_b32 s71, s43, 10
  s_branch job_go_3
job_wo_1:
  s_mov_b32 s96, s68
  s_mov_b32 s97, s69
  s_mov_b32 s98, 819200
  s_mov_b32 s99, 0x00020000
  s_sub_u32 s101, s101, 40
  s_mul_i32 s89, s101, 43691
  s_lshr_b32 s89, s89, 17
  s_mul_i32 s41, s89, 3
  s_sub_u32 s88, s101, s41
  s_mul_i32 s44, s27, 80
  s_lshl_b32 s41, s88, 5
  s_add_u32 s41, s41, s44
  s_lshl_b32 s41, s41, 1
  s_mov_b32 s70, 2048
  s_cmp_lt_u32 s88, 2
  s_cselect_b64 vcc, -1, 0
  s_cselect_b32 s70, s70, 1073741824
  v_lshlrev_b32 v128, 2, v2
  v_and_b32 v129, 14, v2
  v_lshlrev_b32 v129, 1, v129
  v_cndmask_b32 v128, v129, v128, vcc
  v_add_u32 v128, s41, v128
  v_and_b32 v129, 1, v2
  v_cndmask_b32 v129, v129, 0, vcc
  s_mov_b32 s41, 0x02020202
  v_mul_lo_u32 v129, v129, s41
  v_add_u32 v169, 0x05040100, v129
  s_mov_b32 s100, 1280
  s_mov_b32 s43, 10240
  v_mul_u32_u24 v129, s43, v3
  s_mov_b32 s43, 102400
  v_mul_u32_u24 v130, s43, v131
  s_mov_b32 s43, 51200
  v_mad_u32_u24 v130, v132, s43, v130
  s_cmp_lt_u32 s89, 4
  s_cselect_b64 vcc, -1, 0
  v_cndmask_b32 v168, v130, v129, vcc
  s_mul_i32 s41, s89, 160
  s_add_u32 s41, s41, 0
  s_cmp_eq_u32 s89, 4
  s_cselect_b32 s3, 32, s41
  s_mul_i32 s41, s89, 160
  s_add_u32 s41, s41, 40
  s_cmp_eq_u32 s89, 4
  s_cselect_b32 s4, 192, s41
  s_mul_i32 s41, s89, 160
  s_add_u32 s41, s41, 80
  s_cmp_eq_u32 s89, 4
  s_cselect_b32 s5, 352, s41
  s_mul_i32 s41, s89, 160
  s_add_u32 s41, s41, 120
  s_cmp_eq_u32 s89, 4
  s_cselect_b32 s6, 512, s41
  s_mul_i32 s44, s27, 104
  s_add_u32 s44, s44, 2752
  s_lshl_b32 s41, s88, 2
  s_add_u32 s44, s44, s41
  s_lshl_b32 s41, s89, 2
  s_add_u32 s41, s41, 0
  s_mul_i32 s43, s41, 10
  s_cmp_ge_u32 s41, 10
  s_cselect_b32 s42, 99, 0
  s_sub_u32 s43, s43, s42
  s_add_u32 s43, s43, s44
  s_lshl_b32 s64, s43, 10
  s_lshl_b32 s41, s89, 2
  s_add_u32 s41, s41, 1
  s_mul_i32 s43, s41, 10
  s_cmp_ge_u32 s41, 10
  s_cselect_b32 s42, 99, 0
  s_sub_u32 s43, s43, s42
  s_add_u32 s43, s43, s44
  s_lshl_b32 s65, s43, 10
  s_lshl_b32 s41, s89, 2
  s_add_u32 s41, s41, 2
  s_mul_i32 s43, s41, 10
  s_cmp_ge_u32 s41, 10
  s_cselect_b32 s42, 99, 0
  s_sub_u32 s43, s43, s42
  s_add_u32 s43, s43, s44
  s_lshl_b32 s66, s43, 10
  s_lshl_b32 s41, s89, 2
  s_add_u32 s41, s41, 3
  s_mul_i32 s43, s41, 10
  s_cmp_ge_u32 s41, 10
  s_cselect_b32 s42, 99, 0
  s_sub_u32 s43, s43, s42
  s_add_u32 s43, s43, s44
  s_lshl_b32 s67, s43, 10
  s_branch job_go_3
job_w2_2:
  s_mov_b32 s96, s76
  s_mov_b32 s97, s77
  s_mov_b32 s98, 2211840
  s_mov_b32 s99, 0x00020000
  s_sub_u32 s101, s101, 55
  s_mul_i32 s89, s101, 43691
  s_lshr_b32 s89, s89, 17
  s_mul_i32 s41, s89, 3
  s_sub_u32 s88, s101, s41
  s_mul_i32 s44, s27, 80
  s_lshl_b32 s41, s88, 5
  s_add_u32 s41, s41, s44
  s_lshl_b32 s41, s41, 1
  s_mov_b32 s70, 2048
  s_cmp_lt_u32 s88, 2
  s_cselect_b64 vcc, -1, 0
  s_cselect_b32 s70, s70, 1073741824
  v_lshlrev_b32 v128, 2, v2
  v_and_b32 v129, 14, v2
  v_lshlrev_b32 v129, 1, v129
  v_cndmask_b32 v128, v129, v128, vcc
  v_add_u32 v128, s41, v128
  v_and_b32 v129, 1, v2
  v_cndmask_b32 v129, v129, 0, vcc
  s_mov_b32 s41, 0x02020202
  v_mul_lo_u32 v129, v129, s41
  v_add_u32 v169, 0x05040100, v129
  s_mov_b32 s100, 1280
  s_mov_b32 s43, 10240
  v_mul_u32_u24 v129, s43, v3
  s_mov_b32 s43, 143360
  v_mul_u32_u24 v130, s43, v131
  s_mov_b32 s43, 10240
  v_mad_u32_u24 v130, v132, s43, v130
  s_cmp_lt_u32 s89, 12
  s_cselect_b64 vcc, -1, 0
  v_cndmask_b32 v168, v130, v129, vcc
  s_cmp_ge_u32 s89, 14
  s_cselect_b64 vcc, -1, 0
  v_cndmask_b32 v128, v128, v252, vcc
  v_cndmask_b32 v189, v189, v252, vcc
  s_min_u32 s89, s89, 13
  s_lshl_b32 s43, s89, 2
  s_add_u32 s43, s43, 0
  s_mul_i32 s41, s43, 43691
  s_lshr_b32 s41, s41, 17
  s_lshl_b32 s41, s41, 4
  s_min_u32 s41, s41, 192
  s_lshl_b32 s42, s43, 5
  s_add_u32 s41, s41, s42
  s_mul_i32 s42, s43, 224
  s_sub_u32 s42, s42, 10656
  s_cmp_ge_u32 s43, 48
  s_cselect_b32 s3, s42, s41
  s_lshl_b32 s43, s89, 2
  s_add_u32 s43, s43, 1
  s_mul_i32 s41, s43, 43691
  s_lshr_b32 s41, s41, 17
  s_lshl_b32 s41, s41, 4
  s_min_u32 s41, s41, 192
  s_lshl_b32 s42, s43, 5
  s_add_u32 s41, s41, s42
  s_mul_i32 s42, s43, 224
  s_sub_u32 s42, s42, 10656
  s_cmp_ge_u32 s43, 48
  s_cselect_b32 s4, s42, s41
  s_lshl_b32 s43, s89, 2
  s_add_u32 s43, s43, 2
  s_mul_i32 s41, s43, 43691
  s_lshr_b32 s41, s41, 17
  s_lshl_b32 s41, s41, 4
  s_min_u32 s41, s41, 192
  s_lshl_b32 s42, s43, 5
  s_add_u32 s41, s41, s42
  s_mul_i32 s42, s43, 224
  s_sub_u32 s42, s42, 10656
  s_cmp_ge_u32 s43, 48
  s_cselect_b32 s5, s42, s41
  s_lshl_b32 s43, s89, 2
  s_add_u32 s43, s43, 3
  s_mul_i32 s41, s43, 43691
  s_lshr_b32 s41, s41, 17
  s_lshl_b32 s41, s41, 4
  s_min_u32 s41, s41, 192
  s_lshl_b32 s42, s43, 5
  s_add_u32 s41, s41, s42
  s_mul_i32 s42, s43, 224
  s_sub_u32 s42, s42, 10656
  s_cmp_ge_u32 s43, 48
  s_cselect_b32 s6, s42, s41
  s_mul_i32 s44, s27, 272
  s_add_u32 s44, s44, 6016
  s_lshl_b32 s41, s88, 2
  s_add_u32 s44, s44, s41
  s_lshl_b32 s41, s89, 2
  s_add_u32 s41, s41, 0
  s_mul_i32 s43, s41, 10
  s_cmp_ge_u32 s41, 27
  s_cselect_b32 s42, 269, 0
  s_sub_u32 s43, s43, s42
  s_add_u32 s43, s43, s44
  s_lshl_b32 s64, s43, 10
  s_lshl_b32 s41, s89, 2
  s_add_u32 s41, s41, 1
  s_mul_i32 s43, s41, 10
  s_cmp_ge_u32 s41, 27
  s_cselect_b32 s42, 269, 0
  s_sub_u32 s43, s43, s42
  s_add_u32 s43, s43, s44
  s_lshl_b32 s65, s43, 10
  s_lshl_b32 s41, s89, 2
  s_add_u32 s41, s41, 2
  s_mul_i32 s43, s41, 10
  s_cmp_ge_u32 s41, 27
  s_cselect_b32 s42, 269, 0
  s_sub_u32 s43, s43, s42
  s_add_u32 s43, s43, s44
  s_lshl_b32 s66, s43, 10
  s_cmp_ge_u32 s41, 54
  s_cselect_b32 s66, 1073741824, s66
  s_lshl_b32 s41, s89, 2
  s_add_u32 s41, s41, 3
  s_mul_i32 s43, s41, 10
  s_cmp_ge_u32 s41, 27
  s_cselect_b32 s42, 269, 0
  s_sub_u32 s43, s43, s42
  s_add_u32 s43, s43, s44
  s_lshl_b32 s67, s43, 10
  s_cmp_ge_u32 s41, 54
  s_cselect_b32 s67, 1073741824, s67
job_go_3:
  v_add_u32 v168, v168, v128
  s_cmp_lt_u32 s89, 2
  s_cselect_b64 vcc, -1, 0
  v_cndmask_b32 v102, v252, v128, vcc
  v_mov_b32 v188, 0x07060302
  v_add_u32 v131, s89, v3
  v_lshrrev_b32 v132, 1, v131
  v_lshlrev_b32 v134, 4, v2
  v_lshl_add_u32 v134, v132, 8, v134
  v_and_b32 v131, 1, v131
  v_lshl_add_u32 v134, v131, 3, v134
  s_cmp_eq_u32 s89, 4
  s_cselect_b32 s41, 4, 1
  v_cmp_gt_u32 vcc, s41, v3
  s_nop 1
  v_cndmask_b32 v134, v252, v134, vcc
  s_lshl_b32 s41, s26, 4
  s_add_u32 s41, s41, s25
  s_mul_i32 s41, s41, 1792
  s_mul_i32 s42, s24, 448
  s_add_u32 s41, s41, s42
  s_add_u32 s79, s41, 21299200
  s_lshr_b32 s41, s26, 1
  s_lshl_b32 s42, s25, 3
  s_add_u32 s41, s41, s42
  s_mul_i32 s41, s41, 20480
  s_and_b32 s42, s26, 1
  s_lshl_b32 s42, s42, 7
  s_add_u32 s41, s41, s42
  s_add_u32 s41, s41, 8388608
  s_lshl_b32 s42, s90, 11
  s_add_u32 s42, s42, s41
  s_waitcnt vmcnt(22)
  buffer_store_dwordx4 v[160:163], v184, s[8:11], s42 offen sc1
  s_lshl_b32 s42, s91, 11
  s_add_u32 s42, s42, s41
  s_waitcnt vmcnt(22)
  buffer_store_dwordx4 v[164:167], v184, s[8:11], s42 offen sc1
  s_lshl_b32 s42, s94, 11
  s_add_u32 s42, s42, s41
  s_waitcnt vmcnt(22)
  buffer_store_dwordx4 v[180:183], v184, s[8:11], s42 offen sc1
  v_mov_b32 v90, 0
  v_mov_b32 v91, 0
  v_mov_b32 v88, 0
  v_mov_b32 v89, 0
  v_dot2c_f32_bf16 v90, v160, v30
  v_dot2c_f32_bf16 v91, v160, v160
  v_dot2c_f32_bf16 v90, v161, v30
  v_dot2c_f32_bf16 v91, v161, v161
  v_dot2c_f32_bf16 v90, v162, v30
  v_dot2c_f32_bf16 v91, v162, v162
  v_dot2c_f32_bf16 v90, v163, v30
  v_dot2c_f32_bf16 v91, v163, v163
  v_dot2c_f32_bf16 v90, v164, v30
  v_dot2c_f32_bf16 v91, v164, v164
  v_dot2c_f32_bf16 v90, v165, v30
  v_dot2c_f32_bf16 v91, v165, v165
  v_dot2c_f32_bf16 v90, v166, v30
  v_dot2c_f32_bf16 v91, v166, v166
  v_dot2c_f32_bf16 v90, v167, v30
  v_dot2c_f32_bf16 v91, v167, v167
  v_dot2c_f32_bf16 v90, v180, v30
  v_dot2c_f32_bf16 v91, v180, v180
  v_dot2c_f32_bf16 v90, v181, v30
  v_dot2c_f32_bf16 v91, v181, v181
  v_dot2c_f32_bf16 v90, v182, v30
  v_dot2c_f32_bf16 v91, v182, v182
  v_dot2c_f32_bf16 v90, v183, v30
  v_dot2c_f32_bf16 v91, v183, v183
  s_nop 1
  v_add_f32_dpp v90, v90, v90 row_ror:8 row_mask:0xf bank_mask:0xf
  v_mov_b32 v136, v90
  s_nop 1
  v_permlane32_swap_b32 v90, v136
  v_add_f32 v90, v90, v136
  v_mov_b32 v136, v90
  s_nop 1
  v_permlane16_swap_b32 v90, v136
  v_add_f32 v90, v90, v136
  v_add_f32_dpp v91, v91, v91 row_ror:8 row_mask:0xf bank_mask:0xf
  v_mov_b32 v136, v91
  s_nop 1
  v_permlane32_swap_b32 v91, v136
  v_add_f32 v91, v91, v136
  v_mov_b32 v136, v91
  s_nop 1
  v_permlane16_swap_b32 v91, v136
  v_add_f32 v91, v91, v136
  s_lshl_b32 s41, s25, 3
  s_add_u32 s41, s41, s24
  s_lshl_b32 s41, s41, 10
  s_lshl_b32 s42, s26, 6
  s_add_u32 s41, s41, s42
  s_add_u32 s41, s41, 11010048
  s_add_u32 s42, s41, 4096
  v_lshlrev_b32 v136, 3, v1
  s_mov_b64 exec, 0xff
  buffer_store_dwordx2 v[90:91], v136, s[8:11], s41 offen sc1
  buffer_store_dwordx2 v[88:89], v136, s[8:11], s42 offen sc1
  s_mov_b64 exec, -1
  s_cmp_lt_u32 s7, 5
  s_cselect_b32 s44, 5, 3
  s_cselect_b32 s41, 0, 100
  s_add_u32 s41, s41, s7
  s_mul_i32 s42, s26, 168
  s_add_u32 s41, s41, s42
  s_add_u32 s41, s41, 64
  s_lshl_b32 s41, s41, 10
  s_lshl_b32 s44, s44, 10
  s_mul_i32 s42, s93, s44
  s_lshl_b32 s42, s42, 1
  s_add_u32 s42, s42, s41
  s_waitcnt vmcnt(23)
  v_lshl_or_b32 v64, v65, 16, v64
  s_waitcnt vmcnt(21)
  v_lshl_or_b32 v65, v67, 16, v66
  s_waitcnt vmcnt(19)
  v_lshl_or_b32 v66, v69, 16, v68
  s_waitcnt vmcnt(17)
  v_lshl_or_b32 v67, v71, 16, v70
  buffer_store_dwordx4 v[64:67], v4, s[8:11], s42 offen sc1
  s_add_u32 s42, s42, s44
  s_waitcnt vmcnt(16)
  v_lshl_or_b32 v72, v73, 16, v72
  s_waitcnt vmcnt(14)
  v_lshl_or_b32 v73, v75, 16, v74
  s_waitcnt vmcnt(12)
  v_lshl_or_b32 v74, v77, 16, v76
  s_waitcnt vmcnt(10)
  v_lshl_or_b32 v75, v79, 16, v78
  buffer_store_dwordx4 v[72:75], v4, s[8:11], s42 offen sc1
  s_lshr_b32 s42, s93, 1
  s_add_u32 s42, s42, 16
  s_mul_i32 s42, s42, s44
  s_add_u32 s42, s42, s41
  s_and_b32 s43, s93, 1
  s_lshl_b32 s95, s43, 9
  s_add_u32 s42, s42, s95
  v_lshlrev_b32 v136, 8, v3
  v_and_b32 v136, 256, v136
  v_lshl_add_u32 v136, v2, 4, v136
  v_lshrrev_b32 v137, 1, v3
  v_lshl_add_u32 v138, v137, 3, v136
  s_waitcnt vmcnt(9)
  v_lshl_or_b32 v80, v81, 16, v80
  s_waitcnt vmcnt(7)
  v_lshl_or_b32 v81, v83, 16, v82
  buffer_store_dwordx2 v[80:81], v138, s[8:11], s42 offen sc1
  v_mov_b32 v139, 0
  v_dot2c_f32_bf16 v139, v64, v30
  v_dot2c_f32_bf16 v139, v65, v30
  v_dot2c_f32_bf16 v139, v66, v30
  v_dot2c_f32_bf16 v139, v67, v30
  v_dot2c_f32_bf16 v139, v72, v30
  v_dot2c_f32_bf16 v139, v73, v30
  v_dot2c_f32_bf16 v139, v74, v30
  v_dot2c_f32_bf16 v139, v75, v30
  v_dot2c_f32_bf16 v139, v80, v30
  v_dot2c_f32_bf16 v139, v81, v30
  s_nop 2
  v_mov_b32 v136, v139
  s_nop 1
  v_permlane32_swap_b32 v139, v136
  v_add_f32 v139, v139, v136
  v_mov_b32 v136, v139
  s_nop 1
  v_permlane16_swap_b32 v139, v136
  v_add_f32 v139, v139, v136
  v_sub_f32 v139, 0, v139
  v_cvt_pk_bf16_f32 v136, v139, v139
  v_lshlrev_b32 v136, 16, v136
  v_sub_f32 v136, v139, v136
  v_cvt_pk_bf16_f32 v84, v139, v136
  v_and_b32 v85, 0xffff, v84
  s_mul_i32 s42, s44, 20
  s_add_u32 s42, s42, s41
  s_lshr_b32 s41, s93, 1
  s_lshl_b32 s41, s41, 8
  s_add_u32 s42, s42, s41
  s_lshl_b32 s43, s43, 3
  s_add_u32 s42, s42, s43
  s_mov_b64 exec, 0xffff
  buffer_store_dwordx2 v[84:85], v4, s[8:11], s42 offen sc1
  s_mov_b64 exec, -1
  v_mov_b32 v92, -1
  v_mov_b32 v93, -1
  v_mov_b32 v94, -1
  v_mov_b32 v95, -1
  s_lshl_b32 s41, s26, 4
  s_add_u32 s41, s41, s25
  s_mul_i32 s41, s41, 1792
  s_mul_i32 s42, s24, 448
  s_add_u32 s41, s41, s42
  s_add_u32 s41, s41, 20840448
  s_mov_b64 exec, 0xfffffff
  buffer_store_dwordx4 v[92:95], v4, s[8:11], s41 offen sc1
  s_mov_b64 exec, -1
  s_mul_i32 s44, s3, s100
  buffer_load_dword v208, v168, s[96:99], s44 offen
  s_add_u32 s44, s44, s100
  buffer_load_dword v209, v168, s[96:99], s44 offen
  s_add_u32 s44, s44, s100
  buffer_load_dword v210, v168, s[96:99], s44 offen
  s_add_u32 s44, s44, s100
  buffer_load_dword v211, v168, s[96:99], s44 offen
  s_add_u32 s44, s44, s100
  buffer_load_dword v212, v168, s[96:99], s44 offen
  s_add_u32 s44, s44, s100
  buffer_load_dword v213, v168, s[96:99], s44 offen
  s_add_u32 s44, s44, s100
  buffer_load_dword v214, v168, s[96:99], s44 offen
  s_add_u32 s44, s44, s100
  buffer_load_dword v215, v168, s[96:99], s44 offen
  s_mul_i32 s44, s4, s100
  buffer_load_dword v216, v168, s[96:99], s44 offen
  s_add_u32 s44, s44, s100
  buffer_load_dword v217, v168, s[96:99], s44 offen
  s_add_u32 s44, s44, s100
  buffer_load_dword v218, v168, s[96:99], s44 offen
  s_add_u32 s44, s44, s100
  buffer_load_dword v219, v168, s[96:99], s44 offen
  s_add_u32 s44, s44, s100
  buffer_load_dword v220, v168, s[96:99], s44 offen
  s_add_u32 s44, s44, s100
  buffer_load_dword v221, v168, s[96:99], s44 offen
  s_add_u32 s44, s44, s100
  buffer_load_dword v222, v168, s[96:99], s44 offen
  s_add_u32 s44, s44, s100
  buffer_load_dword v223, v168, s[96:99], s44 offen
  s_mul_i32 s44, s5, s100
  buffer_load_dword v224, v168, s[96:99], s44 offen
  s_add_u32 s44, s44, s100
  buffer_load_dword v225, v168, s[96:99], s44 offen
  s_add_u32 s44, s44, s100
  buffer_load_dword v226, v168, s[96:99], s44 offen
  s_add_u32 s44, s44, s100
  buffer_load_dword v227, v168, s[96:99], s44 offen
  s_add_u32 s44, s44, s100
  buffer_load_dword v228, v168, s[96:99], s44 offen
  s_add_u32 s44, s44, s100
  buffer_load_dword v229, v168, s[96:99], s44 offen
  s_add_u32 s44, s44, s100
  buffer_load_dword v230, v168, s[96:99], s44 offen
  s_add_u32 s44, s44, s100
  buffer_load_dword v231, v168, s[96:99], s44 offen
  s_mul_i32 s44, s6, s100
  buffer_load_dword v232, v168, s[96:99], s44 offen
  s_waitcnt vmcnt(25)
  s_barrier
  s_lshl_b32 s41, s47, 2
  s_add_u32 s41, s41, s24
  s_cmp_lg_u32 s41, 1
  s_cbranch_scc1 noflag_4
  s_lshl_b32 s41, s26, 2
  v_mov_b32 v98, s41
  s_add_u32 s41, s92, 1
  v_mov_b32 v99, s41
  s_mov_b64 exec, 1
  buffer_store_dword v99, v98, s[8:11], s39 offen sc1
  s_mov_b64 exec, -1
noflag_4:
  s_cmp_lg_u32 s24, 2
  s_cbranch_scc1 noflag_5
  s_lshl_b32 s41, s26, 2
  v_mov_b32 v98, s41
  s_add_u32 s41, s92, 1
  v_mov_b32 v99, s41
  s_mov_b64 exec, 1
  buffer_store_dword v99, v98, s[8:11], s38 offen
  s_mov_b64 exec, -1
noflag_5:
  s_cmp_lg_u32 s24, 3
  s_cbranch_scc1 noflag_6
  s_lshl_b32 s41, s25, 2
  v_mov_b32 v98, s41
  s_add_u32 s41, s92, 1
  v_mov_b32 v99, s41
  s_mov_b64 exec, 1
  buffer_store_dword v99, v98, s[8:11], s40 offen sc1
  s_mov_b64 exec, -1
noflag_6:
  s_add_u32 s44, s44, s100
  buffer_load_dword v233, v168, s[96:99], s44 offen
  s_add_u32 s44, s44, s100
  buffer_load_dword v234, v168, s[96:99], s44 offen
  s_add_u32 s44, s44, s100
  buffer_load_dword v235, v168, s[96:99], s44 offen
  s_add_u32 s44, s44, s100
  buffer_load_dword v236, v168, s[96:99], s44 offen
  s_add_u32 s44, s44, s100
  buffer_load_dword v237, v168, s[96:99], s44 offen
  s_add_u32 s44, s44, s100
  buffer_load_dword v238, v168, s[96:99], s44 offen
  s_add_u32 s44, s44, s100
  buffer_load_dword v239, v168, s[96:99], s44 offen
  buffer_load_dword v102, v102, s[84:87], 0 offen
  s_waitcnt vmcnt(31)
  v_perm_b32 v104, v209, v208, v169
  s_waitcnt vmcnt(29)
  v_perm_b32 v105, v211, v210, v169
  s_waitcnt vmcnt(27)
  v_perm_b32 v106, v213, v212, v169
  s_waitcnt vmcnt(25)
  v_perm_b32 v107, v215, v214, v169
  v_perm_b32 v208, v209, v208, v188
  v_perm_b32 v209, v211, v210, v188
  v_perm_b32 v210, v213, v212, v188
  v_perm_b32 v211, v215, v214, v188
  s_waitcnt vmcnt(23)
  v_perm_b32 v108, v217, v216, v169
  s_waitcnt vmcnt(21)
  v_perm_b32 v109, v219, v218, v169
  s_waitcnt vmcnt(19)
  v_perm_b32 v110, v221, v220, v169
  s_waitcnt vmcnt(17)
  v_perm_b32 v111, v223, v222, v169
  v_perm_b32 v216, v217, v216, v188
  v_perm_b32 v217, v219, v218, v188
  v_perm_b32 v218, v221, v220, v188
  v_perm_b32 v219, v223, v222, v188
  s_waitcnt vmcnt(15)
  v_perm_b32 v112, v225, v224, v169
  s_waitcnt vmcnt(13)
  v_perm_b32 v113, v227, v226, v169
  s_waitcnt vmcnt(11)
  v_perm_b32 v114, v229, v228, v169
  s_waitcnt vmcnt(9)
  v_perm_b32 v115, v231, v230, v169
  v_perm_b32 v224, v225, v224, v188
  v_perm_b32 v225, v227, v226, v188
  v_perm_b32 v226, v229, v228, v188
  v_perm_b32 v227, v231, v230, v188
  s_waitcnt vmcnt(7)
  v_perm_b32 v116, v233, v232, v169
  s_waitcnt vmcnt(5)
  v_perm_b32 v117, v235, v234, v169
  s_waitcnt vmcnt(3)
  v_perm_b32 v118, v237, v236, v169
  s_waitcnt vmcnt(1)
  v_perm_b32 v119, v239, v238, v169
  v_perm_b32 v232, v233, v232, v188
  v_perm_b32 v233, v235, v234, v188
  v_perm_b32 v234, v237, v236, v188
  v_perm_b32 v235, v239, v238, v188
  v_mov_b32 v240, -1
  v_mov_b32 v241, -1
  v_mov_b32 v242, -1
  v_mov_b32 v243, -1
  v_cmp_eq_u32 s[90:91], 0, v3
  v_mov_b32 v248, 0
  v_dot2c_f32_bf16 v248, v104, v30
  v_dot2c_f32_bf16 v248, v105, v30
  v_dot2c_f32_bf16 v248, v106, v30
  v_dot2c_f32_bf16 v248, v107, v30
  v_dot2c_f32_bf16 v248, v108, v30
  v_dot2c_f32_bf16 v248, v109, v30
  v_dot2c_f32_bf16 v248, v110, v30
  v_dot2c_f32_bf16 v248, v111, v30
  v_dot2c_f32_bf16 v248, v112, v30
  v_dot2c_f32_bf16 v248, v113, v30
  v_dot2c_f32_bf16 v248, v114, v30
  v_dot2c_f32_bf16 v248, v115, v30
  v_dot2c_f32_bf16 v248, v116, v30
  v_dot2c_f32_bf16 v248, v117, v30
  v_dot2c_f32_bf16 v248, v118, v30
  v_dot2c_f32_bf16 v248, v119, v30
  s_nop 2
  v_mov_b32 v249, v248
  s_nop 1
  v_permlane32_swap_b32 v248, v249
  v_add_f32 v248, v248, v249
  v_mov_b32 v249, v248
  s_nop 1
  v_permlane16_swap_b32 v248, v249
  v_add_f32 v248, v248, v249
  v_sub_f32 v248, 0, v248
  v_cvt_pk_bf16_f32 v249, v248, v248
  v_lshlrev_b32 v249, 16, v249
  v_sub_f32 v249, v248, v249
  v_cvt_pk_bf16_f32 v244, v248, v249
  v_and_b32 v245, 0xffff, v244
  s_waitcnt vmcnt(0)
  v_perm_b32 v249, v102, v102, v169
  v_and_b32 v249, 0xffff0000, v249
  v_or_b32 v245, v245, v249
  v_cndmask_b32 v244, 0, v244, s[90:91]
  v_cndmask_b32 v245, 0, v245, s[90:91]
  v_mov_b32 v248, 0
  v_dot2c_f32_bf16 v248, v208, v30
  v_dot2c_f32_bf16 v248, v209, v30
  v_dot2c_f32_bf16 v248, v210, v30
  v_dot2c_f32_bf16 v248, v211, v30
  v_dot2c_f32_bf16 v248, v216, v30
  v_dot2c_f32_bf16 v248, v217, v30
  v_dot2c_f32_bf16 v248, v218, v30
  v_dot2c_f32_bf16 v248, v219, v30
  v_dot2c_f32_bf16 v248, v224, v30
  v_dot2c_f32_bf16 v248, v225, v30
  v_dot2c_f32_bf16 v248, v226, v30
  v_dot2c_f32_bf16 v248, v227, v30
  v_dot2c_f32_bf16 v248, v232, v30
  v_dot2c_f32_bf16 v248, v233, v30
  v_dot2c_f32_bf16 v248, v234, v30
  v_dot2c_f32_bf16 v248, v235, v30
  s_nop 2
  v_mov_b32 v249, v248
  s_nop 1
  v_permlane32_swap_b32 v248, v249
  v_add_f32 v248, v248, v249
  v_mov_b32 v249, v248
  s_nop 1
  v_permlane16_swap_b32 v248, v249
  v_add_f32 v248, v248, v249
  v_sub_f32 v248, 0, v248
  v_cvt_pk_bf16_f32 v249, v248, v248
  v_lshlrev_b32 v249, 16, v249
  v_sub_f32 v249, v248, v249
  v_cvt_pk_bf16_f32 v246, v248, v249
  v_and_b32 v247, 0xffff, v246
  v_perm_b32 v249, v102, v102, v188
  v_and_b32 v249, 0xffff0000, v249
  v_or_b32 v247, v247, v249
  v_cndmask_b32 v246, 0, v246, s[90:91]
  v_cndmask_b32 v247, 0, v247, s[90:91]
  v_mov_b32 v169, v134
  buffer_store_dwordx4 v[104:107], v189, s[8:11], s64 offen sc1
  s_add_u32 s41, s64, s70
  buffer_store_dwordx4 v[208:211], v189, s[8:11], s41 offen sc1
  buffer_store_dwordx4 v[108:111], v189, s[8:11], s65 offen sc1
  s_add_u32 s41, s65, s70
  buffer_store_dwordx4 v[216:219], v189, s[8:11], s41 offen sc1
  buffer_store_dwordx4 v[112:115], v189, s[8:11], s66 offen sc1
  s_add_u32 s41, s66, s70
  buffer_store_dwordx4 v[224:227], v189, s[8:11], s41 offen sc1
  buffer_store_dwordx4 v[116:119], v189, s[8:11], s67 offen sc1
  s_add_u32 s41, s67, s70
  buffer_store_dwordx4 v[232:235], v189, s[8:11], s41 offen sc1
  s_mov_b64 exec, 0xfffffff
  buffer_store_dwordx4 v[240:243], v4, s[8:11], s79 offen sc1
  s_mov_b64 exec, -1
  buffer_store_dwordx2 v[244:245], v169, s[8:11], s71 offen sc1
  s_add_u32 s71, s71, s70
  buffer_store_dwordx2 v[246:247], v169, s[8:11], s71 offen sc1
  s_mul_i32 s42, s27, 160
  buffer_load_dwordx4 v[170:173], v28, s[16:19], 0 offen
  buffer_load_dwordx4 v[174:177], v28, s[16:19], 0 offen offset:64
  buffer_load_dwordx2 v[178:179], v29, s[16:19], 0 offen offset:128
  s_cmp_lg_u32 s24, 3
  s_cbranch_scc1 noxid_7
  s_lshl_b32 s41, s25, 8
  s_add_u32 s41, s41, 12288
  s_lshl_b32 s42, s26, 2
  v_mov_b32 v248, s42
  v_mov_b32 v249, s62
  s_mov_b64 exec, 1
  buffer_store_dword v249, v248, s[8:11], s41 offen sc1
  s_mov_b64 exec, -1
noxid_7:
  s_cmp_lg_u32 s24, 0
  s_cbranch_scc1 nopoll_8
  s_mov_b32 s50, 0
  s_mov_b64 s[94:95], 0
  s_add_u32 s42, s92, 1
  v_cmp_gt_u32 vcc, 2, v3
  v_mov_b32 v236, s40
  v_mov_b32 v237, s38
  v_cndmask_b32 v236, v237, v236, vcc
  v_add_u32 v236, v236, v36
  v_mov_b32 v237, 4096
  v_cndmask_b32 v237, v237, 0, vcc
  v_add_u32 v237, v236, v237
  s_mov_b32 s43, 3
poll_9:
  buffer_load_dword v238, v236, s[8:11], 0 offen sc1
  s_add_u32 s50, s50, 1
  s_waitcnt vmcnt(0)
  v_subrev_u32 v238, s42, v238
  v_cmp_ge_u32 vcc, 1, v238
  s_or_b64 s[94:95], s[94:95], vcc
  s_cmp_eq_u64 s[94:95], -1
  s_cbranch_scc1 nopoll_8
  s_sleep 3
  s_and_b32 s41, s50, s43
  s_cbranch_scc1 pollnext_10
  buffer_load_dword v238, v237, s[8:11], 0 offen sc1
  s_waitcnt vmcnt(0)
  v_subrev_u32 v238, s42, v238
  v_cmp_ge_u32 vcc, 1, v238
  s_or_b64 s[94:95], s[94:95], vcc
  s_cmp_eq_u64 s[94:95], -1
  s_cbranch_scc1 nopoll_8
pollnext_10:
  s_cmp_lt_u32 s50, 0x80000
  s_cbranch_scc1 poll_9
nopoll_8:
  s_barrier
  s_mov_b32 s84, 0x00003f80
  s_mov_b32 s85, 0x3f800000
  s_mov_b32 s86, 0xaaaaaaaa
  s_mov_b32 s87, 0xaaaaaaaa
  s_getpc_b64 s[96:97]
main_pc2:
  s_sub_u32 s96, s96, main_pc2-interleave_layers__linear_attn_block__dense_activation_squared_relu__prompt_kernel
  s_subb_u32 s97, s97, 0
  s_add_u32 m0, s30, 8192
  s_add_u32 s45, s31, 0
  buffer_load_dwordx4 v11, s[8:11], s45 offen lds
  buffer_load_dwordx4 v11, s[8:11], s45 offen offset:1024 lds
  s_add_u32 m0, s30, 16384
  s_add_u32 s45, s31, 8192
  buffer_load_dwordx4 v11, s[8:11], s45 offen lds
  buffer_load_dwordx4 v11, s[8:11], s45 offen offset:1024 lds
  s_add_u32 m0, s30, 24576
  s_add_u32 s45, s31, 16384
  buffer_load_dwordx4 v11, s[8:11], s45 offen lds
  buffer_load_dwordx4 v11, s[8:11], s45 offen offset:1024 lds
  s_add_u32 m0, s30, 32768
  s_add_u32 s45, s31, 24576
  buffer_load_dwordx4 v11, s[8:11], s45 offen lds
  buffer_load_dwordx4 v11, s[8:11], s45 offen offset:1024 lds
  s_add_u32 m0, s30, 40960
  s_add_u32 s45, s31, 32768
  buffer_load_dwordx4 v11, s[8:11], s45 offen lds
  buffer_load_dwordx4 v11, s[8:11], s45 offen offset:1024 lds
  s_add_u32 s46, s35, 8388608
  buffer_load_dwordx4 a[0:3], v12, s[8:11], s46 offen sc1
  buffer_load_dwordx4 a[4:7], v13, s[8:11], s46 offen sc1
  buffer_load_dwordx4 a[8:11], v12, s[8:11], s46 offen offset:1024 sc1
  buffer_load_dwordx4 a[12:15], v13, s[8:11], s46 offen offset:1024 sc1
  buffer_load_dwordx4 a[16:19], v12, s[8:11], s46 offen offset:2048 sc1
  buffer_load_dwordx4 a[20:23], v13, s[8:11], s46 offen offset:2048 sc1
  buffer_load_dwordx4 a[24:27], v12, s[8:11], s46 offen offset:3072 sc1
  buffer_load_dwordx4 a[28:31], v13, s[8:11], s46 offen offset:3072 sc1
  s_add_u32 s41, s37, 11010048
  buffer_load_dwordx2 v[200:201], v18, s[8:11], s41 offen sc1
  buffer_load_dwordx2 v[202:203], v18, s[8:11], s41 offen offset:1024 sc1
  buffer_load_dwordx2 v[204:205], v18, s[8:11], s41 offen offset:128 sc1
  buffer_load_dwordx2 v[206:207], v18, s[8:11], s41 offen offset:1152 sc1
  s_waitcnt vmcnt(18)
  s_barrier
  s_cmp_lg_u32 s24, 3
  s_cbranch_scc1 noflag_11
  s_lshl_b32 s41, s25, 2
  v_mov_b32 v237, s41
  s_add_u32 s41, s92, 2
  v_mov_b32 v238, s41
  s_mov_b64 exec, 1
  buffer_store_dword v238, v237, s[8:11], s40 offen sc1
  s_mov_b64 exec, -1
noflag_11:
  ds_read_b128 v[128:131], v5 offset:8192
  ds_read_b128 v[132:135], v5 offset:9216
  ds_read_b128 v[136:139], v5 offset:10240
  ds_read_b128 v[140:143], v5 offset:11264
  ds_read_b128 v[144:147], v5 offset:12288
  ds_read_b128 v[148:151], v5 offset:13312
  ds_read_b128 v[152:155], v5 offset:14336
  ds_read_b128 v[156:159], v5 offset:15360
  s_waitcnt vmcnt(10) lgkmcnt(6)
  v_mfma_f32_16x16x32_bf16 v[64:67], a[0:3], v[128:131], 0
  s_add_u32 s46, s35, 8392704
  buffer_load_dwordx4 a[32:35], v12, s[8:11], s46 offen sc1
  v_mfma_f32_16x16x32_bf16 v[68:71], a[4:7], v[128:131], 0
  ds_read_b128 v[128:131], v5 offset:16384
  buffer_load_dwordx4 a[36:39], v13, s[8:11], s46 offen sc1
  v_mfma_f32_16x16x32_bf16 v[72:75], a[0:3], v[132:135], 0
  s_add_u32 m0, s30, 49152
  s_add_u32 s45, s31, 40960
  v_mfma_f32_16x16x32_bf16 v[76:79], a[4:7], v[132:135], 0
  ds_read_b128 v[132:135], v5 offset:17408
  s_waitcnt lgkmcnt(6)
  v_mfma_f32_16x16x32_bf16 v[80:83], a[0:3], v[136:139], 0
  buffer_load_dwordx4 v11, s[8:11], s45 offen lds
  buffer_load_dwordx4 v11, s[8:11], s45 offen offset:1024 lds
  v_mfma_f32_16x16x32_bf16 v[84:87], a[4:7], v[136:139], 0
  ds_read_b128 v[136:139], v5 offset:18432
  buffer_load_dwordx4 a[40:43], v12, s[8:11], s46 offen offset:1024 sc1
  v_mfma_f32_16x16x32_bf16 v[88:91], a[0:3], v[140:143], 0
  buffer_load_dwordx4 a[44:47], v13, s[8:11], s46 offen offset:1024 sc1
  s_add_u32 m0, s30, 57344
  v_mfma_f32_16x16x32_bf16 v[92:95], a[4:7], v[140:143], 0
  ds_read_b128 v[140:143], v5 offset:19456
  s_waitcnt vmcnt(14) lgkmcnt(6)
  v_mfma_f32_16x16x32_bf16 v[96:99], a[0:3], v[144:147], 0
  s_add_u32 s45, s31, 49152
  buffer_load_dwordx4 v11, s[8:11], s45 offen lds
  buffer_load_dwordx4 v11, s[8:11], s45 offen offset:1024 lds
  s_barrier
  v_mfma_f32_16x16x32_bf16 v[100:103], a[4:7], v[144:147], 0
  ds_read_b128 v[144:147], v5 offset:20480
  buffer_load_dwordx4 a[48:51], v12, s[8:11], s46 offen offset:2048 sc1
  v_mfma_f32_16x16x32_bf16 v[64:67], a[8:11], v[148:151], v[64:67]
  buffer_load_dwordx4 a[52:55], v13, s[8:11], s46 offen offset:2048 sc1
  buffer_load_dwordx4 a[56:59], v12, s[8:11], s46 offen offset:3072 sc1
  v_mfma_f32_16x16x32_bf16 v[68:71], a[12:15], v[148:151], v[68:71]
  ds_read_b128 v[148:151], v5 offset:21504
  s_waitcnt lgkmcnt(6)
  v_mfma_f32_16x16x32_bf16 v[72:75], a[8:11], v[152:155], v[72:75]
  buffer_load_dwordx4 a[60:63], v13, s[8:11], s46 offen offset:3072 sc1
  s_add_u32 m0, s30, 65536
  v_mfma_f32_16x16x32_bf16 v[76:79], a[12:15], v[152:155], v[76:79]
  ds_read_b128 v[152:155], v5 offset:22528
  s_add_u32 s45, s31, 57344
  v_mfma_f32_16x16x32_bf16 v[80:83], a[8:11], v[156:159], v[80:83]
  buffer_load_dwordx4 v11, s[8:11], s45 offen lds
  buffer_load_dwordx4 v11, s[8:11], s45 offen offset:1024 lds
  v_mfma_f32_16x16x32_bf16 v[84:87], a[12:15], v[156:159], v[84:87]
  ds_read_b128 v[156:159], v5 offset:23552
  s_waitcnt lgkmcnt(6)
  v_mfma_f32_16x16x32_bf16 v[88:91], a[8:11], v[128:131], v[88:91]
  v_mfma_f32_16x16x32_bf16 v[92:95], a[12:15], v[128:131], v[92:95]
  ds_read_b128 v[128:131], v5 offset:24576
  v_mfma_f32_16x16x32_bf16 v[96:99], a[8:11], v[132:135], v[96:99]
  v_mfma_f32_16x16x32_bf16 v[100:103], a[12:15], v[132:135], v[100:103]
  ds_read_b128 v[132:135], v5 offset:25600
  s_waitcnt vmcnt(20) lgkmcnt(6)
  v_mfma_f32_16x16x32_bf16 v[64:67], a[16:19], v[136:139], v[64:67]
  s_add_u32 s46, s35, 8396800
  buffer_load_dwordx4 a[64:67], v12, s[8:11], s46 offen sc1
  v_mfma_f32_16x16x32_bf16 v[68:71], a[20:23], v[136:139], v[68:71]
  ds_read_b128 v[136:139], v5 offset:26624
  buffer_load_dwordx4 a[68:71], v13, s[8:11], s46 offen sc1
  v_mfma_f32_16x16x32_bf16 v[72:75], a[16:19], v[140:143], v[72:75]
  v_mfma_f32_16x16x32_bf16 v[76:79], a[20:23], v[140:143], v[76:79]
  ds_read_b128 v[140:143], v5 offset:27648
  s_waitcnt lgkmcnt(6)
  v_mfma_f32_16x16x32_bf16 v[80:83], a[16:19], v[144:147], v[80:83]
  v_mfma_f32_16x16x32_bf16 v[84:87], a[20:23], v[144:147], v[84:87]
  ds_read_b128 v[144:147], v5 offset:28672
  v_mfma_f32_16x16x32_bf16 v[88:91], a[16:19], v[148:151], v[88:91]
  v_mfma_f32_16x16x32_bf16 v[92:95], a[20:23], v[148:151], v[92:95]
  ds_read_b128 v[148:151], v5 offset:29696
  s_waitcnt vmcnt(20) lgkmcnt(6)
  v_mfma_f32_16x16x32_bf16 v[96:99], a[16:19], v[152:155], v[96:99]
  s_add_u32 m0, s30, 73728
  s_add_u32 s45, s31, 65536
  v_mfma_f32_16x16x32_bf16 v[100:103], a[20:23], v[152:155], v[100:103]
  ds_read_b128 v[152:155], v5 offset:30720
  buffer_load_dwordx4 v11, s[8:11], s45 offen lds
  v_mfma_f32_16x16x32_bf16 v[64:67], a[24:27], v[156:159], v[64:67]
  buffer_load_dwordx4 v11, s[8:11], s45 offen offset:1024 lds
  buffer_load_dwordx4 a[72:75], v12, s[8:11], s46 offen offset:1024 sc1
  v_mfma_f32_16x16x32_bf16 v[68:71], a[28:31], v[156:159], v[68:71]
  ds_read_b128 v[156:159], v5 offset:31744
  s_waitcnt lgkmcnt(6)
  v_mfma_f32_16x16x32_bf16 v[72:75], a[24:27], v[128:131], v[72:75]
  s_barrier
  v_mfma_f32_16x16x32_bf16 v[76:79], a[28:31], v[128:131], v[76:79]
  ds_read_b128 v[128:131], v5 offset:32768
  buffer_load_dwordx4 a[76:79], v13, s[8:11], s46 offen offset:1024 sc1
  v_mfma_f32_16x16x32_bf16 v[80:83], a[24:27], v[132:135], v[80:83]
  v_add_u32 v55, 32768, v11
  ds_read_b128 a[160:163], v55
  v_mfma_f32_16x16x32_bf16 v[84:87], a[28:31], v[132:135], v[84:87]
  ds_read_b128 v[132:135], v5 offset:33792
  s_waitcnt lgkmcnt(7)
  v_mfma_f32_16x16x32_bf16 v[88:91], a[24:27], v[136:139], v[88:91]
  ds_read_b128 a[164:167], v55 offset:1024
  v_add_u32 v55, 40960, v11
  v_mfma_f32_16x16x32_bf16 v[92:95], a[28:31], v[136:139], v[92:95]
  ds_read_b128 v[136:139], v5 offset:34816
  ds_read_b128 a[168:171], v55
  v_mfma_f32_16x16x32_bf16 v[96:99], a[24:27], v[140:143], v[96:99]
  ds_read_b128 a[172:175], v55 offset:1024
  v_mfma_f32_16x16x32_bf16 v[100:103], a[28:31], v[140:143], v[100:103]
  ds_read_b128 v[140:143], v5 offset:35840
  s_waitcnt vmcnt(18) lgkmcnt(10)
  v_mfma_f32_16x16x32_bf16 v[64:67], a[32:35], v[144:147], v[64:67]
  buffer_load_dwordx4 a[80:83], v12, s[8:11], s46 offen offset:2048 sc1
  buffer_load_dwordx4 a[84:87], v13, s[8:11], s46 offen offset:2048 sc1
  v_mfma_f32_16x16x32_bf16 v[68:71], a[36:39], v[144:147], v[68:71]
  ds_read_b128 v[144:147], v5 offset:36864
  v_mfma_f32_16x16x32_bf16 v[72:75], a[32:35], v[148:151], v[72:75]
  v_mfma_f32_16x16x32_bf16 v[76:79], a[36:39], v[148:151], v[76:79]
  ds_read_b128 v[148:151], v5 offset:37888
  s_waitcnt lgkmcnt(10)
  v_mfma_f32_16x16x32_bf16 v[80:83], a[32:35], v[152:155], v[80:83]
  s_add_u32 m0, s30, 81920
  s_add_u32 s45, s31, 73728
  v_mfma_f32_16x16x32_bf16 v[84:87], a[36:39], v[152:155], v[84:87]
  ds_read_b128 v[152:155], v5 offset:38912
  buffer_load_dwordx4 v11, s[8:11], s45 offen lds
  v_mfma_f32_16x16x32_bf16 v[88:91], a[32:35], v[156:159], v[88:91]
  buffer_load_dwordx4 v11, s[8:11], s45 offen offset:1024 lds
  v_mfma_f32_16x16x32_bf16 v[92:95], a[36:39], v[156:159], v[92:95]
  ds_read_b128 v[156:159], v5 offset:39936
  s_waitcnt vmcnt(18) lgkmcnt(9)
  v_mfma_f32_16x16x32_bf16 v[96:99], a[32:35], v[128:131], v[96:99]
  v_mfma_f32_16x16x32_bf16 v[100:103], a[36:39], v[128:131], v[100:103]
  ds_read_b128 v[128:131], v5 offset:40960
  v_mfma_f32_16x16x32_bf16 v[64:67], a[40:43], v[132:135], v[64:67]
  buffer_load_dwordx4 a[88:91], v12, s[8:11], s46 offen offset:3072 sc1
  buffer_load_dwordx4 a[92:95], v13, s[8:11], s46 offen offset:3072 sc1
  v_mfma_f32_16x16x32_bf16 v[68:71], a[44:47], v[132:135], v[68:71]
  ds_read_b128 v[132:135], v5 offset:41984
  s_waitcnt lgkmcnt(6)
  v_mfma_f32_16x16x32_bf16 v[72:75], a[40:43], v[136:139], v[72:75]
  v_mfma_f32_16x16x32_bf16 v[76:79], a[44:47], v[136:139], v[76:79]
  ds_read_b128 v[136:139], v5 offset:43008
  v_mfma_f32_16x16x32_bf16 v[80:83], a[40:43], v[140:143], v[80:83]
  v_mfma_f32_16x16x32_bf16 v[84:87], a[44:47], v[140:143], v[84:87]
  ds_read_b128 v[140:143], v5 offset:44032
  s_waitcnt lgkmcnt(6)
  v_mfma_f32_16x16x32_bf16 v[88:91], a[40:43], v[144:147], v[88:91]
  s_barrier
  v_mfma_f32_16x16x32_bf16 v[92:95], a[44:47], v[144:147], v[92:95]
  ds_read_b128 v[144:147], v5 offset:45056
  s_add_u32 s46, s35, 8400896
  v_mfma_f32_16x16x32_bf16 v[96:99], a[40:43], v[148:151], v[96:99]
  buffer_load_dwordx4 a[96:99], v12, s[8:11], s46 offen sc1
  v_add_u32 v55, 49152, v11
  v_mfma_f32_16x16x32_bf16 v[100:103], a[44:47], v[148:151], v[100:103]
  ds_read_b128 v[148:151], v5 offset:46080
  s_waitcnt vmcnt(17) lgkmcnt(6)
  v_mfma_f32_16x16x32_bf16 v[64:67], a[48:51], v[152:155], v[64:67]
  buffer_load_dwordx4 a[100:103], v13, s[8:11], s46 offen sc1
  s_add_u32 m0, s30, 90112
  v_mfma_f32_16x16x32_bf16 v[68:71], a[52:55], v[152:155], v[68:71]
  ds_read_b128 v[152:155], v5 offset:47104
  s_add_u32 s45, s31, 81920
  v_mfma_f32_16x16x32_bf16 v[72:75], a[48:51], v[156:159], v[72:75]
  buffer_load_dwordx4 v11, s[8:11], s45 offen lds
  buffer_load_dwordx4 v11, s[8:11], s45 offen offset:1024 lds
  v_mfma_f32_16x16x32_bf16 v[76:79], a[52:55], v[156:159], v[76:79]
  ds_read_b128 v[156:159], v5 offset:48128
  s_waitcnt lgkmcnt(6)
  v_mfma_f32_16x16x32_bf16 v[80:83], a[48:51], v[128:131], v[80:83]
  ds_read_b128 a[176:179], v55
  v_add_f32 v200, v200, v202
  v_mfma_f32_16x16x32_bf16 v[84:87], a[52:55], v[128:131], v[84:87]
  ds_read_b128 v[128:131], v5 offset:49152
  v_add_f32 v201, v201, v203
  v_mfma_f32_16x16x32_bf16 v[88:91], a[48:51], v[132:135], v[88:91]
  v_mov_b32 v202, v200
  v_mov_b32 v203, v201
  v_mfma_f32_16x16x32_bf16 v[92:95], a[52:55], v[132:135], v[92:95]
  ds_read_b128 v[132:135], v5 offset:50176
  s_waitcnt vmcnt(18) lgkmcnt(7)
  v_mfma_f32_16x16x32_bf16 v[96:99], a[48:51], v[136:139], v[96:99]
  buffer_load_dwordx4 a[104:107], v12, s[8:11], s46 offen offset:1024 sc1
  v_permlane32_swap_b32 v200, v202
  v_mfma_f32_16x16x32_bf16 v[100:103], a[52:55], v[136:139], v[100:103]
  ds_read_b128 v[136:139], v5 offset:51200
  v_permlane32_swap_b32 v201, v203
  v_mfma_f32_16x16x32_bf16 v[64:67], a[56:59], v[140:143], v[64:67]
  buffer_load_dwordx4 a[108:111], v13, s[8:11], s46 offen offset:1024 sc1
  v_add_f32 v200, v200, v202
  v_mfma_f32_16x16x32_bf16 v[68:71], a[60:63], v[140:143], v[68:71]
  ds_read_b128 v[140:143], v5 offset:52224
  s_waitcnt lgkmcnt(7)
  v_mfma_f32_16x16x32_bf16 v[72:75], a[56:59], v[144:147], v[72:75]
  v_add_f32 v201, v201, v203
  v_mov_b32 v202, v200
  v_mfma_f32_16x16x32_bf16 v[76:79], a[60:63], v[144:147], v[76:79]
  ds_read_b128 v[144:147], v5 offset:53248
  v_mov_b32 v203, v201
  v_mfma_f32_16x16x32_bf16 v[80:83], a[56:59], v[148:151], v[80:83]
  v_permlane16_swap_b32 v200, v202
  v_permlane16_swap_b32 v201, v203
  v_mfma_f32_16x16x32_bf16 v[84:87], a[60:63], v[148:151], v[84:87]
  ds_read_b128 v[148:151], v5 offset:54272
  s_waitcnt lgkmcnt(7)
  v_mfma_f32_16x16x32_bf16 v[88:91], a[56:59], v[152:155], v[88:91]
  s_add_u32 m0, s30, 98304
  s_add_u32 s45, s31, 90112
  v_mfma_f32_16x16x32_bf16 v[92:95], a[60:63], v[152:155], v[92:95]
  ds_read_b128 v[152:155], v5 offset:55296
  buffer_load_dwordx4 v11, s[8:11], s45 offen lds
  v_mfma_f32_16x16x32_bf16 v[96:99], a[56:59], v[156:159], v[96:99]
  buffer_load_dwordx4 v11, s[8:11], s45 offen offset:1024 lds
  v_add_f32 v200, v200, v202
  v_mfma_f32_16x16x32_bf16 v[100:103], a[60:63], v[156:159], v[100:103]
  ds_read_b128 v[156:159], v5 offset:56320
  s_waitcnt vmcnt(18) lgkmcnt(6)
  v_mfma_f32_16x16x32_bf16 v[64:67], a[64:67], v[128:131], v[64:67]
  s_barrier
  v_mfma_f32_16x16x32_bf16 v[68:71], a[68:71], v[128:131], v[68:71]
  ds_read_b128 v[128:131], v5 offset:57344
  buffer_load_dwordx4 a[112:115], v12, s[8:11], s46 offen offset:2048 sc1
  v_mfma_f32_16x16x32_bf16 v[72:75], a[64:67], v[132:135], v[72:75]
  buffer_load_dwordx4 a[116:119], v13, s[8:11], s46 offen offset:2048 sc1
  v_add_f32 v201, v201, v203
  v_mfma_f32_16x16x32_bf16 v[76:79], a[68:71], v[132:135], v[76:79]
  ds_read_b128 v[132:135], v5 offset:58368
  s_waitcnt lgkmcnt(6)
  v_mfma_f32_16x16x32_bf16 v[80:83], a[64:67], v[136:139], v[80:83]
  v_mul_f32 v200, 0x3acccccd, v200
  v_mul_f32 v202, v200, v200
  v_mfma_f32_16x16x32_bf16 v[84:87], a[68:71], v[136:139], v[84:87]
  ds_read_b128 v[136:139], v5 offset:59392
  v_fma_f32 v201, v201, s63, -v202
  v_mfma_f32_16x16x32_bf16 v[88:91], a[64:67], v[140:143], v[88:91]
  v_max_f32 v201, 0, v201
  v_add_f32 v201, 0x3727c5ac, v201
  v_mfma_f32_16x16x32_bf16 v[92:95], a[68:71], v[140:143], v[92:95]
  ds_read_b128 v[140:143], v5 offset:60416
  s_waitcnt vmcnt(16) lgkmcnt(6)
  v_mfma_f32_16x16x32_bf16 v[96:99], a[64:67], v[144:147], v[96:99]
  buffer_load_dwordx4 a[120:123], v12, s[8:11], s46 offen offset:3072 sc1
  v_rsq_f32 v202, v201
  v_mfma_f32_16x16x32_bf16 v[100:103], a[68:71], v[144:147], v[100:103]
  ds_read_b128 v[144:147], v5 offset:61440
  v_cvt_pk_bf16_f32 v40, v200, v200
  v_mfma_f32_16x16x32_bf16 v[64:67], a[72:75], v[148:151], v[64:67]
  buffer_load_dwordx4 a[124:127], v13, s[8:11], s46 offen offset:3072 sc1
  v_mul_f32 v201, v201, v202
  v_mfma_f32_16x16x32_bf16 v[68:71], a[76:79], v[148:151], v[68:71]
  ds_read_b128 v[148:151], v5 offset:62464
  s_waitcnt lgkmcnt(6)
  v_mfma_f32_16x16x32_bf16 v[72:75], a[72:75], v[152:155], v[72:75]
  s_add_u32 m0, s30, 106496
  s_add_u32 s45, s31, 98304
  v_mfma_f32_16x16x32_bf16 v[76:79], a[76:79], v[152:155], v[76:79]
  ds_read_b128 v[152:155], v5 offset:63488
  buffer_load_dwordx4 v11, s[8:11], s45 offen lds
  v_mfma_f32_16x16x32_bf16 v[80:83], a[72:75], v[156:159], v[80:83]
  buffer_load_dwordx4 v11, s[8:11], s45 offen offset:1024 lds
  ds_write_b32 v26, v202
  v_mfma_f32_16x16x32_bf16 v[84:87], a[76:79], v[156:159], v[84:87]
  ds_read_b128 v[156:159], v5 offset:64512
  s_waitcnt lgkmcnt(7)
  v_mfma_f32_16x16x32_bf16 v[88:91], a[72:75], v[128:131], v[88:91]
  v_mul_f32 v48, 0x3fb8aa3b, v202
  v_lshlrev_b32 v203, 16, v40
  v_mfma_f32_16x16x32_bf16 v[92:95], a[76:79], v[128:131], v[92:95]
  ds_read_b128 v[128:131], v6
  v_sub_f32 v200, v200, v203
  v_mfma_f32_16x16x32_bf16 v[96:99], a[72:75], v[132:135], v[96:99]
  v_cvt_pk_bf16_f32 v41, v200, v201
  v_and_b32 v203, 0xffff0000, v41
  v_mfma_f32_16x16x32_bf16 v[100:103], a[76:79], v[132:135], v[100:103]
  ds_read_b128 v[132:135], v6 offset:1024
  s_waitcnt vmcnt(18) lgkmcnt(7)
  v_mfma_f32_16x16x32_bf16 v[64:67], a[80:83], v[136:139], v[64:67]
  s_add_u32 s46, s35, 8404992
  buffer_load_dwordx4 a[128:131], v12, s[8:11], s46 offen sc1
  v_mfma_f32_16x16x32_bf16 v[68:71], a[84:87], v[136:139], v[68:71]
  ds_read_b128 v[136:139], v6 offset:2048
  buffer_load_dwordx4 a[132:135], v13, s[8:11], s46 offen sc1
  v_mfma_f32_16x16x32_bf16 v[72:75], a[80:83], v[140:143], v[72:75]
  v_sub_f32 v203, v201, v203
  v_cvt_pk_bf16_f32 v43, v200, v203
  v_mfma_f32_16x16x32_bf16 v[76:79], a[84:87], v[140:143], v[76:79]
  ds_read_b128 v[140:143], v6 offset:3072
  s_waitcnt lgkmcnt(7)
  v_mfma_f32_16x16x32_bf16 v[80:83], a[80:83], v[144:147], v[80:83]
  s_barrier
  v_mfma_f32_16x16x32_bf16 v[84:87], a[84:87], v[144:147], v[84:87]
  ds_read_b128 v[144:147], v6 offset:4096
  v_mov_b32 v42, v40
  v_mfma_f32_16x16x32_bf16 v[88:91], a[80:83], v[148:151], v[88:91]
  s_add_u32 m0, s30, 114688
  s_add_u32 s45, s31, 106496
  v_mfma_f32_16x16x32_bf16 v[92:95], a[84:87], v[148:151], v[92:95]
  ds_read_b128 v[148:151], v6 offset:5120
  s_waitcnt vmcnt(16) lgkmcnt(6)
  v_mfma_f32_16x16x32_bf16 v[96:99], a[80:83], v[152:155], v[96:99]
  buffer_load_dwordx4 v11, s[8:11], s45 offen lds
  buffer_load_dwordx4 v11, s[8:11], s45 offen offset:1024 lds
  v_mfma_f32_16x16x32_bf16 v[100:103], a[84:87], v[152:155], v[100:103]
  ds_read_b128 v[152:155], v6 offset:6144
  v_add_f32 v204, v204, v206
  v_mfma_f32_16x16x32_bf16 v[64:67], a[88:91], v[156:159], v[64:67]
  buffer_load_dwordx4 a[136:139], v12, s[8:11], s46 offen offset:1024 sc1
  buffer_load_dwordx4 a[140:143], v13, s[8:11], s46 offen offset:1024 sc1
  v_mfma_f32_16x16x32_bf16 v[68:71], a[92:95], v[156:159], v[68:71]
  ds_read_b128 v[156:159], v6 offset:7168
  s_waitcnt lgkmcnt(6)
  v_mfma_f32_16x16x32_bf16 v[72:75], a[88:91], v[128:131], v[72:75]
  v_add_f32 v205, v205, v207
  v_mov_b32 v206, v204
  v_mfma_f32_16x16x32_bf16 v[76:79], a[92:95], v[128:131], v[76:79]
  ds_read_b128 v[128:131], v6 offset:8192
  v_mov_b32 v207, v205
  v_mfma_f32_16x16x32_bf16 v[80:83], a[88:91], v[132:135], v[80:83]
  v_permlane32_swap_b32 v204, v206
  v_permlane32_swap_b32 v205, v207
  v_mfma_f32_16x16x32_bf16 v[84:87], a[92:95], v[132:135], v[84:87]
  ds_read_b128 v[132:135], v6 offset:9216
  s_waitcnt lgkmcnt(6)
  v_mfma_f32_16x16x32_bf16 v[88:91], a[88:91], v[136:139], v[88:91]
  buffer_load_dwordx4 a[144:147], v12, s[8:11], s46 offen offset:2048 sc1
  v_add_f32 v204, v204, v206
  v_mfma_f32_16x16x32_bf16 v[92:95], a[92:95], v[136:139], v[92:95]
  ds_read_b128 v[136:139], v6 offset:10240
  v_add_f32 v205, v205, v207
  v_mfma_f32_16x16x32_bf16 v[96:99], a[88:91], v[140:143], v[96:99]
  v_mov_b32 v206, v204
  v_mov_b32 v207, v205
  v_mfma_f32_16x16x32_bf16 v[100:103], a[92:95], v[140:143], v[100:103]
  ds_read_b128 v[140:143], v6 offset:11264
  s_waitcnt vmcnt(19) lgkmcnt(6)
  v_mfma_f32_16x16x32_bf16 v[64:67], a[96:99], v[144:147], v[64:67]
  buffer_load_dwordx4 a[148:151], v13, s[8:11], s46 offen offset:2048 sc1
  v_permlane16_swap_b32 v204, v206
  v_mfma_f32_16x16x32_bf16 v[68:71], a[100:103], v[144:147], v[68:71]
  ds_read_b128 v[144:147], v6 offset:12288
  v_permlane16_swap_b32 v205, v207
  v_mfma_f32_16x16x32_bf16 v[72:75], a[96:99], v[148:151], v[72:75]
  v_add_f32 v204, v204, v206
  v_add_f32 v205, v205, v207
  v_mfma_f32_16x16x32_bf16 v[76:79], a[100:103], v[148:151], v[76:79]
  ds_read_b128 v[148:151], v6 offset:13312
  s_waitcnt lgkmcnt(6)
  v_mfma_f32_16x16x32_bf16 v[80:83], a[96:99], v[152:155], v[80:83]
  s_add_u32 m0, s30, 122880
  s_add_u32 s45, s31, 114688
  v_mfma_f32_16x16x32_bf16 v[84:87], a[100:103], v[152:155], v[84:87]
  ds_read_b128 v[152:155], v6 offset:14336
  buffer_load_dwordx4 v11, s[8:11], s45 offen lds
  v_mfma_f32_16x16x32_bf16 v[88:91], a[96:99], v[156:159], v[88:91]
  buffer_load_dwordx4 v11, s[8:11], s45 offen offset:1024 lds
  v_mul_f32 v204, 0x3acccccd, v204
  v_mfma_f32_16x16x32_bf16 v[92:95], a[100:103], v[156:159], v[92:95]
  ds_read_b128 v[156:159], v6 offset:15360
  s_waitcnt vmcnt(18) lgkmcnt(6)
  v_mfma_f32_16x16x32_bf16 v[96:99], a[96:99], v[128:131], v[96:99]
  s_barrier
  v_mfma_f32_16x16x32_bf16 v[100:103], a[100:103], v[128:131], v[100:103]
  ds_read_b128 v[128:131], v6 offset:16384
  v_mul_f32 v206, v204, v204
  v_mfma_f32_16x16x32_bf16 v[64:67], a[104:107], v[132:135], v[64:67]
  buffer_load_dwordx4 a[152:155], v12, s[8:11], s46 offen offset:3072 sc1
  buffer_load_dwordx4 a[156:159], v13, s[8:11], s46 offen offset:3072 sc1
  v_mfma_f32_16x16x32_bf16 v[68:71], a[108:111], v[132:135], v[68:71]
  ds_read_b128 v[132:135], v6 offset:17408
  s_waitcnt lgkmcnt(6)
  v_mfma_f32_16x16x32_bf16 v[72:75], a[104:107], v[136:139], v[72:75]
  v_fma_f32 v205, v205, s63, -v206
  v_max_f32 v205, 0, v205
  v_mfma_f32_16x16x32_bf16 v[76:79], a[108:111], v[136:139], v[76:79]
  ds_read_b128 v[136:139], v6 offset:18432
  v_add_f32 v205, 0x3727c5ac, v205
  v_mfma_f32_16x16x32_bf16 v[80:83], a[104:107], v[140:143], v[80:83]
  v_rsq_f32 v206, v205
  v_cvt_pk_bf16_f32 v44, v204, v204
  v_mfma_f32_16x16x32_bf16 v[84:87], a[108:111], v[140:143], v[84:87]
  ds_read_b128 v[140:143], v6 offset:19456
  s_waitcnt lgkmcnt(6)
  v_mfma_f32_16x16x32_bf16 v[88:91], a[104:107], v[144:147], v[88:91]
  s_add_u32 m0, s30, 131072
  s_add_u32 s45, s31, 122880
  v_mfma_f32_16x16x32_bf16 v[92:95], a[108:111], v[144:147], v[92:95]
  ds_read_b128 v[144:147], v6 offset:20480
  buffer_load_dwordx4 v11, s[8:11], s45 offen lds
  v_mfma_f32_16x16x32_bf16 v[96:99], a[104:107], v[148:151], v[96:99]
here_12:
  v_add_u32 v51, here_12-interleave_layers__linear_attn_block__dense_activation_squared_relu__prompt_kernel+1024, v38
  v_min_u32 v51, 57340, v51
  global_load_dword v49, v51, s[96:97]
  v_mfma_f32_16x16x32_bf16 v[100:103], a[108:111], v[148:151], v[100:103]
  ds_read_b128 v[148:151], v6 offset:21504
  s_waitcnt vmcnt(18) lgkmcnt(6)
  v_mfma_f32_16x16x32_bf16 v[64:67], a[112:115], v[152:155], v[64:67]
  buffer_load_dwordx4 v11, s[8:11], s45 offen offset:1024 lds
  v_mul_f32 v205, v205, v206
  v_mfma_f32_16x16x32_bf16 v[68:71], a[116:119], v[152:155], v[68:71]
  ds_read_b128 v[152:155], v6 offset:22528
  ds_write_b32 v26, v206 offset:64
  v_mfma_f32_16x16x32_bf16 v[72:75], a[112:115], v[156:159], v[72:75]
  v_mul_f32 v50, 0x3fb8aa3b, v206
  v_lshlrev_b32 v207, 16, v44
  v_mfma_f32_16x16x32_bf16 v[76:79], a[116:119], v[156:159], v[76:79]
  ds_read_b128 v[156:159], v6 offset:23552
  s_waitcnt lgkmcnt(7)
  v_mfma_f32_16x16x32_bf16 v[80:83], a[112:115], v[128:131], v[80:83]
  v_sub_f32 v204, v204, v207
  v_cvt_pk_bf16_f32 v45, v204, v205
  v_mfma_f32_16x16x32_bf16 v[84:87], a[116:119], v[128:131], v[84:87]
  ds_read_b128 v[128:131], v6 offset:24576
  s_add_u32 m0, s30, 139264
  v_mfma_f32_16x16x32_bf16 v[88:91], a[112:115], v[132:135], v[88:91]
  s_add_u32 s45, s31, 131072
  buffer_load_dwordx4 v11, s[8:11], s45 offen lds
  v_mfma_f32_16x16x32_bf16 v[92:95], a[116:119], v[132:135], v[92:95]
  ds_read_b128 v[132:135], v6 offset:25600
  s_waitcnt vmcnt(18) lgkmcnt(7)
  v_mfma_f32_16x16x32_bf16 v[96:99], a[112:115], v[136:139], v[96:99]
  v_and_b32 v207, 0xffff0000, v45
  v_sub_f32 v207, v205, v207
  v_mfma_f32_16x16x32_bf16 v[100:103], a[116:119], v[136:139], v[100:103]
  ds_read_b128 v[136:139], v6 offset:26624
  v_cvt_pk_bf16_f32 v47, v204, v207
  v_mfma_f32_16x16x32_bf16 v[64:67], a[120:123], v[140:143], v[64:67]
  v_mov_b32 v46, v44
  buffer_load_dwordx4 v11, s[8:11], s45 offen offset:1024 lds
  v_mfma_f32_16x16x32_bf16 v[68:71], a[124:127], v[140:143], v[68:71]
  ds_read_b128 v[140:143], v6 offset:27648
  s_waitcnt lgkmcnt(7)
  v_mfma_f32_16x16x32_bf16 v[72:75], a[120:123], v[144:147], v[72:75]
  s_barrier
  v_mfma_f32_16x16x32_bf16 v[76:79], a[124:127], v[144:147], v[76:79]
  ds_read_b128 v[144:147], v6 offset:28672
  ds_read_b128 v[56:59], v25
  v_mfma_f32_16x16x32_bf16 v[80:83], a[120:123], v[148:151], v[80:83]
  ds_read_b128 v[60:63], v25 offset:64
  s_add_u32 m0, s30, 147456
  v_mfma_f32_16x16x32_bf16 v[84:87], a[124:127], v[148:151], v[84:87]
  ds_read_b128 v[148:151], v6 offset:29696
  s_waitcnt lgkmcnt(8)
  v_mfma_f32_16x16x32_bf16 v[88:91], a[120:123], v[152:155], v[88:91]
  s_add_u32 s45, s31, 139264
  buffer_load_dwordx4 v11, s[8:11], s45 offen lds
  v_mfma_f32_16x16x32_bf16 v[92:95], a[124:127], v[152:155], v[92:95]
  ds_read_b128 v[152:155], v6 offset:30720
  v_bfe_u32 v160, v1, 4, 1
  v_mfma_f32_16x16x32_bf16 v[96:99], a[120:123], v[156:159], v[96:99]
  v_lshl_add_u32 v160, v160, 11, v36
  s_lshl_b32 s4, s27, 8
  v_mfma_f32_16x16x32_bf16 v[100:103], a[124:127], v[156:159], v[100:103]
  ds_read_b128 v[156:159], v6 offset:31744
  s_waitcnt vmcnt(16) lgkmcnt(8)
  v_mfma_f32_16x16x32_bf16 v[64:67], a[128:131], v[128:131], v[64:67]
  buffer_load_dwordx4 v11, s[8:11], s45 offen offset:1024 lds
  s_add_u32 s4, s4, 8192
  v_mfma_f32_16x16x32_bf16 v[68:71], a[132:135], v[128:131], v[68:71]
  ds_read_b128 v[128:131], v6 offset:32768
  buffer_load_dword v161, v160, s[8:11], s4 offen sc1
  v_mfma_f32_16x16x32_bf16 v[72:75], a[128:131], v[132:135], v[72:75]
  ds_read_b128 a[180:183], v55 offset:1024
  v_add_u32 v55, 57344, v11
  v_mfma_f32_16x16x32_bf16 v[76:79], a[132:135], v[132:135], v[76:79]
  ds_read_b128 v[132:135], v6 offset:33792
  s_waitcnt lgkmcnt(9)
  v_mfma_f32_16x16x32_bf16 v[80:83], a[128:131], v[136:139], v[80:83]
  ds_read_b128 a[184:187], v55
  ds_read_b128 a[188:191], v55 offset:1024
  v_mfma_f32_16x16x32_bf16 v[84:87], a[132:135], v[136:139], v[84:87]
  ds_read_b128 v[136:139], v6 offset:34816
  v_add_u32 v55, 65536, v11
  v_mfma_f32_16x16x32_bf16 v[88:91], a[128:131], v[140:143], v[88:91]
  ds_read_b128 a[192:195], v55
  s_add_u32 m0, s30, 155648
  v_mfma_f32_16x16x32_bf16 v[92:95], a[132:135], v[140:143], v[92:95]
  ds_read_b128 v[140:143], v6 offset:35840
  s_waitcnt vmcnt(14) lgkmcnt(10)
  v_mfma_f32_16x16x32_bf16 v[96:99], a[128:131], v[144:147], v[96:99]
  s_add_u32 s45, s31, 147456
  buffer_load_dwordx4 v11, s[8:11], s45 offen lds
  v_mfma_f32_16x16x32_bf16 v[100:103], a[132:135], v[144:147], v[100:103]
  ds_read_b128 v[144:147], v6 offset:36864
  ds_read_b128 a[196:199], v55 offset:1024
  v_mfma_f32_16x16x32_bf16 v[64:67], a[136:139], v[148:151], v[64:67]
  v_add_u32 v55, 73728, v11
  ds_read_b128 a[200:203], v55
  v_mfma_f32_16x16x32_bf16 v[68:71], a[140:143], v[148:151], v[68:71]
  ds_read_b128 v[148:151], v6 offset:37888
  s_waitcnt lgkmcnt(12)
  v_mfma_f32_16x16x32_bf16 v[72:75], a[136:139], v[152:155], v[72:75]
  buffer_load_dwordx4 v11, s[8:11], s45 offen offset:1024 lds
  ds_read_b128 a[204:207], v55 offset:1024
  v_mfma_f32_16x16x32_bf16 v[76:79], a[140:143], v[152:155], v[76:79]
  ds_read_b128 v[152:155], v6 offset:38912
  v_add_u32 v55, 81920, v11
  v_mfma_f32_16x16x32_bf16 v[80:83], a[136:139], v[156:159], v[80:83]
  ds_read_b128 a[208:211], v55
  ds_read_b128 a[212:215], v55 offset:1024
  v_mfma_f32_16x16x32_bf16 v[84:87], a[140:143], v[156:159], v[84:87]
  ds_read_b128 v[156:159], v6 offset:39936
  s_waitcnt lgkmcnt(14)
  v_mfma_f32_16x16x32_bf16 v[88:91], a[136:139], v[128:131], v[88:91]
  s_waitcnt lgkmcnt(1)
  s_barrier
  v_mfma_f32_16x16x32_bf16 v[92:95], a[140:143], v[128:131], v[92:95]
  ds_read_b128 v[128:131], v6 offset:40960
  s_add_u32 m0, s30, 8192
  v_mfma_f32_16x16x32_bf16 v[96:99], a[136:139], v[132:135], v[96:99]
  s_add_u32 s45, s31, 155648
  buffer_load_dwordx4 v11, s[8:11], s45 offen lds
  v_mfma_f32_16x16x32_bf16 v[100:103], a[140:143], v[132:135], v[100:103]
  ds_read_b128 v[132:135], v6 offset:41984
  s_waitcnt vmcnt(15)
  v_mfma_f32_16x16x32_bf16 v[64:67], a[144:147], v[136:139], v[64:67]
  buffer_load_dwordx4 v11, s[8:11], s45 offen offset:1024 lds
  v_add_u32 v55, 90112, v11
  v_mfma_f32_16x16x32_bf16 v[68:71], a[148:151], v[136:139], v[68:71]
  ds_read_b128 v[136:139], v6 offset:43008
  ds_read_b128 a[216:219], v55
  v_mfma_f32_16x16x32_bf16 v[72:75], a[144:147], v[140:143], v[72:75]
  s_add_u32 m0, s30, 16384
  s_add_u32 s45, s31, 163840
  v_mfma_f32_16x16x32_bf16 v[76:79], a[148:151], v[140:143], v[76:79]
  ds_read_b128 v[140:143], v6 offset:44032
  buffer_load_dwordx4 v11, s[8:11], s45 offen lds
  v_mfma_f32_16x16x32_bf16 v[80:83], a[144:147], v[144:147], v[80:83]
  ds_read_b128 a[220:223], v55 offset:1024
  v_add_u32 v55, 98304, v11
  v_mfma_f32_16x16x32_bf16 v[84:87], a[148:151], v[144:147], v[84:87]
  ds_read_b128 v[144:147], v6 offset:45056
  buffer_load_dwordx4 v11, s[8:11], s45 offen offset:1024 lds
  v_mfma_f32_16x16x32_bf16 v[88:91], a[144:147], v[148:151], v[88:91]
  ds_read_b128 a[224:227], v55
  ds_read_b128 a[228:231], v55 offset:1024
  v_mfma_f32_16x16x32_bf16 v[92:95], a[148:151], v[148:151], v[92:95]
  ds_read_b128 v[148:151], v6 offset:46080
  s_waitcnt vmcnt(14) lgkmcnt(10)
  v_mfma_f32_16x16x32_bf16 v[96:99], a[144:147], v[152:155], v[96:99]
  v_add_u32 v55, 106496, v11
  ds_read_b128 a[232:235], v55
  v_mfma_f32_16x16x32_bf16 v[100:103], a[148:151], v[152:155], v[100:103]
  ds_read_b128 v[152:155], v6 offset:47104
  ds_read_b128 a[236:239], v55 offset:1024
  v_mfma_f32_16x16x32_bf16 v[64:67], a[152:155], v[156:159], v[64:67]
  v_add_u32 v55, 114688, v11
  ds_read_b128 a[240:243], v55
  v_mfma_f32_16x16x32_bf16 v[68:71], a[156:159], v[156:159], v[68:71]
  ds_read_b128 v[156:159], v6 offset:48128
  s_waitcnt lgkmcnt(13)
  v_mfma_f32_16x16x32_bf16 v[72:75], a[152:155], v[128:131], v[72:75]
  ds_read_b128 a[244:247], v55 offset:1024
  s_mul_i32 s7, s24, 7168
  v_mfma_f32_16x16x32_bf16 v[76:79], a[156:159], v[128:131], v[76:79]
  ds_read_b128 v[128:131], v6 offset:49152
  s_add_u32 s7, s7, 83968
  v_mfma_f32_16x16x32_bf16 v[80:83], a[152:155], v[132:135], v[80:83]
  v_add_u32 v224, s7, v4
  v_add_u32 v225, 83968, v20
  v_mfma_f32_16x16x32_bf16 v[84:87], a[156:159], v[132:135], v[84:87]
  ds_read_b128 v[132:135], v6 offset:50176
  s_waitcnt lgkmcnt(13)
  s_mul_i32 s7, s25, 1792
  s_add_u32 s7, s7, s61
  s_add_u32 s7, s7, 20840448
  v_mul_f32 v104, 0x3fb8aa3b, v56
  v_mul_f32 v105, 0x3fb8aa3b, v57
  v_mul_f32 v106, 0x3fb8aa3b, v58
  v_mul_f32 v107, 0x3fb8aa3b, v59
  v_mul_f32 v108, 0x3fb8aa3b, v60
  v_mul_f32 v109, 0x3fb8aa3b, v61
  v_mul_f32 v110, 0x3fb8aa3b, v62
  v_mul_f32 v111, 0x3fb8aa3b, v63
  v_mfma_f32_16x16x32_bf16 v[88:91], a[152:155], v[136:139], v[88:91]
  v_mfma_f32_16x16x32_bf16 v[92:95], a[156:159], v[136:139], v[92:95]
  ds_read_b128 v[136:139], v6 offset:51200
  v_mfma_f32_16x16x32_bf16 v[96:99], a[152:155], v[140:143], v[96:99]
  v_mfma_f32_16x16x32_bf16 v[100:103], a[156:159], v[140:143], v[100:103]
  ds_read_b128 v[140:143], v6 offset:52224
  s_waitcnt lgkmcnt(10)
  v_mfma_f32_16x16x32_bf16 v[64:67], v[40:43], v[144:147], v[64:67]
  s_waitcnt lgkmcnt(4)
  s_barrier
  v_mfma_f32_16x16x32_bf16 v[68:71], v[44:47], v[144:147], v[68:71]
  ds_read_b128 v[144:147], v6 offset:53248
  v_add_u32 v55, 122880, v11
  v_mfma_f32_16x16x32_bf16 v[72:75], v[40:43], v[148:151], v[72:75]
  ds_read_b128 a[248:251], v55
  ds_read_b128 a[252:255], v55 offset:1024
  v_mfma_f32_16x16x32_bf16 v[76:79], v[44:47], v[148:151], v[76:79]
  ds_read_b128 v[148:151], v6 offset:54272
  v_mfma_f32_16x16x32_bf16 v[80:83], v[40:43], v[152:155], v[80:83]
  s_waitcnt vmcnt(11) lgkmcnt(1)
  s_barrier
  v_mfma_f32_16x16x32_bf16 v[84:87], v[44:47], v[152:155], v[84:87]
  ds_read_b128 v[152:155], v6 offset:55296
  v_mfma_f32_16x16x32_bf16 v[88:91], v[40:43], v[156:159], v[88:91]
  v_mfma_f32_16x16x32_bf16 v[92:95], v[44:47], v[156:159], v[92:95]
  ds_read_b128 v[156:159], v6 offset:56320
  v_mfma_f32_16x16x32_bf16 v[96:99], v[40:43], v[128:131], v[96:99]
  v_mfma_f32_16x16x32_bf16 v[100:103], v[44:47], v[128:131], v[100:103]
  ds_read_b128 v[128:131], v6 offset:57344
  s_add_u32 s5, s92, 2
  s_waitcnt vmcnt(6)
  v_cmp_ne_u32 vcc, s5, v161
  s_cmp_eq_u64 vcc, 0
  s_cbranch_scc1 w2ok_13
  s_mov_b32 s50, 0
w2retry_14:
  s_sleep 4
  buffer_load_dword v161, v160, s[8:11], s4 offen sc1
  s_waitcnt vmcnt(0)
  v_cmp_ne_u32 vcc, s5, v161
  s_cmp_eq_u64 vcc, 0
  s_cbranch_scc1 w2ok_13
  s_add_u32 s50, s50, 1
  s_cmp_lt_u32 s50, 131072
  s_cbranch_scc1 w2retry_14
w2ok_13:
  v_pk_mul_f32 v[112:113], v[64:65], v[104:105]
  s_add_u32 m0, s30, 24576
  s_add_u32 s45, s32, 0
  buffer_load_dwordx4 v11, s[8:11], s45 offen lds
  v_exp_f32_e64 v114, v112 clamp
  v_exp_f32_e64 v115, v113 clamp
  v_max_f32 v112, 0, v112
  v_max_f32 v113, 0, v113
  buffer_load_dwordx4 v11, s[8:11], s45 offen offset:1024 lds
  v_pk_add_f32 v[114:115], v[114:115], v[54:55] op_sel_hi:[1,0]
  v_pk_fma_f32 v[112:113], v[112:113], v[52:53], v[114:115] op_sel_hi:[1,0,1]
  v_cvt_pk_bf16_f32 v208, v112, v113
  v_pk_mul_f32 v[116:117], v[66:67], v[106:107]
  v_exp_f32_e64 v118, v116 clamp
  s_add_u32 m0, s30, 32768
  s_add_u32 s45, s32, 8192
  buffer_load_dwordx4 v11, s[8:11], s45 offen lds
  v_exp_f32_e64 v119, v117 clamp
  v_max_f32 v116, 0, v116
  v_max_f32 v117, 0, v117
  v_pk_add_f32 v[118:119], v[118:119], v[54:55] op_sel_hi:[1,0]
  v_pk_fma_f32 v[116:117], v[116:117], v[52:53], v[118:119] op_sel_hi:[1,0,1]
  buffer_load_dwordx4 v11, s[8:11], s45 offen offset:1024 lds
  v_cvt_pk_bf16_f32 v209, v116, v117
  v_pk_mul_f32 v[112:113], v[68:69], v[108:109]
  v_exp_f32_e64 v114, v112 clamp
  v_exp_f32_e64 v115, v113 clamp
  s_add_u32 m0, s30, 40960
  s_add_u32 s45, s32, 16384
  buffer_load_dwordx4 v11, s[8:11], s45 offen lds
  v_max_f32 v112, 0, v112
  v_max_f32 v113, 0, v113
  v_pk_add_f32 v[114:115], v[114:115], v[54:55] op_sel_hi:[1,0]
  v_pk_fma_f32 v[112:113], v[112:113], v[52:53], v[114:115] op_sel_hi:[1,0,1]
  v_cvt_pk_bf16_f32 v210, v112, v113
  v_pk_mul_f32 v[116:117], v[70:71], v[110:111]
  buffer_load_dwordx4 v11, s[8:11], s45 offen offset:1024 lds
  v_exp_f32_e64 v118, v116 clamp
  v_exp_f32_e64 v119, v117 clamp
  v_max_f32 v116, 0, v116
  v_max_f32 v117, 0, v117
  s_add_u32 m0, s30, 49152
  s_add_u32 s45, s32, 24576
  buffer_load_dwordx4 v11, s[8:11], s45 offen lds
  v_pk_add_f32 v[118:119], v[118:119], v[54:55] op_sel_hi:[1,0]
  v_pk_fma_f32 v[116:117], v[116:117], v[52:53], v[118:119] op_sel_hi:[1,0,1]
  v_cvt_pk_bf16_f32 v211, v116, v117
  v_pk_mul_f32 v[112:113], v[72:73], v[104:105]
  v_exp_f32_e64 v114, v112 clamp
  buffer_load_dwordx4 v11, s[8:11], s45 offen offset:1024 lds
  v_exp_f32_e64 v115, v113 clamp
  v_max_f32 v112, 0, v112
  v_max_f32 v113, 0, v113
  v_pk_add_f32 v[114:115], v[114:115], v[54:55] op_sel_hi:[1,0]
  v_pk_fma_f32 v[112:113], v[112:113], v[52:53], v[114:115] op_sel_hi:[1,0,1]
  s_add_u32 m0, s30, 57344
  s_add_u32 s45, s32, 32768
  buffer_load_dwordx4 v11, s[8:11], s45 offen lds
  v_cvt_pk_bf16_f32 v212, v112, v113
  v_pk_mul_f32 v[116:117], v[74:75], v[106:107]
  v_exp_f32_e64 v118, v116 clamp
  v_exp_f32_e64 v119, v117 clamp
  v_max_f32 v116, 0, v116
  v_max_f32 v117, 0, v117
  v_pk_add_f32 v[118:119], v[118:119], v[54:55] op_sel_hi:[1,0]
  v_pk_fma_f32 v[116:117], v[116:117], v[52:53], v[118:119] op_sel_hi:[1,0,1]
  v_cvt_pk_bf16_f32 v213, v116, v117
  v_pk_mul_f32 v[112:113], v[76:77], v[108:109]
  v_exp_f32_e64 v114, v112 clamp
  v_exp_f32_e64 v115, v113 clamp
  v_max_f32 v112, 0, v112
  v_max_f32 v113, 0, v113
  v_pk_add_f32 v[114:115], v[114:115], v[54:55] op_sel_hi:[1,0]
  v_pk_fma_f32 v[112:113], v[112:113], v[52:53], v[114:115] op_sel_hi:[1,0,1]
  v_cvt_pk_bf16_f32 v214, v112, v113
  v_pk_mul_f32 v[116:117], v[78:79], v[110:111]
  v_exp_f32_e64 v118, v116 clamp
  v_exp_f32_e64 v119, v117 clamp
  v_max_f32 v116, 0, v116
  v_max_f32 v117, 0, v117
  v_pk_add_f32 v[118:119], v[118:119], v[54:55] op_sel_hi:[1,0]
  v_pk_fma_f32 v[116:117], v[116:117], v[52:53], v[118:119] op_sel_hi:[1,0,1]
  v_cvt_pk_bf16_f32 v215, v116, v117
  buffer_load_dwordx4 v11, s[8:11], s45 offen offset:1024 lds
  v_pk_mul_f32 v[112:113], v[80:81], v[104:105]
  v_exp_f32_e64 v114, v112 clamp
  v_exp_f32_e64 v115, v113 clamp
  v_max_f32 v112, 0, v112
  v_max_f32 v113, 0, v113
  v_pk_add_f32 v[114:115], v[114:115], v[54:55] op_sel_hi:[1,0]
  v_pk_fma_f32 v[112:113], v[112:113], v[52:53], v[114:115] op_sel_hi:[1,0,1]
  v_cvt_pk_bf16_f32 v216, v112, v113
  v_pk_mul_f32 v[116:117], v[82:83], v[106:107]
  v_exp_f32_e64 v118, v116 clamp
  v_exp_f32_e64 v119, v117 clamp
  v_max_f32 v116, 0, v116
  v_max_f32 v117, 0, v117
  v_pk_add_f32 v[118:119], v[118:119], v[54:55] op_sel_hi:[1,0]
  v_pk_fma_f32 v[116:117], v[116:117], v[52:53], v[118:119] op_sel_hi:[1,0,1]
  v_cvt_pk_bf16_f32 v217, v116, v117
  v_pk_mul_f32 v[112:113], v[84:85], v[108:109]
  v_exp_f32_e64 v114, v112 clamp
  v_exp_f32_e64 v115, v113 clamp
  v_max_f32 v112, 0, v112
  v_max_f32 v113, 0, v113
  v_pk_add_f32 v[114:115], v[114:115], v[54:55] op_sel_hi:[1,0]
  v_pk_fma_f32 v[112:113], v[112:113], v[52:53], v[114:115] op_sel_hi:[1,0,1]
  v_cvt_pk_bf16_f32 v218, v112, v113
  v_pk_mul_f32 v[116:117], v[86:87], v[110:111]
  v_exp_f32_e64 v118, v116 clamp
  s_add_u32 m0, s30, 65536
  s_add_u32 s45, s32, 40960
  buffer_load_dwordx4 v11, s[8:11], s45 offen lds
  v_exp_f32_e64 v119, v117 clamp
  v_max_f32 v116, 0, v116
  v_max_f32 v117, 0, v117
  v_pk_add_f32 v[118:119], v[118:119], v[54:55] op_sel_hi:[1,0]
  v_pk_fma_f32 v[116:117], v[116:117], v[52:53], v[118:119] op_sel_hi:[1,0,1]
  v_cvt_pk_bf16_f32 v219, v116, v117
  v_pk_mul_f32 v[88:89], v[88:89], v[56:57]
  v_pk_mul_f32 v[90:91], v[90:91], v[58:59]
  v_pk_mul_f32 v[92:93], v[92:93], v[60:61]
  v_pk_mul_f32 v[94:95], v[94:95], v[62:63]
  v_cvt_pk_bf16_f32 v220, v88, v89
  v_cvt_pk_bf16_f32 v221, v90, v91
  v_cvt_pk_bf16_f32 v222, v92, v93
  v_cvt_pk_bf16_f32 v223, v94, v95
  v_pk_mul_f32 v[96:97], v[96:97], v[56:57]
  v_pk_mul_f32 v[98:99], v[98:99], v[58:59]
  v_pk_mul_f32 v[100:101], v[100:101], v[60:61]
  v_pk_mul_f32 v[102:103], v[102:103], v[62:63]
  v_cvt_pk_bf16_f32 v120, v96, v97
  v_cvt_pk_bf16_f32 v121, v98, v99
  v_cvt_pk_bf16_f32 v122, v100, v101
  v_cvt_pk_bf16_f32 v123, v102, v103
  v_pk_mul_f32 v[80:81], v[80:81], v[56:57]
  v_pk_mul_f32 v[82:83], v[82:83], v[58:59]
  v_pk_mul_f32 v[84:85], v[84:85], v[60:61]
  v_pk_mul_f32 v[86:87], v[86:87], v[62:63]
  v_cvt_pk_bf16_f32 v124, v80, v81
  buffer_load_dwordx4 v11, s[8:11], s45 offen offset:1024 lds
  v_cvt_pk_bf16_f32 v125, v82, v83
  v_cvt_pk_bf16_f32 v126, v84, v85
  v_cvt_pk_bf16_f32 v127, v86, v87
  v_cndmask_b32 v124, v124, v30, s[48:49]
  v_cndmask_b32 v125, v125, v30, s[48:49]
  v_cndmask_b32 v126, v126, v30, s[48:49]
  v_cndmask_b32 v127, v127, v30, s[48:49]
  v_mfma_f32_16x16x32_bf16 v[64:67], v[208:211], v[220:223], 0
  s_nop 0
  v_mfma_f32_16x16x32_bf16 v[68:71], v[208:211], v[124:127], 0
  v_mfma_f32_16x16x32_bf16 v[72:75], v[212:215], v[120:123], 0
  v_mfma_f32_16x16x32_bf16 v[76:79], v[212:215], v[124:127], 0
  v_mfma_f32_16x16x32_bf16 v[80:83], v[216:219], v[220:223], 0
  v_mfma_f32_16x16x32_bf16 v[84:87], v[216:219], v[120:123], 0
  v_mfma_f32_16x16x32_bf16 v[88:91], v[216:219], v[124:127], 0
  s_nop 0
  ds_write_b128 v224, v[64:67]
  s_nop 0
  ds_write_b128 v224, v[68:71] offset:1024
  ds_write_b128 v224, v[72:75] offset:2048
  ds_write_b128 v224, v[76:79] offset:3072
  ds_write_b128 v224, v[80:83] offset:4096
  ds_write_b128 v224, v[84:87] offset:5120
  ds_write_b128 v224, v[88:91] offset:6144
  s_waitcnt lgkmcnt(0)
  s_barrier
  ds_read_b128 v[64:67], v225
  ds_read_b128 v[68:71], v225 offset:7168
  ds_read_b128 v[72:75], v225 offset:14336
  ds_read_b128 v[76:79], v225 offset:21504
  s_waitcnt lgkmcnt(2)
  v_pk_add_f32 v[64:65], v[64:65], v[68:69]
  s_add_u32 m0, s30, 73728
  s_add_u32 s45, s32, 49152
  buffer_load_dwordx4 v11, s[8:11], s45 offen lds
  s_waitcnt lgkmcnt(0)
  v_pk_add_f32 v[72:73], v[72:73], v[76:77]
  v_pk_add_f32 v[66:67], v[66:67], v[70:71]
  v_pk_add_f32 v[74:75], v[74:75], v[78:79]
  v_pk_add_f32 v[64:65], v[64:65], v[72:73]
  buffer_load_dwordx4 v11, s[8:11], s45 offen offset:1024 lds
  v_pk_add_f32 v[66:67], v[66:67], v[74:75]
  v_cvt_pk_bf16_f32 v68, v64, v65
  v_cvt_pk_bf16_f32 v69, v66, v67
  buffer_store_dwordx2 v[68:69], v22, s[8:11], s7 offen sc1
  v_mfma_f32_16x16x32_bf16 v[104:107], v[132:135], a[0:3], 0
  s_lshl_b32 s6, s25, 8
  s_add_u32 s6, s6, 12288
  v_mfma_f32_16x16x32_bf16 v[108:111], v[132:135], a[4:7], 0
  ds_read_b128 v[132:135], v6 offset:58368
  buffer_load_dword v239, v36, s[8:11], s6 offen sc1
  v_mfma_f32_16x16x32_bf16 v[112:115], v[136:139], a[0:3], 0
  v_mfma_f32_16x16x32_bf16 v[116:119], v[136:139], a[4:7], 0
  ds_read_b128 v[136:139], v6 offset:59392
  v_mfma_f32_16x16x32_bf16 v[120:123], v[140:143], a[0:3], 0
  v_mfma_f32_16x16x32_bf16 v[124:127], v[140:143], a[4:7], 0
  ds_read_b128 v[140:143], v6 offset:60416
  v_mfma_f32_16x16x32_bf16 v[104:107], v[144:147], a[8:11], v[104:107]
  v_mfma_f32_16x16x32_bf16 v[108:111], v[144:147], a[12:15], v[108:111]
  ds_read_b128 v[144:147], v6 offset:61440
  v_mfma_f32_16x16x32_bf16 v[112:115], v[148:151], a[8:11], v[112:115]
  v_mfma_f32_16x16x32_bf16 v[116:119], v[148:151], a[12:15], v[116:119]
  ds_read_b128 v[148:151], v6 offset:62464
  v_mfma_f32_16x16x32_bf16 v[120:123], v[152:155], a[8:11], v[120:123]
  v_mfma_f32_16x16x32_bf16 v[124:127], v[152:155], a[12:15], v[124:127]
  ds_read_b128 v[152:155], v6 offset:63488
  v_mfma_f32_16x16x32_bf16 v[104:107], v[156:159], a[16:19], v[104:107]
  v_mfma_f32_16x16x32_bf16 v[108:111], v[156:159], a[20:23], v[108:111]
  ds_read_b128 v[156:159], v6 offset:64512
  v_mfma_f32_16x16x32_bf16 v[112:115], v[128:131], a[16:19], v[112:115]
  v_mfma_f32_16x16x32_bf16 v[116:119], v[128:131], a[20:23], v[116:119]
  ds_read_b128 v[128:131], v7
  s_waitcnt lgkmcnt(6)
  v_mfma_f32_16x16x32_bf16 v[120:123], v[132:135], a[16:19], v[120:123]
  v_mfma_f32_16x16x32_bf16 v[124:127], v[132:135], a[20:23], v[124:127]
  ds_read_b128 v[132:135], v7 offset:1024
  v_mfma_f32_16x16x32_bf16 v[104:107], v[136:139], a[24:27], v[104:107]
  v_mfma_f32_16x16x32_bf16 v[108:111], v[136:139], a[28:31], v[108:111]
  ds_read_b128 v[136:139], v7 offset:2048
  s_waitcnt lgkmcnt(6)
  v_mfma_f32_16x16x32_bf16 v[112:115], v[140:143], a[24:27], v[112:115]
  v_mfma_f32_16x16x32_bf16 v[116:119], v[140:143], a[28:31], v[116:119]
  ds_read_b128 v[140:143], v7 offset:3072
  v_mfma_f32_16x16x32_bf16 v[120:123], v[144:147], a[24:27], v[120:123]
  v_mfma_f32_16x16x32_bf16 v[124:127], v[144:147], a[28:31], v[124:127]
  ds_read_b128 v[144:147], v7 offset:4096
  s_waitcnt lgkmcnt(6)
  v_mfma_f32_16x16x32_bf16 v[104:107], v[148:151], a[32:35], v[104:107]
  v_mfma_f32_16x16x32_bf16 v[108:111], v[148:151], a[36:39], v[108:111]
  ds_read_b128 v[148:151], v7 offset:5120
  v_mfma_f32_16x16x32_bf16 v[112:115], v[152:155], a[32:35], v[112:115]
  v_mfma_f32_16x16x32_bf16 v[116:119], v[152:155], a[36:39], v[116:119]
  ds_read_b128 v[152:155], v7 offset:6144
  s_waitcnt lgkmcnt(6)
  v_mfma_f32_16x16x32_bf16 v[120:123], v[156:159], a[32:35], v[120:123]
  v_mfma_f32_16x16x32_bf16 v[124:127], v[156:159], a[36:39], v[124:127]
  ds_read_b128 v[156:159], v7 offset:7168
  v_mfma_f32_16x16x32_bf16 v[104:107], v[128:131], a[40:43], v[104:107]
  s_waitcnt vmcnt(16)
  s_barrier
  v_mfma_f32_16x16x32_bf16 v[108:111], v[128:131], a[44:47], v[108:111]
  ds_read_b128 v[128:131], v7 offset:8192
  s_waitcnt lgkmcnt(6)
  v_mfma_f32_16x16x32_bf16 v[112:115], v[132:135], a[40:43], v[112:115]
  s_add_u32 m0, s30, 81920
  s_add_u32 s45, s32, 57344
  v_mfma_f32_16x16x32_bf16 v[116:119], v[132:135], a[44:47], v[116:119]
  ds_read_b128 v[132:135], v7 offset:9216
  buffer_load_dwordx4 v11, s[8:11], s45 offen lds
  v_mfma_f32_16x16x32_bf16 v[120:123], v[136:139], a[40:43], v[120:123]
  v_mfma_f32_16x16x32_bf16 v[124:127], v[136:139], a[44:47], v[124:127]
  ds_read_b128 v[136:139], v7 offset:10240
  s_waitcnt lgkmcnt(6)
  v_mfma_f32_16x16x32_bf16 v[104:107], v[140:143], a[48:51], v[104:107]
  buffer_load_dwordx4 v11, s[8:11], s45 offen offset:1024 lds
  v_mfma_f32_16x16x32_bf16 v[108:111], v[140:143], a[52:55], v[108:111]
  ds_read_b128 v[140:143], v7 offset:11264
  v_mfma_f32_16x16x32_bf16 v[112:115], v[144:147], a[48:51], v[112:115]
  s_add_u32 m0, s30, 90112
  s_add_u32 s45, s32, 65536
  v_mfma_f32_16x16x32_bf16 v[116:119], v[144:147], a[52:55], v[116:119]
  ds_read_b128 v[144:147], v7 offset:12288
  s_waitcnt lgkmcnt(6)
  v_mfma_f32_16x16x32_bf16 v[120:123], v[148:151], a[48:51], v[120:123]
  buffer_load_dwordx4 v11, s[8:11], s45 offen lds
  v_mfma_f32_16x16x32_bf16 v[124:127], v[148:151], a[52:55], v[124:127]
  ds_read_b128 v[148:151], v7 offset:13312
  v_mfma_f32_16x16x32_bf16 v[104:107], v[152:155], a[56:59], v[104:107]
  buffer_load_dwordx4 v11, s[8:11], s45 offen offset:1024 lds
  v_mfma_f32_16x16x32_bf16 v[108:111], v[152:155], a[60:63], v[108:111]
  ds_read_b128 v[152:155], v7 offset:14336
  s_waitcnt lgkmcnt(6)
  v_mfma_f32_16x16x32_bf16 v[112:115], v[156:159], a[56:59], v[112:115]
  s_add_u32 m0, s30, 98304
  s_add_u32 s45, s32, 73728
  v_mfma_f32_16x16x32_bf16 v[116:119], v[156:159], a[60:63], v[116:119]
  ds_read_b128 v[156:159], v7 offset:15360
  buffer_load_dwordx4 v11, s[8:11], s45 offen lds
  v_mfma_f32_16x16x32_bf16 v[120:123], v[128:131], a[56:59], v[120:123]
  v_mfma_f32_16x16x32_bf16 v[124:127], v[128:131], a[60:63], v[124:127]
  ds_read_b128 v[128:131], v7 offset:16384
  s_waitcnt lgkmcnt(6)
  v_mfma_f32_16x16x32_bf16 v[104:107], v[132:135], a[64:67], v[104:107]
  buffer_load_dwordx4 v11, s[8:11], s45 offen offset:1024 lds
  v_mfma_f32_16x16x32_bf16 v[108:111], v[132:135], a[68:71], v[108:111]
  ds_read_b128 v[132:135], v7 offset:17408
  v_mfma_f32_16x16x32_bf16 v[112:115], v[136:139], a[64:67], v[112:115]
  s_add_u32 m0, s30, 106496
  s_add_u32 s45, s32, 81920
  v_mfma_f32_16x16x32_bf16 v[116:119], v[136:139], a[68:71], v[116:119]
  ds_read_b128 v[136:139], v7 offset:18432
  s_waitcnt lgkmcnt(6)
  v_mfma_f32_16x16x32_bf16 v[120:123], v[140:143], a[64:67], v[120:123]
  buffer_load_dwordx4 v11, s[8:11], s45 offen lds
  v_mfma_f32_16x16x32_bf16 v[124:127], v[140:143], a[68:71], v[124:127]
  ds_read_b128 v[140:143], v7 offset:19456
  v_mfma_f32_16x16x32_bf16 v[104:107], v[144:147], a[72:75], v[104:107]
  buffer_load_dwordx4 v11, s[8:11], s45 offen offset:1024 lds
  v_mfma_f32_16x16x32_bf16 v[108:111], v[144:147], a[76:79], v[108:111]
  ds_read_b128 v[144:147], v7 offset:20480
  s_waitcnt lgkmcnt(6)
  v_mfma_f32_16x16x32_bf16 v[112:115], v[148:151], a[72:75], v[112:115]
  s_add_u32 m0, s30, 114688
  s_add_u32 s45, s32, 90112
  v_mfma_f32_16x16x32_bf16 v[116:119], v[148:151], a[76:79], v[116:119]
  ds_read_b128 v[148:151], v7 offset:21504
  buffer_load_dwordx4 v11, s[8:11], s45 offen lds
  v_mfma_f32_16x16x32_bf16 v[120:123], v[152:155], a[72:75], v[120:123]
  v_mfma_f32_16x16x32_bf16 v[124:127], v[152:155], a[76:79], v[124:127]
  ds_read_b128 v[152:155], v7 offset:22528
  s_waitcnt lgkmcnt(6)
  v_mfma_f32_16x16x32_bf16 v[104:107], v[156:159], a[80:83], v[104:107]
  buffer_load_dwordx4 v11, s[8:11], s45 offen offset:1024 lds
  v_mfma_f32_16x16x32_bf16 v[108:111], v[156:159], a[84:87], v[108:111]
  ds_read_b128 v[156:159], v7 offset:23552
  v_mfma_f32_16x16x32_bf16 v[112:115], v[128:131], a[80:83], v[112:115]
  s_add_u32 m0, s30, 122880
  s_add_u32 s45, s32, 98304
  v_mfma_f32_16x16x32_bf16 v[116:119], v[128:131], a[84:87], v[116:119]
  ds_read_b128 v[128:131], v7 offset:24576
  s_waitcnt lgkmcnt(6)
  v_mfma_f32_16x16x32_bf16 v[120:123], v[132:135], a[80:83], v[120:123]
  s_cmp_ge_u32 s24, 2
  s_cbranch_scc1 nopad_15
  buffer_load_dwordx4 v11, s[8:11], s45 offen lds
nopad_15:
  v_mfma_f32_16x16x32_bf16 v[124:127], v[132:135], a[84:87], v[124:127]
  ds_read_b128 v[132:135], v7 offset:25600
  v_mfma_f32_16x16x32_bf16 v[104:107], v[136:139], a[88:91], v[104:107]
  s_cmp_ge_u32 s24, 2
  s_cbranch_scc1 nopad_16
  buffer_load_dwordx4 v11, s[8:11], s45 offen offset:1024 lds
nopad_16:
  v_mfma_f32_16x16x32_bf16 v[108:111], v[136:139], a[92:95], v[108:111]
  ds_read_b128 v[136:139], v7 offset:26624
  s_waitcnt lgkmcnt(6)
  v_mfma_f32_16x16x32_bf16 v[112:115], v[140:143], a[88:91], v[112:115]
  s_waitcnt vmcnt(10)
  v_cmp_ne_u32 vcc, s62, v239
  v_mfma_f32_16x16x32_bf16 v[116:119], v[140:143], a[92:95], v[116:119]
  ds_read_b128 v[140:143], v7 offset:27648
  s_cmp_eq_u64 vcc, 0
  s_cselect_b32 s47, 1, 0
  v_mfma_f32_16x16x32_bf16 v[120:123], v[144:147], a[88:91], v[120:123]
  v_mfma_f32_16x16x32_bf16 v[124:127], v[144:147], a[92:95], v[124:127]
  ds_read_b128 v[144:147], v7 offset:28672
  s_waitcnt lgkmcnt(6)
  v_mfma_f32_16x16x32_bf16 v[104:107], v[148:151], a[96:99], v[104:107]
  v_mfma_f32_16x16x32_bf16 v[108:111], v[148:151], a[100:103], v[108:111]
  ds_read_b128 v[148:151], v7 offset:29696
  v_mfma_f32_16x16x32_bf16 v[112:115], v[152:155], a[96:99], v[112:115]
  v_mfma_f32_16x16x32_bf16 v[116:119], v[152:155], a[100:103], v[116:119]
  ds_read_b128 v[152:155], v7 offset:30720
  s_waitcnt lgkmcnt(6)
  v_mfma_f32_16x16x32_bf16 v[120:123], v[156:159], a[96:99], v[120:123]
  v_mfma_f32_16x16x32_bf16 v[124:127], v[156:159], a[100:103], v[124:127]
  ds_read_b128 v[156:159], v7 offset:31744
  v_mfma_f32_16x16x32_bf16 v[104:107], v[128:131], a[104:107], v[104:107]
  s_barrier
  v_mfma_f32_16x16x32_bf16 v[108:111], v[128:131], a[108:111], v[108:111]
  ds_read_b128 v[128:131], v5 offset:8192
  s_waitcnt lgkmcnt(6)
  v_mfma_f32_16x16x32_bf16 v[112:115], v[132:135], a[104:107], v[112:115]
  s_add_u32 s42, s61, 20840448
  buffer_load_dwordx4 v[64:67], v37, s[8:11], s42 offen sc1
  v_mfma_f32_16x16x32_bf16 v[116:119], v[132:135], a[108:111], v[116:119]
  ds_read_b128 v[132:135], v5 offset:9216
here_17:
  v_add_u32 v51, here_17-interleave_layers__linear_attn_block__dense_activation_squared_relu__prompt_kernel+1024, v38
  v_min_u32 v51, 57340, v51
  global_load_dword v49, v51, s[96:97]
  v_mfma_f32_16x16x32_bf16 v[120:123], v[136:139], a[104:107], v[120:123]
  buffer_load_dwordx4 v[68:71], v37, s[8:11], s42 offen offset:1792 sc1
  v_mfma_f32_16x16x32_bf16 v[124:127], v[136:139], a[108:111], v[124:127]
  ds_read_b128 v[136:139], v5 offset:10240
  s_waitcnt lgkmcnt(6)
  v_mfma_f32_16x16x32_bf16 v[104:107], v[140:143], a[112:115], v[104:107]
  s_add_u32 s42, s61, 20844032
  buffer_load_dwordx4 v[72:75], v37, s[8:11], s42 offen sc1
  v_mfma_f32_16x16x32_bf16 v[108:111], v[140:143], a[116:119], v[108:111]
  ds_read_b128 v[140:143], v5 offset:11264
  v_mfma_f32_16x16x32_bf16 v[112:115], v[144:147], a[112:115], v[112:115]
  buffer_load_dwordx4 v[76:79], v37, s[8:11], s42 offen offset:1792 sc1
  v_mfma_f32_16x16x32_bf16 v[116:119], v[144:147], a[116:119], v[116:119]
  ds_read_b128 v[144:147], v5 offset:12288
  s_waitcnt lgkmcnt(6)
  v_mfma_f32_16x16x32_bf16 v[120:123], v[148:151], a[112:115], v[120:123]
  s_add_u32 s42, s61, 20847616
  buffer_load_dwordx4 v[80:83], v37, s[8:11], s42 offen sc1
  v_mfma_f32_16x16x32_bf16 v[124:127], v[148:151], a[116:119], v[124:127]
  ds_read_b128 v[148:151], v5 offset:13312
  v_mfma_f32_16x16x32_bf16 v[104:107], v[152:155], a[120:123], v[104:107]
  buffer_load_dwordx4 v[84:87], v37, s[8:11], s42 offen offset:1792 sc1
  v_mfma_f32_16x16x32_bf16 v[108:111], v[152:155], a[124:127], v[108:111]
  ds_read_b128 v[152:155], v5 offset:14336
  s_waitcnt lgkmcnt(6)
  v_mfma_f32_16x16x32_bf16 v[112:115], v[156:159], a[120:123], v[112:115]
  s_add_u32 s42, s61, 20851200
  buffer_load_dwordx4 v[88:91], v37, s[8:11], s42 offen sc1
  v_mfma_f32_16x16x32_bf16 v[116:119], v[156:159], a[124:127], v[116:119]
  ds_read_b128 v[156:159], v5 offset:15360
  v_mfma_f32_16x16x32_bf16 v[120:123], v[128:131], a[120:123], v[120:123]
  buffer_load_dwordx4 v[92:95], v37, s[8:11], s42 offen offset:1792 sc1
  v_mfma_f32_16x16x32_bf16 v[124:127], v[128:131], a[124:127], v[124:127]
  ds_read_b128 v[128:131], v5 offset:16384
  s_waitcnt lgkmcnt(6)
  v_mfma_f32_16x16x32_bf16 v[104:107], v[132:135], a[128:131], v[104:107]
  v_mfma_f32_16x16x32_bf16 v[108:111], v[132:135], a[132:135], v[108:111]
  ds_read_b128 v[132:135], v5 offset:17408
  v_mfma_f32_16x16x32_bf16 v[112:115], v[136:139], a[128:131], v[112:115]
  v_mfma_f32_16x16x32_bf16 v[116:119], v[136:139], a[132:135], v[116:119]
  ds_read_b128 v[136:139], v5 offset:18432
  s_waitcnt lgkmcnt(6)
  v_mfma_f32_16x16x32_bf16 v[120:123], v[140:143], a[128:131], v[120:123]
  v_mfma_f32_16x16x32_bf16 v[124:127], v[140:143], a[132:135], v[124:127]
  ds_read_b128 v[140:143], v5 offset:19456
  s_add_u32 m0, s30, 131072
  v_mfma_f32_16x16x32_bf16 v[104:107], v[144:147], a[136:139], v[104:107]
  s_add_u32 s45, s33, 0
  buffer_load_dwordx4 v11, s[8:11], s45 offen lds
  v_mfma_f32_16x16x32_bf16 v[108:111], v[144:147], a[140:143], v[108:111]
  ds_read_b128 v[144:147], v5 offset:20480
  s_waitcnt lgkmcnt(6)
  v_mfma_f32_16x16x32_bf16 v[112:115], v[148:151], a[136:139], v[112:115]
  v_mfma_f32_16x16x32_bf16 v[116:119], v[148:151], a[140:143], v[116:119]
  ds_read_b128 v[148:151], v5 offset:21504
  v_mfma_f32_16x16x32_bf16 v[120:123], v[152:155], a[136:139], v[120:123]
  buffer_load_dwordx4 v11, s[8:11], s45 offen offset:1024 lds
  v_mfma_f32_16x16x32_bf16 v[124:127], v[152:155], a[140:143], v[124:127]
  ds_read_b128 v[152:155], v5 offset:22528
  s_waitcnt lgkmcnt(6)
  v_mfma_f32_16x16x32_bf16 v[104:107], v[156:159], a[144:147], v[104:107]
  v_mfma_f32_16x16x32_bf16 v[108:111], v[156:159], a[148:151], v[108:111]
  ds_read_b128 v[156:159], v5 offset:23552
  v_mfma_f32_16x16x32_bf16 v[112:115], v[128:131], a[144:147], v[112:115]
  v_mfma_f32_16x16x32_bf16 v[116:119], v[128:131], a[148:151], v[116:119]
  s_waitcnt lgkmcnt(5)
  v_mfma_f32_16x16x32_bf16 v[120:123], v[132:135], a[144:147], v[120:123]
  s_add_u32 m0, s30, 139264
  s_add_u32 s45, s33, 8192
  v_mfma_f32_16x16x32_bf16 v[124:127], v[132:135], a[148:151], v[124:127]
  buffer_load_dwordx4 v11, s[8:11], s45 offen lds
  v_mfma_f32_16x16x32_bf16 v[104:107], v[136:139], a[152:155], v[104:107]
  v_mfma_f32_16x16x32_bf16 v[108:111], v[136:139], a[156:159], v[108:111]
  s_waitcnt lgkmcnt(3)
  v_mfma_f32_16x16x32_bf16 v[112:115], v[140:143], a[152:155], v[112:115]
  v_mfma_f32_16x16x32_bf16 v[116:119], v[140:143], a[156:159], v[116:119]
  v_mfma_f32_16x16x32_bf16 v[120:123], v[144:147], a[152:155], v[120:123]
  buffer_load_dwordx4 v11, s[8:11], s45 offen offset:1024 lds
  v_mfma_f32_16x16x32_bf16 v[124:127], v[144:147], a[156:159], v[124:127]
  s_waitcnt lgkmcnt(1)
  v_mfma_f32_16x16x32_bf16 v[104:107], v[148:151], v[40:43], v[104:107]
  v_mfma_f32_16x16x32_bf16 v[108:111], v[148:151], v[44:47], v[108:111]
  v_mfma_f32_16x16x32_bf16 v[112:115], v[152:155], v[40:43], v[112:115]
  s_barrier
  v_mfma_f32_16x16x32_bf16 v[116:119], v[152:155], v[44:47], v[116:119]
  s_waitcnt lgkmcnt(0)
  v_mfma_f32_16x16x32_bf16 v[120:123], v[156:159], v[40:43], v[120:123]
  v_mfma_f32_16x16x32_bf16 v[124:127], v[156:159], v[44:47], v[124:127]
  s_nop 0
  v_pk_mul_f32 v[216:217], v[104:105], v[48:49] op_sel_hi:[1,0]
  v_exp_f32_e64 v218, v216 clamp
  v_exp_f32_e64 v219, v217 clamp
  v_max_f32 v216, 0, v216
  v_max_f32 v217, 0, v217
  v_pk_add_f32 v[218:219], v[218:219], v[54:55] op_sel_hi:[1,0]
  v_pk_fma_f32 v[216:217], v[216:217], v[52:53], v[218:219] op_sel_hi:[1,0,1]
  v_pk_mul_f32 v[220:221], v[112:113], v[48:49] op_sel_hi:[1,0]
  s_add_u32 m0, s30, 147456
  s_add_u32 s45, s33, 16384
  buffer_load_dwordx4 v11, s[8:11], s45 offen lds
  v_exp_f32_e64 v222, v220 clamp
  v_exp_f32_e64 v223, v221 clamp
  v_max_f32 v220, 0, v220
  v_max_f32 v221, 0, v221
  buffer_load_dwordx4 v11, s[8:11], s45 offen offset:1024 lds
  v_pk_add_f32 v[222:223], v[222:223], v[54:55] op_sel_hi:[1,0]
  v_pk_fma_f32 v[220:221], v[220:221], v[52:53], v[222:223] op_sel_hi:[1,0,1]
  v_cvt_pk_bf16_f32 v200, v216, v220
  v_cvt_pk_bf16_f32 v201, v217, v221
  v_pk_mul_f32 v[216:217], v[106:107], v[48:49] op_sel_hi:[1,0]
  v_exp_f32_e64 v218, v216 clamp
  v_exp_f32_e64 v219, v217 clamp
  v_max_f32 v216, 0, v216
  v_max_f32 v217, 0, v217
  v_pk_add_f32 v[218:219], v[218:219], v[54:55] op_sel_hi:[1,0]
  v_pk_fma_f32 v[216:217], v[216:217], v[52:53], v[218:219] op_sel_hi:[1,0,1]
  v_pk_mul_f32 v[220:221], v[114:115], v[48:49] op_sel_hi:[1,0]
  v_exp_f32_e64 v222, v220 clamp
  v_exp_f32_e64 v223, v221 clamp
  v_max_f32 v220, 0, v220
  v_max_f32 v221, 0, v221
  v_pk_add_f32 v[222:223], v[222:223], v[54:55] op_sel_hi:[1,0]
  v_pk_fma_f32 v[220:221], v[220:221], v[52:53], v[222:223] op_sel_hi:[1,0,1]
  s_add_u32 m0, s30, 155648
  s_add_u32 s45, s33, 24576
  buffer_load_dwordx4 v11, s[8:11], s45 offen lds
  v_cvt_pk_bf16_f32 v202, v216, v220
  v_cvt_pk_bf16_f32 v203, v217, v221
  v_pk_mul_f32 v[216:217], v[120:121], v[48:49] op_sel_hi:[1,0]
  v_exp_f32_e64 v218, v216 clamp
  v_exp_f32_e64 v219, v217 clamp
  v_max_f32 v216, 0, v216
  v_max_f32 v217, 0, v217
  v_pk_add_f32 v[218:219], v[218:219], v[54:55] op_sel_hi:[1,0]
  v_pk_fma_f32 v[216:217], v[216:217], v[52:53], v[218:219] op_sel_hi:[1,0,1]
  v_cvt_pk_bf16_f32 v208, v216, v217
  v_pk_mul_f32 v[220:221], v[122:123], v[48:49] op_sel_hi:[1,0]
  v_exp_f32_e64 v222, v220 clamp
  v_exp_f32_e64 v223, v221 clamp
  v_max_f32 v220, 0, v220
  v_max_f32 v221, 0, v221
  v_pk_add_f32 v[222:223], v[222:223], v[54:55] op_sel_hi:[1,0]
  v_pk_fma_f32 v[220:221], v[220:221], v[52:53], v[222:223] op_sel_hi:[1,0,1]
  v_cvt_pk_bf16_f32 v209, v220, v221
  v_mov_b32 v210, 0
  v_mov_b32 v211, 0
  v_pk_mul_f32 v[216:217], v[108:109], v[50:51] op_sel_hi:[1,0]
  v_exp_f32_e64 v218, v216 clamp
  buffer_load_dwordx4 v11, s[8:11], s45 offen offset:1024 lds
  v_exp_f32_e64 v219, v217 clamp
  v_max_f32 v216, 0, v216
  v_max_f32 v217, 0, v217
  v_pk_add_f32 v[218:219], v[218:219], v[54:55] op_sel_hi:[1,0]
  v_pk_fma_f32 v[216:217], v[216:217], v[52:53], v[218:219] op_sel_hi:[1,0,1]
  v_pk_mul_f32 v[220:221], v[116:117], v[50:51] op_sel_hi:[1,0]
  v_exp_f32_e64 v222, v220 clamp
  v_exp_f32_e64 v223, v221 clamp
  v_max_f32 v220, 0, v220
  v_max_f32 v221, 0, v221
  v_pk_add_f32 v[222:223], v[222:223], v[54:55] op_sel_hi:[1,0]
  v_pk_fma_f32 v[220:221], v[220:221], v[52:53], v[222:223] op_sel_hi:[1,0,1]
  v_cvt_pk_bf16_f32 v204, v216, v220
  v_cvt_pk_bf16_f32 v205, v217, v221
  v_pk_mul_f32 v[216:217], v[110:111], v[50:51] op_sel_hi:[1,0]
  v_exp_f32_e64 v218, v216 clamp
  v_exp_f32_e64 v219, v217 clamp
  v_max_f32 v216, 0, v216
  v_max_f32 v217, 0, v217
  v_pk_add_f32 v[218:219], v[218:219], v[54:55] op_sel_hi:[1,0]
  v_pk_fma_f32 v[216:217], v[216:217], v[52:53], v[218:219] op_sel_hi:[1,0,1]
  v_pk_mul_f32 v[220:221], v[118:119], v[50:51] op_sel_hi:[1,0]
  v_exp_f32_e64 v222, v220 clamp
  s_add_u32 m0, s30, 8192
  s_add_u32 s45, s33, 32768
  buffer_load_dwordx4 v11, s[8:11], s45 offen lds
  v_exp_f32_e64 v223, v221 clamp
  v_max_f32 v220, 0, v220
  v_max_f32 v221, 0, v221
  v_pk_add_f32 v[222:223], v[222:223], v[54:55] op_sel_hi:[1,0]
  v_pk_fma_f32 v[220:221], v[220:221], v[52:53], v[222:223] op_sel_hi:[1,0,1]
  v_cvt_pk_bf16_f32 v206, v216, v220
  v_cvt_pk_bf16_f32 v207, v217, v221
  v_pk_mul_f32 v[216:217], v[124:125], v[50:51] op_sel_hi:[1,0]
  v_exp_f32_e64 v218, v216 clamp
  v_exp_f32_e64 v219, v217 clamp
  v_max_f32 v216, 0, v216
  v_max_f32 v217, 0, v217
  v_pk_add_f32 v[218:219], v[218:219], v[54:55] op_sel_hi:[1,0]
  v_pk_fma_f32 v[216:217], v[216:217], v[52:53], v[218:219] op_sel_hi:[1,0,1]
  v_cvt_pk_bf16_f32 v212, v216, v217
  v_pk_mul_f32 v[220:221], v[126:127], v[50:51] op_sel_hi:[1,0]
  v_exp_f32_e64 v222, v220 clamp
  v_exp_f32_e64 v223, v221 clamp
  v_max_f32 v220, 0, v220
  v_max_f32 v221, 0, v221
  v_pk_add_f32 v[222:223], v[222:223], v[54:55] op_sel_hi:[1,0]
  v_pk_fma_f32 v[220:221], v[220:221], v[52:53], v[222:223] op_sel_hi:[1,0,1]
  buffer_load_dwordx4 v11, s[8:11], s45 offen offset:1024 lds
  v_cvt_pk_bf16_f32 v213, v220, v221
  v_mov_b32 v214, 0
  v_mov_b32 v215, 0
  s_waitcnt vmcnt(18)
  v_dot2_f32_bf16 v96, v64, s84, 0
  v_dot2_f32_bf16 v97, v64, s85, 0
  v_dot2_f32_bf16 v98, v65, s84, 0
  v_dot2_f32_bf16 v99, v65, s85, 0
  v_dot2_f32_bf16 v100, v66, s84, 0
  v_dot2_f32_bf16 v101, v66, s85, 0
  v_dot2_f32_bf16 v102, v67, s84, 0
  v_dot2_f32_bf16 v103, v67, s85, 0
  s_waitcnt vmcnt(16)
  v_dot2c_f32_bf16 v96, s84, v68
  v_dot2c_f32_bf16 v97, s85, v68
  v_dot2c_f32_bf16 v98, s84, v69
  v_dot2c_f32_bf16 v99, s85, v69
  v_dot2c_f32_bf16 v100, s84, v70
  v_dot2c_f32_bf16 v101, s85, v70
  v_dot2c_f32_bf16 v102, s84, v71
  v_dot2c_f32_bf16 v103, s85, v71
  s_waitcnt vmcnt(15)
  v_dot2c_f32_bf16 v96, s84, v72
  v_dot2c_f32_bf16 v97, s85, v72
  v_dot2c_f32_bf16 v98, s84, v73
  v_dot2c_f32_bf16 v99, s85, v73
  v_dot2c_f32_bf16 v100, s84, v74
  v_dot2c_f32_bf16 v101, s85, v74
  v_dot2c_f32_bf16 v102, s84, v75
  v_dot2c_f32_bf16 v103, s85, v75
  s_waitcnt vmcnt(14)
  v_dot2c_f32_bf16 v96, s84, v76
  v_dot2c_f32_bf16 v97, s85, v76
  v_dot2c_f32_bf16 v98, s84, v77
  v_dot2c_f32_bf16 v99, s85, v77
  v_dot2c_f32_bf16 v100, s84, v78
  v_dot2c_f32_bf16 v101, s85, v78
  v_dot2c_f32_bf16 v102, s84, v79
  v_dot2c_f32_bf16 v103, s85, v79
  s_waitcnt vmcnt(13)
  v_dot2c_f32_bf16 v96, s84, v80
  v_dot2c_f32_bf16 v97, s85, v80
  v_dot2c_f32_bf16 v98, s84, v81
  v_dot2c_f32_bf16 v99, s85, v81
  v_dot2c_f32_bf16 v100, s84, v82
  v_dot2c_f32_bf16 v101, s85, v82
  v_dot2c_f32_bf16 v102, s84, v83
  v_dot2c_f32_bf16 v103, s85, v83
  s_waitcnt vmcnt(12)
  v_dot2c_f32_bf16 v96, s84, v84
  v_dot2c_f32_bf16 v97, s85, v84
  v_dot2c_f32_bf16 v98, s84, v85
  v_dot2c_f32_bf16 v99, s85, v85
  v_dot2c_f32_bf16 v100, s84, v86
  v_dot2c_f32_bf16 v101, s85, v86
  v_dot2c_f32_bf16 v102, s84, v87
  v_dot2c_f32_bf16 v103, s85, v87
  s_waitcnt vmcnt(11)
  v_dot2c_f32_bf16 v96, s84, v88
  v_dot2c_f32_bf16 v97, s85, v88
  v_dot2c_f32_bf16 v98, s84, v89
  v_dot2c_f32_bf16 v99, s85, v89
  v_dot2c_f32_bf16 v100, s84, v90
  v_dot2c_f32_bf16 v101, s85, v90
  v_dot2c_f32_bf16 v102, s84, v91
  v_dot2c_f32_bf16 v103, s85, v91
  s_waitcnt vmcnt(10)
  v_dot2c_f32_bf16 v96, s84, v92
  v_dot2c_f32_bf16 v97, s85, v92
  v_dot2c_f32_bf16 v98, s84, v93
  v_dot2c_f32_bf16 v99, s85, v93
  v_dot2c_f32_bf16 v100, s84, v94
  v_dot2c_f32_bf16 v101, s85, v94
  v_dot2c_f32_bf16 v102, s84, v95
  v_dot2c_f32_bf16 v103, s85, v95
  v_add_f32_dpp v96, v96, v96 quad_perm:[1,0,3,2] row_mask:0xf bank_mask:0xf
  v_add_f32_dpp v97, v97, v97 quad_perm:[1,0,3,2] row_mask:0xf bank_mask:0xf
  v_add_f32_dpp v98, v98, v98 quad_perm:[1,0,3,2] row_mask:0xf bank_mask:0xf
  v_add_f32_dpp v99, v99, v99 quad_perm:[1,0,3,2] row_mask:0xf bank_mask:0xf
  v_add_f32_dpp v100, v100, v100 quad_perm:[1,0,3,2] row_mask:0xf bank_mask:0xf
  v_add_f32_dpp v101, v101, v101 quad_perm:[1,0,3,2] row_mask:0xf bank_mask:0xf
  v_add_f32_dpp v102, v102, v102 quad_perm:[1,0,3,2] row_mask:0xf bank_mask:0xf
  v_add_f32_dpp v103, v103, v103 quad_perm:[1,0,3,2] row_mask:0xf bank_mask:0xf
  v_cndmask_b32 v64, v96, v100, s[86:87]
  v_cndmask_b32 v65, v97, v101, s[86:87]
  v_cndmask_b32 v66, v98, v102, s[86:87]
  v_cndmask_b32 v67, v99, v103, s[86:87]
  v_cmp_u_f32 vcc, v64, v65
  v_cmp_u_f32 s[90:91], v66, v67
  s_or_b64 vcc, vcc, s[90:91]
  s_cbranch_scc0 kvok_18
  s_mov_b32 s50, 0
kvretry_19:
  s_sleep 4
  s_add_u32 s42, s61, 20840448
  buffer_load_dwordx4 v[64:67], v37, s[8:11], s42 offen sc1
  buffer_load_dwordx4 v[68:71], v37, s[8:11], s42 offen offset:1792 sc1
  s_add_u32 s42, s61, 20844032
  buffer_load_dwordx4 v[72:75], v37, s[8:11], s42 offen sc1
  buffer_load_dwordx4 v[76:79], v37, s[8:11], s42 offen offset:1792 sc1
  s_add_u32 s42, s61, 20847616
  buffer_load_dwordx4 v[80:83], v37, s[8:11], s42 offen sc1
  buffer_load_dwordx4 v[84:87], v37, s[8:11], s42 offen offset:1792 sc1
  s_add_u32 s42, s61, 20851200
  buffer_load_dwordx4 v[88:91], v37, s[8:11], s42 offen sc1
  buffer_load_dwordx4 v[92:95], v37, s[8:11], s42 offen offset:1792 sc1
  s_waitcnt vmcnt(7)
  v_dot2_f32_bf16 v96, v64, s84, 0
  v_dot2_f32_bf16 v97, v64, s85, 0
  v_dot2_f32_bf16 v98, v65, s84, 0
  v_dot2_f32_bf16 v99, v65, s85, 0
  v_dot2_f32_bf16 v100, v66, s84, 0
  v_dot2_f32_bf16 v101, v66, s85, 0
  v_dot2_f32_bf16 v102, v67, s84, 0
  v_dot2_f32_bf16 v103, v67, s85, 0
  s_waitcnt vmcnt(6)
  v_dot2c_f32_bf16 v96, s84, v68
  v_dot2c_f32_bf16 v97, s85, v68
  v_dot2c_f32_bf16 v98, s84, v69
  v_dot2c_f32_bf16 v99, s85, v69
  v_dot2c_f32_bf16 v100, s84, v70
  v_dot2c_f32_bf16 v101, s85, v70
  v_dot2c_f32_bf16 v102, s84, v71
  v_dot2c_f32_bf16 v103, s85, v71
  s_waitcnt vmcnt(5)
  v_dot2c_f32_bf16 v96, s84, v72
  v_dot2c_f32_bf16 v97, s85, v72
  v_dot2c_f32_bf16 v98, s84, v73
  v_dot2c_f32_bf16 v99, s85, v73
  v_dot2c_f32_bf16 v100, s84, v74
  v_dot2c_f32_bf16 v101, s85, v74
  v_dot2c_f32_bf16 v102, s84, v75
  v_dot2c_f32_bf16 v103, s85, v75
  s_waitcnt vmcnt(4)
  v_dot2c_f32_bf16 v96, s84, v76
  v_dot2c_f32_bf16 v97, s85, v76
  v_dot2c_f32_bf16 v98, s84, v77
  v_dot2c_f32_bf16 v99, s85, v77
  v_dot2c_f32_bf16 v100, s84, v78
  v_dot2c_f32_bf16 v101, s85, v78
  v_dot2c_f32_bf16 v102, s84, v79
  v_dot2c_f32_bf16 v103, s85, v79
  s_waitcnt vmcnt(3)
  v_dot2c_f32_bf16 v96, s84, v80
  v_dot2c_f32_bf16 v97, s85, v80
  v_dot2c_f32_bf16 v98, s84, v81
  v_dot2c_f32_bf16 v99, s85, v81
  v_dot2c_f32_bf16 v100, s84, v82
  v_dot2c_f32_bf16 v101, s85, v82
  v_dot2c_f32_bf16 v102, s84, v83
  v_dot2c_f32_bf16 v103, s85, v83
  s_waitcnt vmcnt(2)
  v_dot2c_f32_bf16 v96, s84, v84
  v_dot2c_f32_bf16 v97, s85, v84
  v_dot2c_f32_bf16 v98, s84, v85
  v_dot2c_f32_bf16 v99, s85, v85
  v_dot2c_f32_bf16 v100, s84, v86
  v_dot2c_f32_bf16 v101, s85, v86
  v_dot2c_f32_bf16 v102, s84, v87
  v_dot2c_f32_bf16 v103, s85, v87
  s_waitcnt vmcnt(1)
  v_dot2c_f32_bf16 v96, s84, v88
  v_dot2c_f32_bf16 v97, s85, v88
  v_dot2c_f32_bf16 v98, s84, v89
  v_dot2c_f32_bf16 v99, s85, v89
  v_dot2c_f32_bf16 v100, s84, v90
  v_dot2c_f32_bf16 v101, s85, v90
  v_dot2c_f32_bf16 v102, s84, v91
  v_dot2c_f32_bf16 v103, s85, v91
  s_waitcnt vmcnt(0)
  v_dot2c_f32_bf16 v96, s84, v92
  v_dot2c_f32_bf16 v97, s85, v92
  v_dot2c_f32_bf16 v98, s84, v93
  v_dot2c_f32_bf16 v99, s85, v93
  v_dot2c_f32_bf16 v100, s84, v94
  v_dot2c_f32_bf16 v101, s85, v94
  v_dot2c_f32_bf16 v102, s84, v95
  v_dot2c_f32_bf16 v103, s85, v95
  v_add_f32_dpp v96, v96, v96 quad_perm:[1,0,3,2] row_mask:0xf bank_mask:0xf
  v_add_f32_dpp v97, v97, v97 quad_perm:[1,0,3,2] row_mask:0xf bank_mask:0xf
  v_add_f32_dpp v98, v98, v98 quad_perm:[1,0,3,2] row_mask:0xf bank_mask:0xf
  v_add_f32_dpp v99, v99, v99 quad_perm:[1,0,3,2] row_mask:0xf bank_mask:0xf
  v_add_f32_dpp v100, v100, v100 quad_perm:[1,0,3,2] row_mask:0xf bank_mask:0xf
  v_add_f32_dpp v101, v101, v101 quad_perm:[1,0,3,2] row_mask:0xf bank_mask:0xf
  v_add_f32_dpp v102, v102, v102 quad_perm:[1,0,3,2] row_mask:0xf bank_mask:0xf
  v_add_f32_dpp v103, v103, v103 quad_perm:[1,0,3,2] row_mask:0xf bank_mask:0xf
  v_cndmask_b32 v64, v96, v100, s[86:87]
  v_cndmask_b32 v65, v97, v101, s[86:87]
  v_cndmask_b32 v66, v98, v102, s[86:87]
  v_cndmask_b32 v67, v99, v103, s[86:87]
  v_cmp_u_f32 vcc, v64, v65
  v_cmp_u_f32 s[90:91], v66, v67
  s_or_b64 vcc, vcc, s[90:91]
  s_cbranch_scc0 kvok_18
  s_add_u32 s50, s50, 1
  s_cmp_lt_u32 s50, 65536
  s_cbranch_scc1 kvretry_19
kvok_18:
  v_cvt_pk_bf16_f32 v216, v64, v65
  v_cvt_pk_bf16_f32 v217, v66, v67
  ds_write_b64 v21, v[216:217]
  s_waitcnt lgkmcnt(0)
  s_barrier
  ds_read_b128 v[104:107], v4
  ds_read_b128 v[108:111], v4 offset:1024
  ds_read_b128 v[112:115], v4 offset:2048
  ds_read_b128 v[116:119], v4 offset:3072
  ds_read_b128 v[120:123], v4 offset:4096
  ds_read_b128 v[124:127], v4 offset:5120
  ds_read_b128 v[216:219], v23
  ds_read_b128 v[224:227], v24
  ds_read_b128 v[220:223], v23 offset:64
  ds_read_b128 v[228:231], v24 offset:64
  s_waitcnt lgkmcnt(3)
  v_mfma_f32_16x16x32_bf16 v[88:91], v[216:219], v[200:203], 0
  s_waitcnt lgkmcnt(2)
  v_mfma_f32_16x16x32_bf16 v[96:99], v[224:227], v[200:203], 0
  v_mfma_f32_16x16x32_bf16 v[64:67], v[104:107], v[200:203], 0
  v_mfma_f32_16x16x32_bf16 v[72:75], v[112:115], v[200:203], 0
  v_mfma_f32_16x16x32_bf16 v[80:83], v[120:123], v[200:203], 0
  s_waitcnt lgkmcnt(1)
  v_mfma_f32_16x16x32_bf16 v[88:91], v[220:223], v[208:211], v[88:91]
  s_waitcnt lgkmcnt(0)
  v_mfma_f32_16x16x32_bf16 v[96:99], v[228:231], v[208:211], v[96:99]
  v_mfma_f32_16x16x32_bf16 v[64:67], v[108:111], v[208:211], v[64:67]
  v_mfma_f32_16x16x32_bf16 v[72:75], v[116:119], v[208:211], v[72:75]
  v_mfma_f32_16x16x32_bf16 v[80:83], v[124:127], v[208:211], v[80:83]
  s_add_u32 s41, s57, 11141120
  s_add_u32 s42, s58, 11141120
  v_mfma_f32_16x16x32_bf16 v[92:95], v[216:219], v[204:207], 0
  s_add_u32 s43, s58, 11161600
  v_mfma_f32_16x16x32_bf16 v[100:103], v[224:227], v[204:207], 0
  v_add_f32 v88, v54, v88
  v_add_f32 v90, v54, v90
  v_mfma_f32_16x16x32_bf16 v[68:71], v[104:107], v[204:207], 0
  v_add_f32 v96, v54, v96
  v_mfma_f32_16x16x32_bf16 v[76:79], v[112:115], v[204:207], 0
  v_rcp_f32 v88, v88
  v_mfma_f32_16x16x32_bf16 v[84:87], v[120:123], v[204:207], 0
  v_rcp_f32 v90, v90
  v_rcp_f32 v96, v96
  v_mfma_f32_16x16x32_bf16 v[92:95], v[220:223], v[212:215], v[92:95]
  v_mul_f32 v64, v64, v88
  v_mul_f32 v65, v65, v88
  v_mfma_f32_16x16x32_bf16 v[100:103], v[228:231], v[212:215], v[100:103]
  v_mul_f32 v66, v66, v90
  v_mul_f32 v67, v67, v90
  v_mfma_f32_16x16x32_bf16 v[68:71], v[108:111], v[212:215], v[68:71]
  v_mul_f32 v72, v72, v88
  v_mul_f32 v73, v73, v88
  v_mfma_f32_16x16x32_bf16 v[76:79], v[116:119], v[212:215], v[76:79]
  v_mul_f32 v74, v74, v90
  v_mul_f32 v75, v75, v90
  v_mfma_f32_16x16x32_bf16 v[84:87], v[124:127], v[212:215], v[84:87]
  v_mul_f32 v80, v80, v96
  v_mul_f32 v81, v81, v96
  v_mul_f32 v82, v82, v96
  v_mul_f32 v83, v83, v96
  v_cvt_pk_bf16_f32 v56, v64, v72
  v_cvt_pk_bf16_f32 v57, v65, v73
  v_cvt_pk_bf16_f32 v58, v66, v74
  v_cvt_pk_bf16_f32 v59, v67, v75
  v_cvt_pk_bf16_f32 v40, v80, v81
  v_cvt_pk_bf16_f32 v41, v82, v83
  buffer_store_dwordx4 v[56:59], v12, s[8:11], s41 offen sc1
  buffer_store_dwordx2 v[40:41], v31, s[8:11], s42 offen sc1
  v_add_f32 v92, v54, v92
  v_add_f32 v94, v54, v94
  v_add_f32 v100, v54, v100
  v_rcp_f32 v92, v92
  v_rcp_f32 v94, v94
  v_rcp_f32 v100, v100
  v_pk_mul_f32 v[68:69], v[68:69], v[92:93] op_sel_hi:[1,0]
  v_pk_mul_f32 v[70:71], v[70:71], v[94:95] op_sel_hi:[1,0]
  v_pk_mul_f32 v[76:77], v[76:77], v[92:93] op_sel_hi:[1,0]
  v_pk_mul_f32 v[78:79], v[78:79], v[94:95] op_sel_hi:[1,0]
  v_pk_mul_f32 v[84:85], v[84:85], v[100:101] op_sel_hi:[1,0]
  v_pk_mul_f32 v[86:87], v[86:87], v[100:101] op_sel_hi:[1,0]
  v_cvt_pk_bf16_f32 v60, v68, v76
  v_cvt_pk_bf16_f32 v61, v69, v77
  v_cvt_pk_bf16_f32 v62, v70, v78
  v_cvt_pk_bf16_f32 v63, v71, v79
  v_cvt_pk_bf16_f32 v44, v84, v85
  v_cvt_pk_bf16_f32 v45, v86, v87
  buffer_store_dwordx4 v[60:63], v13, s[8:11], s41 offen sc1
  buffer_store_dwordx2 v[44:45], v31, s[8:11], s43 offen sc1
  s_waitcnt vmcnt(0)
  s_barrier
  s_lshl_b32 s41, s47, 2
  s_add_u32 s41, s41, s24
  s_cmp_lg_u32 s41, 1
  s_cbranch_scc1 noflag_20
  s_lshl_b32 s41, s26, 2
  v_mov_b32 v237, s41
  s_add_u32 s41, s92, 2
  v_mov_b32 v238, s41
  s_mov_b64 exec, 1
  buffer_store_dword v238, v237, s[8:11], s39 offen sc1
  s_mov_b64 exec, -1
noflag_20:
  s_cmp_lg_u32 s24, 2
  s_cbranch_scc1 noflag_21
  s_lshl_b32 s41, s26, 2
  v_mov_b32 v237, s41
  s_add_u32 s41, s92, 2
  v_mov_b32 v238, s41
  s_mov_b64 exec, 1
  buffer_store_dword v238, v237, s[8:11], s38 offen
  s_mov_b64 exec, -1
noflag_21:
  s_add_u32 m0, s30, 16384
  s_add_u32 s45, s33, 40960
  buffer_load_dwordx4 v11, s[8:11], s45 offen lds
  buffer_load_dwordx4 v11, s[8:11], s45 offen offset:1024 lds
  ds_read_b128 v[128:131], v8 offset:24576
  ds_read_b128 v[132:135], v8 offset:26624
  ds_read_b128 v[136:139], v8 offset:28672
  ds_read_b128 v[140:143], v8 offset:30720
  ds_read_b128 v[144:147], v8 offset:32768
  ds_read_b128 v[148:151], v8 offset:34816
  ds_read_b128 v[152:155], v8 offset:36864
  ds_read_b128 v[156:159], v8 offset:38912
  s_mul_i32 s42, s27, 160
  v_lshl_add_u32 v202, v3, 4, s42
  v_lshl_add_u32 v203, v3, 3, s42
  buffer_load_dwordx4 v[104:107], v202, s[20:23], 0 offen
  buffer_load_dwordx4 v[108:111], v202, s[20:23], 0 offen offset:64
  buffer_load_dwordx2 v[112:113], v203, s[20:23], 0 offen offset:128
  v_lshlrev_b32 v160, 16, v170
  v_and_b32 v164, 0xffff0000, v170
  v_lshlrev_b32 v161, 16, v171
  v_and_b32 v165, 0xffff0000, v171
  v_lshlrev_b32 v162, 16, v172
  v_and_b32 v166, 0xffff0000, v172
  v_lshlrev_b32 v163, 16, v173
  v_and_b32 v167, 0xffff0000, v173
  v_lshlrev_b32 v168, 16, v174
  v_and_b32 v172, 0xffff0000, v174
  v_lshlrev_b32 v169, 16, v175
  v_and_b32 v173, 0xffff0000, v175
  v_lshlrev_b32 v170, 16, v176
  v_and_b32 v174, 0xffff0000, v176
  v_lshlrev_b32 v171, 16, v177
  v_and_b32 v175, 0xffff0000, v177
  v_lshlrev_b32 v176, 16, v178
  v_and_b32 v177, 0xffff0000, v178
  v_lshlrev_b32 v178, 16, v179
  v_and_b32 v179, 0xffff0000, v179
  s_cmp_lg_u32 s24, 0
  s_cbranch_scc1 nopoll_22
  s_mov_b32 s50, 0
  s_mov_b64 s[94:95], 0
  s_add_u32 s42, s92, 2
  s_cmp_eq_u32 s47, 0
  s_cselect_b32 s43, 3, -1
poll_23:
  buffer_load_dword v238, v36, s[8:11], s38 offen sc1
  s_add_u32 s50, s50, 1
  s_waitcnt vmcnt(0)
  v_subrev_u32 v238, s42, v238
  v_cmp_ge_u32 vcc, 1, v238
  s_or_b64 s[94:95], s[94:95], vcc
  s_cmp_eq_u64 s[94:95], -1
  s_cbranch_scc1 nopoll_22
  s_and_b32 s41, s50, s43
  s_cbranch_scc1 pollnext_24
  buffer_load_dword v238, v36, s[8:11], s39 offen sc1
  s_waitcnt vmcnt(0)
  v_subrev_u32 v238, s42, v238
  v_cmp_ge_u32 vcc, 1, v238
  s_or_b64 s[94:95], s[94:95], vcc
  s_cmp_eq_u64 s[94:95], -1
  s_cbranch_scc1 nopoll_22
pollnext_24:
  s_cmp_lt_u32 s50, 0x80000
  s_cbranch_scc1 poll_23
nopoll_22:
  s_barrier
  s_add_u32 s46, s35, 11141120
  buffer_load_dwordx4 a[0:3], v14, s[8:11], s46 offen sc1
  buffer_load_dwordx4 a[4:7], v15, s[8:11], s46 offen sc1
  buffer_load_dwordx4 a[8:11], v14, s[8:11], s46 offen offset:1024 sc1
  buffer_load_dwordx4 a[12:15], v15, s[8:11], s46 offen offset:1024 sc1
  buffer_load_dwordx4 a[16:19], v14, s[8:11], s46 offen offset:2048 sc1
  buffer_load_dwordx4 a[20:23], v15, s[8:11], s46 offen offset:2048 sc1
  buffer_load_dwordx4 a[24:27], v14, s[8:11], s46 offen offset:3072 sc1
  buffer_load_dwordx4 a[28:31], v15, s[8:11], s46 offen offset:3072 sc1
  s_waitcnt vmcnt(6) lgkmcnt(6)
  v_mfma_f32_16x16x32_bf16 v[84:87], v[128:131], a[4:7], 0
  s_add_u32 s46, s35, 11145216
  buffer_load_dwordx4 a[32:35], v14, s[8:11], s46 offen sc1
  v_mfma_f32_16x16x32_bf16 v[64:67], v[128:131], a[0:3], v[160:163]
  ds_read_b128 v[128:131], v8 offset:40960
  buffer_load_dwordx4 a[36:39], v15, s[8:11], s46 offen sc1
  v_mfma_f32_16x16x32_bf16 v[88:91], v[132:135], a[4:7], 0
  buffer_load_dwordx4 a[40:43], v14, s[8:11], s46 offen offset:1024 sc1
  buffer_load_dwordx4 a[44:47], v15, s[8:11], s46 offen offset:1024 sc1
  v_mfma_f32_16x16x32_bf16 v[68:71], v[132:135], a[0:3], v[164:167]
  ds_read_b128 v[132:135], v8 offset:43008
  s_waitcnt lgkmcnt(6)
  v_mfma_f32_16x16x32_bf16 v[92:95], v[136:139], a[4:7], 0
  buffer_load_dwordx4 a[48:51], v14, s[8:11], s46 offen offset:2048 sc1
  buffer_load_dwordx4 a[52:55], v15, s[8:11], s46 offen offset:2048 sc1
  v_mfma_f32_16x16x32_bf16 v[72:75], v[136:139], a[0:3], v[168:171]
  ds_read_b128 v[136:139], v8 offset:45056
  v_mfma_f32_16x16x32_bf16 v[96:99], v[140:143], a[4:7], 0
  buffer_load_dwordx4 a[56:59], v14, s[8:11], s46 offen offset:3072 sc1
  v_mfma_f32_16x16x32_bf16 v[76:79], v[140:143], a[0:3], v[172:175]
  ds_read_b128 v[140:143], v8 offset:47104
  s_waitcnt vmcnt(11) lgkmcnt(6)
  v_mfma_f32_16x16x32_bf16 v[100:103], v[144:147], a[4:7], 0
  s_barrier
  v_mfma_f32_16x16x32_bf16 v[80:83], v[144:147], a[0:3], v[176:179]
  ds_read_b128 v[144:147], v8 offset:49152
  buffer_load_dwordx4 a[60:63], v15, s[8:11], s46 offen offset:3072 sc1
  v_mfma_f32_16x16x32_bf16 v[84:87], v[148:151], a[12:15], v[84:87]
  v_mfma_f32_16x16x32_bf16 v[64:67], v[148:151], a[8:11], v[64:67]
  ds_read_b128 v[148:151], v8 offset:51200
  s_waitcnt lgkmcnt(6)
  v_mfma_f32_16x16x32_bf16 v[88:91], v[152:155], a[12:15], v[88:91]
  s_add_u32 s46, s35, 11149312
  buffer_load_dwordx4 a[64:67], v14, s[8:11], s46 offen sc1
  v_mfma_f32_16x16x32_bf16 v[68:71], v[152:155], a[8:11], v[68:71]
  ds_read_b128 v[152:155], v8 offset:53248
  v_mfma_f32_16x16x32_bf16 v[92:95], v[156:159], a[12:15], v[92:95]
  buffer_load_dwordx4 a[68:71], v15, s[8:11], s46 offen sc1
  v_mfma_f32_16x16x32_bf16 v[72:75], v[156:159], a[8:11], v[72:75]
  ds_read_b128 v[156:159], v8 offset:55296
  s_waitcnt lgkmcnt(6)
  v_mfma_f32_16x16x32_bf16 v[96:99], v[128:131], a[12:15], v[96:99]
  buffer_load_dwordx4 a[72:75], v14, s[8:11], s46 offen offset:1024 sc1
  v_mfma_f32_16x16x32_bf16 v[76:79], v[128:131], a[8:11], v[76:79]
  ds_read_b128 v[128:131], v8 offset:57344
  v_mfma_f32_16x16x32_bf16 v[100:103], v[132:135], a[12:15], v[100:103]
  v_mfma_f32_16x16x32_bf16 v[80:83], v[132:135], a[8:11], v[80:83]
  ds_read_b128 v[132:135], v8 offset:59392
  s_waitcnt vmcnt(13) lgkmcnt(6)
  v_mfma_f32_16x16x32_bf16 v[84:87], v[136:139], a[20:23], v[84:87]
  v_mfma_f32_16x16x32_bf16 v[64:67], v[136:139], a[16:19], v[64:67]
  ds_read_b128 v[136:139], v8 offset:61440
  buffer_load_dwordx4 a[76:79], v15, s[8:11], s46 offen offset:1024 sc1
  v_mfma_f32_16x16x32_bf16 v[88:91], v[140:143], a[20:23], v[88:91]
  v_mfma_f32_16x16x32_bf16 v[68:71], v[140:143], a[16:19], v[68:71]
  ds_read_b128 v[140:143], v8 offset:63488
  s_waitcnt lgkmcnt(6)
  v_mfma_f32_16x16x32_bf16 v[92:95], v[144:147], a[20:23], v[92:95]
  v_mfma_f32_16x16x32_bf16 v[72:75], v[144:147], a[16:19], v[72:75]
  ds_read_b128 v[144:147], v9
  v_mfma_f32_16x16x32_bf16 v[96:99], v[148:151], a[20:23], v[96:99]
  s_add_u32 m0, s30, 24576
  s_add_u32 s45, s33, 49152
  v_mfma_f32_16x16x32_bf16 v[76:79], v[148:151], a[16:19], v[76:79]
  ds_read_b128 v[148:151], v9 offset:2048
  s_waitcnt vmcnt(12) lgkmcnt(6)
  v_mfma_f32_16x16x32_bf16 v[100:103], v[152:155], a[20:23], v[100:103]
  buffer_load_dwordx4 v11, s[8:11], s45 offen lds
  v_mfma_f32_16x16x32_bf16 v[80:83], v[152:155], a[16:19], v[80:83]
  ds_read_b128 v[152:155], v9 offset:4096
  v_mfma_f32_16x16x32_bf16 v[84:87], v[156:159], a[28:31], v[84:87]
  v_mfma_f32_16x16x32_bf16 v[64:67], v[156:159], a[24:27], v[64:67]
  ds_read_b128 v[156:159], v9 offset:6144
  s_waitcnt lgkmcnt(6)
  v_mfma_f32_16x16x32_bf16 v[88:91], v[128:131], a[28:31], v[88:91]
  buffer_load_dwordx4 v11, s[8:11], s45 offen offset:1024 lds
  s_barrier
  v_mfma_f32_16x16x32_bf16 v[68:71], v[128:131], a[24:27], v[68:71]
  ds_read_b128 v[128:131], v9 offset:8192
  v_mfma_f32_16x16x32_bf16 v[92:95], v[132:135], a[28:31], v[92:95]
  v_mfma_f32_16x16x32_bf16 v[72:75], v[132:135], a[24:27], v[72:75]
  ds_read_b128 v[132:135], v9 offset:10240
  s_waitcnt lgkmcnt(6)
  v_mfma_f32_16x16x32_bf16 v[96:99], v[136:139], a[28:31], v[96:99]
  s_add_u32 m0, s30, 32768
  s_add_u32 s45, s33, 57344
  v_mfma_f32_16x16x32_bf16 v[76:79], v[136:139], a[24:27], v[76:79]
  ds_read_b128 v[136:139], v9 offset:12288
  buffer_load_dwordx4 v11, s[8:11], s45 offen lds
  v_mfma_f32_16x16x32_bf16 v[100:103], v[140:143], a[28:31], v[100:103]
  v_mfma_f32_16x16x32_bf16 v[80:83], v[140:143], a[24:27], v[80:83]
  ds_read_b128 v[140:143], v9 offset:14336
  s_waitcnt vmcnt(13) lgkmcnt(6)
  v_mfma_f32_16x16x32_bf16 v[84:87], v[144:147], a[36:39], v[84:87]
  v_mfma_f32_16x16x32_bf16 v[64:67], v[144:147], a[32:35], v[64:67]
  ds_read_b128 v[144:147], v9 offset:16384
  buffer_load_dwordx4 v11, s[8:11], s45 offen offset:1024 lds
  v_mfma_f32_16x16x32_bf16 v[88:91], v[148:151], a[36:39], v[88:91]
  v_mfma_f32_16x16x32_bf16 v[68:71], v[148:151], a[32:35], v[68:71]
  ds_read_b128 v[148:151], v9 offset:18432
  s_waitcnt lgkmcnt(6)
  v_mfma_f32_16x16x32_bf16 v[92:95], v[152:155], a[36:39], v[92:95]
  v_add_u32 v200, 100352, v39
  s_xor_b32 s41, s24, 1
  v_mfma_f32_16x16x32_bf16 v[72:75], v[152:155], a[32:35], v[72:75]
  ds_read_b128 v[152:155], v9 offset:20480
  s_mul_i32 s41, s41, 5120
  v_mfma_f32_16x16x32_bf16 v[96:99], v[156:159], a[36:39], v[96:99]
  s_add_u32 m0, s30, 40960
  s_add_u32 s45, s33, 65536
  v_mfma_f32_16x16x32_bf16 v[76:79], v[156:159], a[32:35], v[76:79]
  ds_read_b128 v[156:159], v9 offset:22528
  s_waitcnt vmcnt(12) lgkmcnt(6)
  v_mfma_f32_16x16x32_bf16 v[100:103], v[128:131], a[36:39], v[100:103]
  buffer_load_dwordx4 v11, s[8:11], s45 offen lds
  s_add_u32 s41, s41, 100352
  v_mfma_f32_16x16x32_bf16 v[80:83], v[128:131], a[32:35], v[80:83]
  ds_read_b128 v[128:131], v9 offset:24576
  v_add_u32 v201, s41, v4
  v_mfma_f32_16x16x32_bf16 v[84:87], v[132:135], a[44:47], v[84:87]
  s_add_u32 s41, s54, 8388608
  buffer_load_dwordx4 v11, s[8:11], s45 offen offset:1024 lds
  v_mfma_f32_16x16x32_bf16 v[64:67], v[132:135], a[40:43], v[64:67]
  ds_read_b128 v[132:135], v9 offset:26624
  s_waitcnt lgkmcnt(6)
  v_mfma_f32_16x16x32_bf16 v[88:91], v[136:139], a[44:47], v[88:91]
  s_add_u32 s42, s55, 8388608
  s_add_u32 s43, s56, 11010048
  v_mfma_f32_16x16x32_bf16 v[68:71], v[136:139], a[40:43], v[68:71]
  ds_read_b128 v[136:139], v9 offset:28672
  v_mfma_f32_16x16x32_bf16 v[92:95], v[140:143], a[44:47], v[92:95]
  v_mfma_f32_16x16x32_bf16 v[72:75], v[140:143], a[40:43], v[72:75]
  ds_read_b128 v[140:143], v9 offset:30720
  s_waitcnt lgkmcnt(6)
  v_mfma_f32_16x16x32_bf16 v[96:99], v[144:147], a[44:47], v[96:99]
  s_barrier
  v_mfma_f32_16x16x32_bf16 v[76:79], v[144:147], a[40:43], v[76:79]
  ds_read_b128 v[144:147], v9 offset:32768
  s_add_u32 m0, s30, 49152
  v_mfma_f32_16x16x32_bf16 v[100:103], v[148:151], a[44:47], v[100:103]
  s_add_u32 s45, s33, 73728
  buffer_load_dwordx4 v11, s[8:11], s45 offen lds
  v_mfma_f32_16x16x32_bf16 v[80:83], v[148:151], a[40:43], v[80:83]
  ds_read_b128 v[148:151], v9 offset:34816
  s_waitcnt vmcnt(13) lgkmcnt(6)
  v_mfma_f32_16x16x32_bf16 v[84:87], v[152:155], a[52:55], v[84:87]
  buffer_load_dwordx4 v11, s[8:11], s45 offen offset:1024 lds
  v_mfma_f32_16x16x32_bf16 v[64:67], v[152:155], a[48:51], v[64:67]
  ds_read_b128 v[152:155], v9 offset:36864
  v_mfma_f32_16x16x32_bf16 v[88:91], v[156:159], a[52:55], v[88:91]
  v_mfma_f32_16x16x32_bf16 v[68:71], v[156:159], a[48:51], v[68:71]
  ds_read_b128 v[156:159], v9 offset:38912
  s_waitcnt lgkmcnt(6)
  v_mfma_f32_16x16x32_bf16 v[92:95], v[128:131], a[52:55], v[92:95]
  s_add_u32 m0, s30, 57344
  s_add_u32 s45, s33, 81920
  v_mfma_f32_16x16x32_bf16 v[72:75], v[128:131], a[48:51], v[72:75]
  ds_read_b128 v[128:131], v9 offset:40960
  buffer_load_dwordx4 v11, s[8:11], s45 offen lds
  v_mfma_f32_16x16x32_bf16 v[96:99], v[132:135], a[52:55], v[96:99]
here_25:
  v_add_u32 v51, here_25-interleave_layers__linear_attn_block__dense_activation_squared_relu__prompt_kernel+1024, v38
  v_min_u32 v51, 57340, v51
  global_load_dword v49, v51, s[96:97]
  v_mfma_f32_16x16x32_bf16 v[76:79], v[132:135], a[48:51], v[76:79]
  ds_read_b128 v[132:135], v9 offset:43008
  s_waitcnt vmcnt(14) lgkmcnt(6)
  v_mfma_f32_16x16x32_bf16 v[100:103], v[136:139], a[52:55], v[100:103]
  v_mfma_f32_16x16x32_bf16 v[80:83], v[136:139], a[48:51], v[80:83]
  ds_read_b128 v[136:139], v9 offset:45056
  v_mfma_f32_16x16x32_bf16 v[84:87], v[140:143], a[60:63], v[84:87]
  v_mfma_f32_16x16x32_bf16 v[64:67], v[140:143], a[56:59], v[64:67]
  ds_read_b128 v[140:143], v9 offset:47104
  s_waitcnt lgkmcnt(6)
  v_mfma_f32_16x16x32_bf16 v[88:91], v[144:147], a[60:63], v[88:91]
  buffer_load_dwordx4 v11, s[8:11], s45 offen offset:1024 lds
  v_mfma_f32_16x16x32_bf16 v[68:71], v[144:147], a[56:59], v[68:71]
  ds_read_b128 v[144:147], v9 offset:49152
  v_mfma_f32_16x16x32_bf16 v[92:95], v[148:151], a[60:63], v[92:95]
  v_mfma_f32_16x16x32_bf16 v[72:75], v[148:151], a[56:59], v[72:75]
  ds_read_b128 v[148:151], v9 offset:51200
  s_waitcnt lgkmcnt(6)
  v_mfma_f32_16x16x32_bf16 v[96:99], v[152:155], a[60:63], v[96:99]
  s_add_u32 m0, s30, 65536
  s_add_u32 s45, s33, 90112
  v_mfma_f32_16x16x32_bf16 v[76:79], v[152:155], a[56:59], v[76:79]
  ds_read_b128 v[152:155], v9 offset:53248
  buffer_load_dwordx4 v11, s[8:11], s45 offen lds
  v_mfma_f32_16x16x32_bf16 v[100:103], v[156:159], a[60:63], v[100:103]
  v_mfma_f32_16x16x32_bf16 v[80:83], v[156:159], a[56:59], v[80:83]
  ds_read_b128 v[156:159], v9 offset:55296
  s_waitcnt vmcnt(14) lgkmcnt(6)
  v_mfma_f32_16x16x32_bf16 v[84:87], v[128:131], a[68:71], v[84:87]
  buffer_load_dwordx4 v11, s[8:11], s45 offen offset:1024 lds
  s_barrier
  v_mfma_f32_16x16x32_bf16 v[64:67], v[128:131], a[64:67], v[64:67]
  ds_read_b128 v[128:131], v9 offset:57344
  v_mfma_f32_16x16x32_bf16 v[88:91], v[132:135], a[68:71], v[88:91]
  v_mfma_f32_16x16x32_bf16 v[68:71], v[132:135], a[64:67], v[68:71]
  ds_read_b128 v[132:135], v9 offset:59392
  s_waitcnt lgkmcnt(6)
  v_mfma_f32_16x16x32_bf16 v[92:95], v[136:139], a[68:71], v[92:95]
  v_mfma_f32_16x16x32_bf16 v[72:75], v[136:139], a[64:67], v[72:75]
  s_add_u32 m0, s30, 73728
  s_add_u32 s45, s33, 98304
  v_mfma_f32_16x16x32_bf16 v[96:99], v[140:143], a[68:71], v[96:99]
  buffer_load_dwordx4 v11, s[8:11], s45 offen lds
  v_mfma_f32_16x16x32_bf16 v[76:79], v[140:143], a[64:67], v[76:79]
  s_waitcnt vmcnt(14) lgkmcnt(4)
  v_mfma_f32_16x16x32_bf16 v[100:103], v[144:147], a[68:71], v[100:103]
  v_mfma_f32_16x16x32_bf16 v[80:83], v[144:147], a[64:67], v[80:83]
  v_mfma_f32_16x16x32_bf16 v[84:87], v[148:151], a[76:79], v[84:87]
  buffer_load_dwordx4 v11, s[8:11], s45 offen offset:1024 lds
  v_mfma_f32_16x16x32_bf16 v[64:67], v[148:151], a[72:75], v[64:67]
  s_waitcnt lgkmcnt(2)
  v_mfma_f32_16x16x32_bf16 v[88:91], v[152:155], a[76:79], v[88:91]
  v_mfma_f32_16x16x32_bf16 v[68:71], v[152:155], a[72:75], v[68:71]
  v_mfma_f32_16x16x32_bf16 v[92:95], v[156:159], a[76:79], v[92:95]
  s_barrier
  v_mfma_f32_16x16x32_bf16 v[72:75], v[156:159], a[72:75], v[72:75]
  s_add_u32 m0, s30, 81920
  s_waitcnt lgkmcnt(0)
  v_mfma_f32_16x16x32_bf16 v[96:99], v[128:131], a[76:79], v[96:99]
  s_add_u32 s45, s33, 106496
  buffer_load_dwordx4 v11, s[8:11], s45 offen lds
  v_mfma_f32_16x16x32_bf16 v[76:79], v[128:131], a[72:75], v[76:79]
  v_mfma_f32_16x16x32_bf16 v[100:103], v[132:135], a[76:79], v[100:103]
  v_mfma_f32_16x16x32_bf16 v[80:83], v[132:135], a[72:75], v[80:83]
  ds_write_b128 v200, v[84:87]
  ds_write_b128 v200, v[88:91] offset:1024
  ds_write_b128 v200, v[92:95] offset:2048
  ds_write_b128 v200, v[96:99] offset:3072
  s_nop 2
  ds_write_b128 v200, v[100:103] offset:4096
  s_waitcnt lgkmcnt(0)
  s_barrier
  ds_read_b128 v[204:207], v201
  ds_read_b128 v[208:211], v201 offset:1024
  ds_read_b128 v[212:215], v201 offset:2048
  ds_read_b128 v[216:219], v201 offset:3072
  ds_read_b128 v[220:223], v201 offset:4096
  s_waitcnt lgkmcnt(4)
  v_pk_add_f32 v[64:65], v[64:65], v[204:205]
  buffer_load_dwordx4 v11, s[8:11], s45 offen offset:1024 lds
  v_pk_add_f32 v[66:67], v[66:67], v[206:207]
  s_waitcnt lgkmcnt(3)
  v_pk_add_f32 v[68:69], v[68:69], v[208:209]
  v_pk_add_f32 v[70:71], v[70:71], v[210:211]
  s_waitcnt lgkmcnt(2)
  v_pk_add_f32 v[72:73], v[72:73], v[212:213]
  s_add_u32 m0, s30, 90112
  s_add_u32 s45, s33, 114688
  buffer_load_dwordx4 v11, s[8:11], s45 offen lds
  v_pk_add_f32 v[74:75], v[74:75], v[214:215]
  s_waitcnt lgkmcnt(1)
  v_pk_add_f32 v[76:77], v[76:77], v[216:217]
  v_pk_add_f32 v[78:79], v[78:79], v[218:219]
  s_waitcnt lgkmcnt(0)
  v_pk_add_f32 v[80:81], v[80:81], v[220:221]
  buffer_load_dwordx4 v11, s[8:11], s45 offen offset:1024 lds
  v_pk_add_f32 v[82:83], v[82:83], v[222:223]
  v_cvt_pk_bf16_f32 v224, v64, v68
  v_cvt_pk_bf16_f32 v225, v65, v69
  v_cvt_pk_bf16_f32 v226, v66, v70
  v_cvt_pk_bf16_f32 v227, v67, v71
  v_cvt_pk_bf16_f32 v228, v72, v76
  v_cvt_pk_bf16_f32 v229, v73, v77
  v_cvt_pk_bf16_f32 v230, v74, v78
  v_cvt_pk_bf16_f32 v231, v75, v79
  v_cvt_pk_bf16_f32 v232, v80, v81
  v_cvt_pk_bf16_f32 v233, v82, v83
  s_cmp_eq_u32 s47, 0
  s_cbranch_scc1 st_safe_26
  buffer_store_dwordx4 v[224:227], v32, s[8:11], s41 offen
  buffer_store_dwordx4 v[228:231], v32, s[8:11], s41 offen offset:1024
  buffer_store_dwordx2 v[232:233], v33, s[8:11], s42 offen
  s_branch st_end_27
st_safe_26:
  buffer_store_dwordx4 v[224:227], v32, s[8:11], s41 offen sc1
  buffer_store_dwordx4 v[228:231], v32, s[8:11], s41 offen offset:1024 sc1
  buffer_store_dwordx2 v[232:233], v33, s[8:11], s42 offen sc1
st_end_27:
  v_mov_b32 v236, 0
  v_mov_b32 v237, 0
  v_dot2c_f32_bf16 v236, v224, v30
  v_dot2c_f32_bf16 v237, v224, v224
  v_dot2c_f32_bf16 v236, v225, v30
  v_dot2c_f32_bf16 v237, v225, v225
  v_dot2c_f32_bf16 v236, v226, v30
  v_dot2c_f32_bf16 v237, v226, v226
  v_dot2c_f32_bf16 v236, v227, v30
  v_dot2c_f32_bf16 v237, v227, v227
  v_dot2c_f32_bf16 v236, v228, v30
  v_dot2c_f32_bf16 v237, v228, v228
  v_dot2c_f32_bf16 v236, v229, v30
  v_dot2c_f32_bf16 v237, v229, v229
  v_dot2c_f32_bf16 v236, v230, v30
  v_dot2c_f32_bf16 v237, v230, v230
  v_dot2c_f32_bf16 v236, v231, v30
  v_dot2c_f32_bf16 v237, v231, v231
  v_dot2c_f32_bf16 v236, v232, v30
  v_dot2c_f32_bf16 v237, v232, v232
  v_dot2c_f32_bf16 v236, v233, v30
  v_dot2c_f32_bf16 v237, v233, v233
  s_nop 2
  v_permlane32_swap_b32 v236, v237
  v_add_f32 v236, v236, v237
  v_mov_b32 v238, v236
  s_nop 1
  v_permlane16_swap_b32 v236, v238
  v_add_f32 v236, v236, v238
  s_cmp_eq_u32 s47, 0
  s_cbranch_scc1 st_safe_28
  buffer_store_dword v236, v19, s[8:11], s43 offen
  s_branch st_end_29
st_safe_28:
  buffer_store_dword v236, v19, s[8:11], s43 offen sc1
st_end_29:
  s_waitcnt vmcnt(0)
  s_barrier
  s_lshl_b32 s41, s47, 2
  s_add_u32 s41, s41, s24
  s_cmp_lg_u32 s41, 1
  s_cbranch_scc1 noflag_30
  s_lshl_b32 s41, s26, 2
  v_mov_b32 v237, s41
  s_add_u32 s41, s92, 3
  v_mov_b32 v238, s41
  s_mov_b64 exec, 1
  buffer_store_dword v238, v237, s[8:11], s39 offen sc1
  s_mov_b64 exec, -1
noflag_30:
  s_cmp_lg_u32 s24, 2
  s_cbranch_scc1 noflag_31
  s_lshl_b32 s41, s26, 2
  v_mov_b32 v237, s41
  s_add_u32 s41, s92, 3
  v_mov_b32 v238, s41
  s_mov_b64 exec, 1
  buffer_store_dword v238, v237, s[8:11], s38 offen
  s_mov_b64 exec, -1
noflag_31:
  s_add_u32 m0, s30, 98304
  s_add_u32 s45, s33, 122880
  buffer_load_dwordx4 v11, s[8:11], s45 offen lds
  buffer_load_dwordx4 v11, s[8:11], s45 offen offset:1024 lds
  s_add_u32 m0, s30, 106496
  s_add_u32 s45, s33, 131072
  buffer_load_dwordx4 v11, s[8:11], s45 offen lds
  buffer_load_dwordx4 v11, s[8:11], s45 offen offset:1024 lds
  ds_read_b128 v[136:139], v7
  ds_read_b128 v[140:143], v7 offset:1024
  ds_read_b128 v[144:147], v7 offset:2048
  ds_read_b128 v[148:151], v7 offset:3072
  ds_read_b128 v[152:155], v7 offset:4096
  ds_read_b128 v[156:159], v7 offset:5120
  ds_read_b128 v[128:131], v7 offset:6144
  ds_read_b128 v[132:135], v7 offset:7168
  v_lshlrev_b32 v160, 16, v224
  v_and_b32 v164, 0xffff0000, v224
  v_lshlrev_b32 v161, 16, v225
  v_and_b32 v165, 0xffff0000, v225
  v_lshlrev_b32 v162, 16, v226
  v_and_b32 v166, 0xffff0000, v226
  v_lshlrev_b32 v163, 16, v227
  v_and_b32 v167, 0xffff0000, v227
  v_lshlrev_b32 v168, 16, v228
  v_and_b32 v172, 0xffff0000, v228
  v_lshlrev_b32 v169, 16, v229
  v_and_b32 v173, 0xffff0000, v229
  v_lshlrev_b32 v170, 16, v230
  v_and_b32 v174, 0xffff0000, v230
  v_lshlrev_b32 v171, 16, v231
  v_and_b32 v175, 0xffff0000, v231
  v_lshlrev_b32 v176, 16, v232
  v_and_b32 v177, 0xffff0000, v232
  v_lshlrev_b32 v178, 16, v233
  v_and_b32 v179, 0xffff0000, v233
  v_lshlrev_b32 v84, 16, v104
  v_and_b32 v88, 0xffff0000, v104
  v_lshlrev_b32 v85, 16, v105
  v_and_b32 v89, 0xffff0000, v105
  v_lshlrev_b32 v86, 16, v106
  v_and_b32 v90, 0xffff0000, v106
  v_lshlrev_b32 v87, 16, v107
  v_and_b32 v91, 0xffff0000, v107
  v_lshlrev_b32 v92, 16, v108
  v_and_b32 v96, 0xffff0000, v108
  v_lshlrev_b32 v93, 16, v109
  v_and_b32 v97, 0xffff0000, v109
  v_lshlrev_b32 v94, 16, v110
  v_and_b32 v98, 0xffff0000, v110
  v_lshlrev_b32 v95, 16, v111
  v_and_b32 v99, 0xffff0000, v111
  v_lshlrev_b32 v100, 16, v112
  v_and_b32 v101, 0xffff0000, v112
  v_lshlrev_b32 v102, 16, v113
  v_and_b32 v103, 0xffff0000, v113
  v_pk_add_f32 v[160:161], v[160:161], v[84:85]
  v_pk_add_f32 v[162:163], v[162:163], v[86:87]
  v_pk_add_f32 v[164:165], v[164:165], v[88:89]
  v_pk_add_f32 v[166:167], v[166:167], v[90:91]
  v_pk_add_f32 v[168:169], v[168:169], v[92:93]
  v_pk_add_f32 v[170:171], v[170:171], v[94:95]
  v_pk_add_f32 v[172:173], v[172:173], v[96:97]
  v_pk_add_f32 v[174:175], v[174:175], v[98:99]
  v_pk_add_f32 v[176:177], v[176:177], v[100:101]
  v_pk_add_f32 v[178:179], v[178:179], v[102:103]
  s_cmp_lg_u32 s24, 0
  s_cbranch_scc1 nopoll_32
  s_mov_b32 s50, 0
  s_mov_b64 s[94:95], 0
  s_add_u32 s42, s92, 3
  s_cmp_eq_u32 s47, 0
  s_cselect_b32 s43, 3, -1
poll_33:
  buffer_load_dword v238, v36, s[8:11], s38 offen sc1
  s_add_u32 s50, s50, 1
  s_waitcnt vmcnt(0)
  v_subrev_u32 v238, s42, v238
  v_cmp_ge_u32 vcc, 1, v238
  s_or_b64 s[94:95], s[94:95], vcc
  s_cmp_eq_u64 s[94:95], -1
  s_cbranch_scc1 nopoll_32
  s_and_b32 s41, s50, s43
  s_cbranch_scc1 pollnext_34
  buffer_load_dword v238, v36, s[8:11], s39 offen sc1
  s_waitcnt vmcnt(0)
  v_subrev_u32 v238, s42, v238
  v_cmp_ge_u32 vcc, 1, v238
  s_or_b64 s[94:95], s[94:95], vcc
  s_cmp_eq_u64 s[94:95], -1
  s_cbranch_scc1 nopoll_32
pollnext_34:
  s_cmp_lt_u32 s50, 0x80000
  s_cbranch_scc1 poll_33
nopoll_32:
  s_barrier
  s_add_u32 s46, s35, 8388608
  buffer_load_dwordx4 a[0:3], v12, s[8:11], s46 offen sc1
  buffer_load_dwordx4 a[4:7], v13, s[8:11], s46 offen sc1
  buffer_load_dwordx4 a[8:11], v12, s[8:11], s46 offen offset:1024 sc1
  buffer_load_dwordx4 a[12:15], v13, s[8:11], s46 offen offset:1024 sc1
  buffer_load_dwordx4 a[16:19], v12, s[8:11], s46 offen offset:2048 sc1
  buffer_load_dwordx4 a[20:23], v13, s[8:11], s46 offen offset:2048 sc1
  buffer_load_dwordx4 a[24:27], v12, s[8:11], s46 offen offset:3072 sc1
  buffer_load_dwordx4 a[28:31], v13, s[8:11], s46 offen offset:3072 sc1
  s_add_u32 s41, s37, 11010048
  buffer_load_dwordx2 v[200:201], v18, s[8:11], s41 offen sc1
  buffer_load_dwordx2 v[202:203], v18, s[8:11], s41 offen offset:1024 sc1
  buffer_load_dwordx2 v[204:205], v18, s[8:11], s41 offen offset:128 sc1
  buffer_load_dwordx2 v[206:207], v18, s[8:11], s41 offen offset:1152 sc1
  s_waitcnt vmcnt(10) lgkmcnt(6)
  v_mfma_f32_16x16x32_bf16 v[64:67], v[136:139], a[0:3], 0
  s_add_u32 s46, s35, 8392704
  buffer_load_dwordx4 a[32:35], v12, s[8:11], s46 offen sc1
  v_mfma_f32_16x16x32_bf16 v[68:71], v[136:139], a[4:7], 0
  ds_read_b128 v[136:139], v7 offset:8192
  buffer_load_dwordx4 a[36:39], v13, s[8:11], s46 offen sc1
  v_mfma_f32_16x16x32_bf16 v[72:75], v[140:143], a[0:3], 0
  buffer_load_dwordx4 a[40:43], v12, s[8:11], s46 offen offset:1024 sc1
  buffer_load_dwordx4 a[44:47], v13, s[8:11], s46 offen offset:1024 sc1
  v_mfma_f32_16x16x32_bf16 v[76:79], v[140:143], a[4:7], 0
  ds_read_b128 v[140:143], v7 offset:9216
  s_waitcnt lgkmcnt(6)
  v_mfma_f32_16x16x32_bf16 v[80:83], v[144:147], a[0:3], 0
  buffer_load_dwordx4 a[48:51], v12, s[8:11], s46 offen offset:2048 sc1
  buffer_load_dwordx4 a[52:55], v13, s[8:11], s46 offen offset:2048 sc1
  v_mfma_f32_16x16x32_bf16 v[84:87], v[144:147], a[4:7], 0
  ds_read_b128 v[144:147], v7 offset:10240
  buffer_load_dwordx4 a[56:59], v12, s[8:11], s46 offen offset:3072 sc1
  v_mfma_f32_16x16x32_bf16 v[88:91], v[148:151], a[0:3], 0
  buffer_load_dwordx4 a[60:63], v13, s[8:11], s46 offen offset:3072 sc1
  s_add_u32 s46, s35, 8396800
  v_mfma_f32_16x16x32_bf16 v[92:95], v[148:151], a[4:7], 0
  ds_read_b128 v[148:151], v7 offset:11264
  s_waitcnt vmcnt(16) lgkmcnt(6)
  v_mfma_f32_16x16x32_bf16 v[64:67], v[152:155], a[8:11], v[64:67]
  buffer_load_dwordx4 a[64:67], v12, s[8:11], s46 offen sc1
  buffer_load_dwordx4 a[68:71], v13, s[8:11], s46 offen sc1
  v_mfma_f32_16x16x32_bf16 v[68:71], v[152:155], a[12:15], v[68:71]
  ds_read_b128 v[152:155], v7 offset:12288
  v_mfma_f32_16x16x32_bf16 v[72:75], v[156:159], a[8:11], v[72:75]
  buffer_load_dwordx4 a[72:75], v12, s[8:11], s46 offen offset:1024 sc1
  v_mfma_f32_16x16x32_bf16 v[76:79], v[156:159], a[12:15], v[76:79]
  ds_read_b128 v[156:159], v7 offset:13312
  s_waitcnt lgkmcnt(6)
  v_mfma_f32_16x16x32_bf16 v[80:83], v[128:131], a[8:11], v[80:83]
  buffer_load_dwordx4 a[76:79], v13, s[8:11], s46 offen offset:1024 sc1
  v_mfma_f32_16x16x32_bf16 v[84:87], v[128:131], a[12:15], v[84:87]
  ds_read_b128 v[128:131], v7 offset:14336
  v_mfma_f32_16x16x32_bf16 v[88:91], v[132:135], a[8:11], v[88:91]
  buffer_load_dwordx4 a[80:83], v12, s[8:11], s46 offen offset:2048 sc1
  v_mfma_f32_16x16x32_bf16 v[92:95], v[132:135], a[12:15], v[92:95]
  ds_read_b128 v[132:135], v7 offset:15360
  s_waitcnt vmcnt(19) lgkmcnt(6)
  v_mfma_f32_16x16x32_bf16 v[64:67], v[136:139], a[16:19], v[64:67]
  v_mfma_f32_16x16x32_bf16 v[68:71], v[136:139], a[20:23], v[68:71]
  ds_read_b128 v[136:139], v7 offset:16384
  v_mfma_f32_16x16x32_bf16 v[72:75], v[140:143], a[16:19], v[72:75]
  v_mfma_f32_16x16x32_bf16 v[76:79], v[140:143], a[20:23], v[76:79]
  ds_read_b128 v[140:143], v7 offset:17408
  s_waitcnt lgkmcnt(6)
  v_mfma_f32_16x16x32_bf16 v[80:83], v[144:147], a[16:19], v[80:83]
  buffer_load_dwordx4 a[84:87], v13, s[8:11], s46 offen offset:2048 sc1
  v_mfma_f32_16x16x32_bf16 v[84:87], v[144:147], a[20:23], v[84:87]
  ds_read_b128 v[144:147], v7 offset:18432
  v_mfma_f32_16x16x32_bf16 v[88:91], v[148:151], a[16:19], v[88:91]
  v_mfma_f32_16x16x32_bf16 v[92:95], v[148:151], a[20:23], v[92:95]
  ds_read_b128 v[148:151], v7 offset:19456
  s_waitcnt vmcnt(18) lgkmcnt(6)
  v_mfma_f32_16x16x32_bf16 v[64:67], v[152:155], a[24:27], v[64:67]
  buffer_load_dwordx4 a[88:91], v12, s[8:11], s46 offen offset:3072 sc1
  v_mfma_f32_16x16x32_bf16 v[68:71], v[152:155], a[28:31], v[68:71]
  ds_read_b128 v[152:155], v7 offset:20480
  v_mfma_f32_16x16x32_bf16 v[72:75], v[156:159], a[24:27], v[72:75]
  v_mfma_f32_16x16x32_bf16 v[76:79], v[156:159], a[28:31], v[76:79]
  ds_read_b128 v[156:159], v7 offset:21504
  s_waitcnt lgkmcnt(6)
  v_mfma_f32_16x16x32_bf16 v[80:83], v[128:131], a[24:27], v[80:83]
  buffer_load_dwordx4 a[92:95], v13, s[8:11], s46 offen offset:3072 sc1
  v_mfma_f32_16x16x32_bf16 v[84:87], v[128:131], a[28:31], v[84:87]
  ds_read_b128 v[128:131], v7 offset:22528
  v_mfma_f32_16x16x32_bf16 v[88:91], v[132:135], a[24:27], v[88:91]
  v_mfma_f32_16x16x32_bf16 v[92:95], v[132:135], a[28:31], v[92:95]
  ds_read_b128 v[132:135], v7 offset:23552
  s_waitcnt vmcnt(14) lgkmcnt(6)
  v_mfma_f32_16x16x32_bf16 v[64:67], v[136:139], a[32:35], v[64:67]
  s_barrier
  v_mfma_f32_16x16x32_bf16 v[68:71], v[136:139], a[36:39], v[68:71]
  ds_read_b128 v[136:139], v7 offset:24576
  s_add_u32 s46, s35, 8400896
  v_mfma_f32_16x16x32_bf16 v[72:75], v[140:143], a[32:35], v[72:75]
  buffer_load_dwordx4 a[96:99], v12, s[8:11], s46 offen sc1
  v_mfma_f32_16x16x32_bf16 v[76:79], v[140:143], a[36:39], v[76:79]
  ds_read_b128 v[140:143], v7 offset:25600
  s_waitcnt lgkmcnt(6)
  v_mfma_f32_16x16x32_bf16 v[80:83], v[144:147], a[32:35], v[80:83]
  buffer_load_dwordx4 a[100:103], v13, s[8:11], s46 offen sc1
  v_mfma_f32_16x16x32_bf16 v[84:87], v[144:147], a[36:39], v[84:87]
  ds_read_b128 v[144:147], v7 offset:26624
  v_mfma_f32_16x16x32_bf16 v[88:91], v[148:151], a[32:35], v[88:91]
  v_mfma_f32_16x16x32_bf16 v[92:95], v[148:151], a[36:39], v[92:95]
  ds_read_b128 v[148:151], v7 offset:27648
  s_waitcnt vmcnt(14) lgkmcnt(6)
  v_mfma_f32_16x16x32_bf16 v[64:67], v[152:155], a[40:43], v[64:67]
  v_mfma_f32_16x16x32_bf16 v[68:71], v[152:155], a[44:47], v[68:71]
  ds_read_b128 v[152:155], v7 offset:28672
  buffer_load_dwordx4 a[104:107], v12, s[8:11], s46 offen offset:1024 sc1
  v_mfma_f32_16x16x32_bf16 v[72:75], v[156:159], a[40:43], v[72:75]
  v_mfma_f32_16x16x32_bf16 v[76:79], v[156:159], a[44:47], v[76:79]
  ds_read_b128 v[156:159], v7 offset:29696
  s_waitcnt lgkmcnt(6)
  v_mfma_f32_16x16x32_bf16 v[80:83], v[128:131], a[40:43], v[80:83]
  buffer_load_dwordx4 a[108:111], v13, s[8:11], s46 offen offset:1024 sc1
  v_mfma_f32_16x16x32_bf16 v[84:87], v[128:131], a[44:47], v[84:87]
  ds_read_b128 v[128:131], v7 offset:30720
  v_add_f32 v200, v200, v202
  v_mfma_f32_16x16x32_bf16 v[88:91], v[132:135], a[40:43], v[88:91]
  v_add_f32 v201, v201, v203
  v_mov_b32 v202, v200
  v_mfma_f32_16x16x32_bf16 v[92:95], v[132:135], a[44:47], v[92:95]
  ds_read_b128 v[132:135], v7 offset:31744
  s_waitcnt vmcnt(14) lgkmcnt(6)
  v_mfma_f32_16x16x32_bf16 v[64:67], v[136:139], a[48:51], v[64:67]
  v_mov_b32 v203, v201
  v_permlane32_swap_b32 v200, v202
  v_mfma_f32_16x16x32_bf16 v[68:71], v[136:139], a[52:55], v[68:71]
  ds_read_b128 v[136:139], v5 offset:8192
  buffer_load_dwordx4 a[112:115], v12, s[8:11], s46 offen offset:2048 sc1
  v_mfma_f32_16x16x32_bf16 v[72:75], v[140:143], a[48:51], v[72:75]
  v_permlane32_swap_b32 v201, v203
  v_add_f32 v200, v200, v202
  v_mfma_f32_16x16x32_bf16 v[76:79], v[140:143], a[52:55], v[76:79]
  ds_read_b128 v[140:143], v5 offset:9216
  s_waitcnt lgkmcnt(6)
  v_mfma_f32_16x16x32_bf16 v[80:83], v[144:147], a[48:51], v[80:83]
  buffer_load_dwordx4 a[116:119], v13, s[8:11], s46 offen offset:2048 sc1
  v_add_f32 v201, v201, v203
  v_mfma_f32_16x16x32_bf16 v[84:87], v[144:147], a[52:55], v[84:87]
  ds_read_b128 v[144:147], v5 offset:10240
  v_mov_b32 v202, v200
  v_mfma_f32_16x16x32_bf16 v[88:91], v[148:151], a[48:51], v[88:91]
  v_mov_b32 v203, v201
  v_permlane16_swap_b32 v200, v202
  v_mfma_f32_16x16x32_bf16 v[92:95], v[148:151], a[52:55], v[92:95]
  ds_read_b128 v[148:151], v5 offset:11264
  s_waitcnt vmcnt(14) lgkmcnt(6)
  v_mfma_f32_16x16x32_bf16 v[64:67], v[152:155], a[56:59], v[64:67]
  v_permlane16_swap_b32 v201, v203
  v_add_f32 v200, v200, v202
  v_mfma_f32_16x16x32_bf16 v[68:71], v[152:155], a[60:63], v[68:71]
  ds_read_b128 v[152:155], v5 offset:12288
  buffer_load_dwordx4 a[120:123], v12, s[8:11], s46 offen offset:3072 sc1
  v_mfma_f32_16x16x32_bf16 v[72:75], v[156:159], a[56:59], v[72:75]
  v_add_f32 v201, v201, v203
  v_mul_f32 v200, 0x3acccccd, v200
  v_mfma_f32_16x16x32_bf16 v[76:79], v[156:159], a[60:63], v[76:79]
  ds_read_b128 v[156:159], v5 offset:13312
  s_waitcnt lgkmcnt(6)
  v_mfma_f32_16x16x32_bf16 v[80:83], v[128:131], a[56:59], v[80:83]
  buffer_load_dwordx4 a[124:127], v13, s[8:11], s46 offen offset:3072 sc1
  v_mul_f32 v202, v200, v200
  v_mfma_f32_16x16x32_bf16 v[84:87], v[128:131], a[60:63], v[84:87]
  ds_read_b128 v[128:131], v5 offset:14336
  v_fma_f32 v201, v201, s63, -v202
  v_mfma_f32_16x16x32_bf16 v[88:91], v[132:135], a[56:59], v[88:91]
  v_max_f32 v201, 0, v201
  v_add_f32 v201, 0x3727c5ac, v201
  v_mfma_f32_16x16x32_bf16 v[92:95], v[132:135], a[60:63], v[92:95]
  ds_read_b128 v[132:135], v5 offset:15360
  s_waitcnt vmcnt(14) lgkmcnt(6)
  v_mfma_f32_16x16x32_bf16 v[64:67], v[136:139], a[64:67], v[64:67]
  v_rsq_f32 v202, v201
  v_cvt_pk_bf16_f32 v40, v200, v200
  v_mfma_f32_16x16x32_bf16 v[68:71], v[136:139], a[68:71], v[68:71]
  ds_read_b128 v[136:139], v5 offset:16384
  s_add_u32 s46, s35, 8404992
  v_mfma_f32_16x16x32_bf16 v[72:75], v[140:143], a[64:67], v[72:75]
  buffer_load_dwordx4 a[128:131], v12, s[8:11], s46 offen sc1
  v_mul_f32 v201, v201, v202
  v_mfma_f32_16x16x32_bf16 v[76:79], v[140:143], a[68:71], v[76:79]
  ds_read_b128 v[140:143], v5 offset:17408
  s_waitcnt lgkmcnt(6)
  v_mfma_f32_16x16x32_bf16 v[80:83], v[144:147], a[64:67], v[80:83]
  buffer_load_dwordx4 a[132:135], v13, s[8:11], s46 offen sc1
  ds_write_b32 v26, v202
  v_mfma_f32_16x16x32_bf16 v[84:87], v[144:147], a[68:71], v[84:87]
  ds_read_b128 v[144:147], v5 offset:18432
  v_mul_f32 v48, 0x3fb8aa3b, v202
  v_mfma_f32_16x16x32_bf16 v[88:91], v[148:151], a[64:67], v[88:91]
  v_lshlrev_b32 v203, 16, v40
  v_sub_f32 v200, v200, v203
  v_mfma_f32_16x16x32_bf16 v[92:95], v[148:151], a[68:71], v[92:95]
  ds_read_b128 v[148:151], v5 offset:19456
  s_waitcnt vmcnt(14) lgkmcnt(7)
  v_mfma_f32_16x16x32_bf16 v[64:67], v[152:155], a[72:75], v[64:67]
  v_cvt_pk_bf16_f32 v41, v200, v201
  v_and_b32 v203, 0xffff0000, v41
  v_mfma_f32_16x16x32_bf16 v[68:71], v[152:155], a[76:79], v[68:71]
  ds_read_b128 v[152:155], v5 offset:20480
  buffer_load_dwordx4 a[136:139], v12, s[8:11], s46 offen offset:1024 sc1
  v_mfma_f32_16x16x32_bf16 v[72:75], v[156:159], a[72:75], v[72:75]
  v_sub_f32 v203, v201, v203
  v_cvt_pk_bf16_f32 v43, v200, v203
  v_mfma_f32_16x16x32_bf16 v[76:79], v[156:159], a[76:79], v[76:79]
  ds_read_b128 v[156:159], v5 offset:21504
  s_waitcnt lgkmcnt(7)
  v_mfma_f32_16x16x32_bf16 v[80:83], v[128:131], a[72:75], v[80:83]
  buffer_load_dwordx4 a[140:143], v13, s[8:11], s46 offen offset:1024 sc1
  v_mov_b32 v42, v40
  v_mfma_f32_16x16x32_bf16 v[84:87], v[128:131], a[76:79], v[84:87]
  ds_read_b128 v[128:131], v5 offset:22528
  v_add_f32 v204, v204, v206
  v_mfma_f32_16x16x32_bf16 v[88:91], v[132:135], a[72:75], v[88:91]
  v_add_f32 v205, v205, v207
  v_mov_b32 v206, v204
  v_mfma_f32_16x16x32_bf16 v[92:95], v[132:135], a[76:79], v[92:95]
  ds_read_b128 v[132:135], v5 offset:23552
  s_waitcnt vmcnt(14) lgkmcnt(7)
  v_mfma_f32_16x16x32_bf16 v[64:67], v[136:139], a[80:83], v[64:67]
  s_barrier
  v_mfma_f32_16x16x32_bf16 v[68:71], v[136:139], a[84:87], v[68:71]
  ds_read_b128 v[136:139], v5 offset:24576
  buffer_load_dwordx4 a[144:147], v12, s[8:11], s46 offen offset:2048 sc1
  v_mfma_f32_16x16x32_bf16 v[72:75], v[140:143], a[80:83], v[72:75]
  v_mov_b32 v207, v205
  v_permlane32_swap_b32 v204, v206
  v_mfma_f32_16x16x32_bf16 v[76:79], v[140:143], a[84:87], v[76:79]
  ds_read_b128 v[140:143], v5 offset:25600
  s_waitcnt lgkmcnt(6)
  v_mfma_f32_16x16x32_bf16 v[80:83], v[144:147], a[80:83], v[80:83]
  buffer_load_dwordx4 a[148:151], v13, s[8:11], s46 offen offset:2048 sc1
  v_permlane32_swap_b32 v205, v207
  v_mfma_f32_16x16x32_bf16 v[84:87], v[144:147], a[84:87], v[84:87]
  ds_read_b128 v[144:147], v5 offset:26624
  v_add_f32 v204, v204, v206
  v_mfma_f32_16x16x32_bf16 v[88:91], v[148:151], a[80:83], v[88:91]
  v_add_f32 v205, v205, v207
  v_mov_b32 v206, v204
  v_mfma_f32_16x16x32_bf16 v[92:95], v[148:151], a[84:87], v[92:95]
  ds_read_b128 v[148:151], v5 offset:27648
  s_waitcnt vmcnt(14) lgkmcnt(6)
  v_mfma_f32_16x16x32_bf16 v[64:67], v[152:155], a[88:91], v[64:67]
  v_mov_b32 v207, v205
  v_permlane16_swap_b32 v204, v206
  v_mfma_f32_16x16x32_bf16 v[68:71], v[152:155], a[92:95], v[68:71]
  ds_read_b128 v[152:155], v5 offset:28672
  buffer_load_dwordx4 a[152:155], v12, s[8:11], s46 offen offset:3072 sc1
  v_mfma_f32_16x16x32_bf16 v[72:75], v[156:159], a[88:91], v[72:75]
  v_permlane16_swap_b32 v205, v207
  v_add_f32 v204, v204, v206
  v_mfma_f32_16x16x32_bf16 v[76:79], v[156:159], a[92:95], v[76:79]
  ds_read_b128 v[156:159], v5 offset:29696
  s_waitcnt lgkmcnt(6)
  v_mfma_f32_16x16x32_bf16 v[80:83], v[128:131], a[88:91], v[80:83]
  buffer_load_dwordx4 a[156:159], v13, s[8:11], s46 offen offset:3072 sc1
  v_add_f32 v205, v205, v207
  v_mfma_f32_16x16x32_bf16 v[84:87], v[128:131], a[92:95], v[84:87]
  ds_read_b128 v[128:131], v5 offset:30720
  v_mul_f32 v204, 0x3acccccd, v204
  v_mfma_f32_16x16x32_bf16 v[88:91], v[132:135], a[88:91], v[88:91]
  v_mul_f32 v206, v204, v204
  v_fma_f32 v205, v205, s63, -v206
  v_mfma_f32_16x16x32_bf16 v[92:95], v[132:135], a[92:95], v[92:95]
  ds_read_b128 v[132:135], v5 offset:31744
  s_waitcnt vmcnt(14) lgkmcnt(6)
  v_mfma_f32_16x16x32_bf16 v[64:67], v[136:139], a[96:99], v[64:67]
  v_max_f32 v205, 0, v205
  v_add_f32 v205, 0x3727c5ac, v205
  v_mfma_f32_16x16x32_bf16 v[68:71], v[136:139], a[100:103], v[68:71]
  ds_read_b128 v[136:139], v5 offset:32768
  s_add_u32 m0, s30, 114688
  v_mfma_f32_16x16x32_bf16 v[72:75], v[140:143], a[96:99], v[72:75]
  s_add_u32 s45, s33, 139264
  buffer_load_dwordx4 v11, s[8:11], s45 offen lds
  v_mfma_f32_16x16x32_bf16 v[76:79], v[140:143], a[100:103], v[76:79]
  ds_read_b128 v[140:143], v5 offset:33792
  s_waitcnt lgkmcnt(6)
  v_mfma_f32_16x16x32_bf16 v[80:83], v[144:147], a[96:99], v[80:83]
  v_rsq_f32 v206, v205
  v_cvt_pk_bf16_f32 v44, v204, v204
  v_mfma_f32_16x16x32_bf16 v[84:87], v[144:147], a[100:103], v[84:87]
  ds_read_b128 v[144:147], v5 offset:34816
  v_mul_f32 v205, v205, v206
  v_mfma_f32_16x16x32_bf16 v[88:91], v[148:151], a[96:99], v[88:91]
  buffer_load_dwordx4 v11, s[8:11], s45 offen offset:1024 lds
  ds_write_b32 v26, v206 offset:64
  v_mfma_f32_16x16x32_bf16 v[92:95], v[148:151], a[100:103], v[92:95]
  ds_read_b128 v[148:151], v5 offset:35840
  s_waitcnt vmcnt(14) lgkmcnt(7)
  v_mfma_f32_16x16x32_bf16 v[64:67], v[152:155], a[104:107], v[64:67]
  v_mul_f32 v50, 0x3fb8aa3b, v206
  v_lshlrev_b32 v207, 16, v44
  v_mfma_f32_16x16x32_bf16 v[68:71], v[152:155], a[108:111], v[68:71]
  ds_read_b128 v[152:155], v5 offset:36864
  v_sub_f32 v204, v204, v207
  v_mfma_f32_16x16x32_bf16 v[72:75], v[156:159], a[104:107], v[72:75]
  v_cvt_pk_bf16_f32 v45, v204, v205
  s_add_u32 m0, s30, 122880
  v_mfma_f32_16x16x32_bf16 v[76:79], v[156:159], a[108:111], v[76:79]
  ds_read_b128 v[156:159], v5 offset:37888
  s_waitcnt lgkmcnt(7)
  v_mfma_f32_16x16x32_bf16 v[80:83], v[128:131], a[104:107], v[80:83]
  s_add_u32 s45, s33, 147456
  s_cmp_ge_u32 s24, 2
  s_cbranch_scc1 nopad_35
  buffer_load_dwordx4 v11, s[8:11], s45 offen lds
nopad_35:
  v_mfma_f32_16x16x32_bf16 v[84:87], v[128:131], a[108:111], v[84:87]
  ds_read_b128 v[128:131], v5 offset:38912
here_36:
  v_add_u32 v51, here_36-interleave_layers__linear_attn_block__dense_activation_squared_relu__prompt_kernel+1024, v38
  v_min_u32 v51, 57340, v51
  global_load_dword v49, v51, s[96:97]
  v_mfma_f32_16x16x32_bf16 v[88:91], v[132:135], a[104:107], v[88:91]
  v_and_b32 v207, 0xffff0000, v45
  s_cmp_ge_u32 s24, 1
  s_cbranch_scc1 nopad_37
  buffer_load_dwordx4 v11, s[8:11], s45 offen offset:1024 lds
nopad_37:
  v_mfma_f32_16x16x32_bf16 v[92:95], v[132:135], a[108:111], v[92:95]
  ds_read_b128 v[132:135], v5 offset:39936
  s_waitcnt vmcnt(13) lgkmcnt(7)
  v_mfma_f32_16x16x32_bf16 v[64:67], v[136:139], a[112:115], v[64:67]
  s_add_u32 m0, s30, 131072
  s_add_u32 s45, s34, 0
  v_mfma_f32_16x16x32_bf16 v[68:71], v[136:139], a[116:119], v[68:71]
  ds_read_b128 v[136:139], v5 offset:40960
  buffer_load_dwordx4 v11, s[8:11], s45 offen lds
  v_mfma_f32_16x16x32_bf16 v[72:75], v[140:143], a[112:115], v[72:75]
  v_sub_f32 v207, v205, v207
  v_cvt_pk_bf16_f32 v47, v204, v207
  v_mfma_f32_16x16x32_bf16 v[76:79], v[140:143], a[116:119], v[76:79]
  ds_read_b128 v[140:143], v5 offset:41984
  s_waitcnt lgkmcnt(6)
  v_mfma_f32_16x16x32_bf16 v[80:83], v[144:147], a[112:115], v[80:83]
  buffer_load_dwordx4 v11, s[8:11], s45 offen offset:1024 lds
  v_mov_b32 v46, v44
  v_mfma_f32_16x16x32_bf16 v[84:87], v[144:147], a[116:119], v[84:87]
  ds_read_b128 v[144:147], v5 offset:43008
  v_add_u32 v55, 40960, v11
  v_mfma_f32_16x16x32_bf16 v[88:91], v[148:151], a[112:115], v[88:91]
  ds_read_b128 v[180:183], v55
  ds_read_b128 v[184:187], v55 offset:1024
  v_mfma_f32_16x16x32_bf16 v[92:95], v[148:151], a[116:119], v[92:95]
  ds_read_b128 v[148:151], v5 offset:44032
  s_waitcnt vmcnt(13) lgkmcnt(8)
  v_mfma_f32_16x16x32_bf16 v[64:67], v[152:155], a[120:123], v[64:67]
  s_add_u32 m0, s30, 139264
  s_add_u32 s45, s34, 8192
  v_mfma_f32_16x16x32_bf16 v[68:71], v[152:155], a[124:127], v[68:71]
  ds_read_b128 v[152:155], v5 offset:45056
  buffer_load_dwordx4 v11, s[8:11], s45 offen lds
  v_mfma_f32_16x16x32_bf16 v[72:75], v[156:159], a[120:123], v[72:75]
  v_mfma_f32_16x16x32_bf16 v[76:79], v[156:159], a[124:127], v[76:79]
  ds_read_b128 v[156:159], v5 offset:46080
  s_waitcnt lgkmcnt(8)
  v_mfma_f32_16x16x32_bf16 v[80:83], v[128:131], a[120:123], v[80:83]
  v_mfma_f32_16x16x32_bf16 v[84:87], v[128:131], a[124:127], v[84:87]
  ds_read_b128 v[128:131], v5 offset:47104
  buffer_load_dwordx4 v11, s[8:11], s45 offen offset:1024 lds
  v_mfma_f32_16x16x32_bf16 v[88:91], v[132:135], a[120:123], v[88:91]
  v_mfma_f32_16x16x32_bf16 v[92:95], v[132:135], a[124:127], v[92:95]
  ds_read_b128 v[132:135], v5 offset:48128
  s_waitcnt vmcnt(13) lgkmcnt(8)
  v_mfma_f32_16x16x32_bf16 v[64:67], v[136:139], a[128:131], v[64:67]
  s_waitcnt lgkmcnt(5)
  s_barrier
  v_mfma_f32_16x16x32_bf16 v[68:71], v[136:139], a[132:135], v[68:71]
  ds_read_b128 v[136:139], v5 offset:49152
  s_add_u32 m0, s30, 147456
  v_mfma_f32_16x16x32_bf16 v[72:75], v[140:143], a[128:131], v[72:75]
  s_add_u32 s45, s34, 16384
  buffer_load_dwordx4 v11, s[8:11], s45 offen lds
  v_mfma_f32_16x16x32_bf16 v[76:79], v[140:143], a[132:135], v[76:79]
  ds_read_b128 v[140:143], v5 offset:50176
  s_waitcnt lgkmcnt(6)
  v_mfma_f32_16x16x32_bf16 v[80:83], v[144:147], a[128:131], v[80:83]
  v_add_u32 v55, 49152, v11
  ds_read_b128 v[188:191], v55
  v_mfma_f32_16x16x32_bf16 v[84:87], v[144:147], a[132:135], v[84:87]
  ds_read_b128 v[144:147], v5 offset:51200
  buffer_load_dwordx4 v11, s[8:11], s45 offen offset:1024 lds
  v_mfma_f32_16x16x32_bf16 v[88:91], v[148:151], a[128:131], v[88:91]
  ds_read_b128 v[192:195], v55 offset:1024
  v_add_u32 v55, 57344, v11
  v_mfma_f32_16x16x32_bf16 v[92:95], v[148:151], a[132:135], v[92:95]
  ds_read_b128 v[148:151], v5 offset:52224
  s_waitcnt vmcnt(13) lgkmcnt(8)
  v_mfma_f32_16x16x32_bf16 v[64:67], v[152:155], a[136:139], v[64:67]
  ds_read_b128 v[196:199], v55
  ds_read_b128 v[240:243], v55 offset:1024
  v_mfma_f32_16x16x32_bf16 v[68:71], v[152:155], a[140:143], v[68:71]
  ds_read_b128 v[152:155], v5 offset:53248
  v_add_u32 v55, 65536, v11
  v_mfma_f32_16x16x32_bf16 v[72:75], v[156:159], a[136:139], v[72:75]
  s_add_u32 m0, s30, 155648
  s_add_u32 s45, s34, 24576
  v_mfma_f32_16x16x32_bf16 v[76:79], v[156:159], a[140:143], v[76:79]
  ds_read_b128 v[156:159], v5 offset:54272
  s_waitcnt lgkmcnt(10)
  v_mfma_f32_16x16x32_bf16 v[80:83], v[128:131], a[136:139], v[80:83]
  buffer_load_dwordx4 v11, s[8:11], s45 offen lds
  ds_read_b128 v[244:247], v55
  v_mfma_f32_16x16x32_bf16 v[84:87], v[128:131], a[140:143], v[84:87]
  ds_read_b128 v[128:131], v5 offset:55296
  ds_read_b128 v[248:251], v55 offset:1024
  v_mfma_f32_16x16x32_bf16 v[88:91], v[132:135], a[136:139], v[88:91]
  v_mfma_f32_16x16x32_bf16 v[92:95], v[132:135], a[140:143], v[92:95]
  ds_read_b128 v[132:135], v5 offset:56320
  s_waitcnt vmcnt(12) lgkmcnt(12)
  v_mfma_f32_16x16x32_bf16 v[64:67], v[136:139], a[144:147], v[64:67]
  buffer_load_dwordx4 v11, s[8:11], s45 offen offset:1024 lds
  v_mfma_f32_16x16x32_bf16 v[68:71], v[136:139], a[148:151], v[68:71]
  ds_read_b128 v[136:139], v5 offset:57344
  v_mfma_f32_16x16x32_bf16 v[72:75], v[140:143], a[144:147], v[72:75]
  v_mfma_f32_16x16x32_bf16 v[76:79], v[140:143], a[148:151], v[76:79]
  ds_read_b128 v[140:143], v5 offset:58368
  s_waitcnt lgkmcnt(10)
  v_mfma_f32_16x16x32_bf16 v[80:83], v[144:147], a[144:147], v[80:83]
  s_add_u32 m0, s30, 8192
  s_add_u32 s45, s34, 32768
  v_mfma_f32_16x16x32_bf16 v[84:87], v[144:147], a[148:151], v[84:87]
  ds_read_b128 v[144:147], v5 offset:59392
  buffer_load_dwordx4 v11, s[8:11], s45 offen lds
  v_mfma_f32_16x16x32_bf16 v[88:91], v[148:151], a[144:147], v[88:91]
  v_mfma_f32_16x16x32_bf16 v[92:95], v[148:151], a[148:151], v[92:95]
  ds_read_b128 v[148:151], v5 offset:60416
  s_waitcnt vmcnt(12) lgkmcnt(8)
  v_mfma_f32_16x16x32_bf16 v[64:67], v[152:155], a[152:155], v[64:67]
  buffer_load_dwordx4 v11, s[8:11], s45 offen offset:1024 lds
  v_mfma_f32_16x16x32_bf16 v[68:71], v[152:155], a[156:159], v[68:71]
  ds_read_b128 v[152:155], v5 offset:61440
  v_mfma_f32_16x16x32_bf16 v[72:75], v[156:159], a[152:155], v[72:75]
  v_mfma_f32_16x16x32_bf16 v[76:79], v[156:159], a[156:159], v[76:79]
  ds_read_b128 v[156:159], v5 offset:62464
  s_waitcnt lgkmcnt(6)
  v_mfma_f32_16x16x32_bf16 v[80:83], v[128:131], a[152:155], v[80:83]
  v_mfma_f32_16x16x32_bf16 v[84:87], v[128:131], a[156:159], v[84:87]
  ds_read_b128 v[128:131], v5 offset:63488
  s_add_u32 m0, s30, 16384
  v_mfma_f32_16x16x32_bf16 v[88:91], v[132:135], a[152:155], v[88:91]
  s_add_u32 s45, s34, 40960
  buffer_load_dwordx4 v11, s[8:11], s45 offen lds
  v_mfma_f32_16x16x32_bf16 v[92:95], v[132:135], a[156:159], v[92:95]
  ds_read_b128 v[132:135], v5 offset:64512
  s_waitcnt lgkmcnt(6)
  v_mfma_f32_16x16x32_bf16 v[64:67], v[136:139], v[40:43], v[64:67]
  v_mfma_f32_16x16x32_bf16 v[68:71], v[136:139], v[44:47], v[68:71]
  ds_read_b128 v[136:139], v6
  v_mfma_f32_16x16x32_bf16 v[72:75], v[140:143], v[40:43], v[72:75]
  buffer_load_dwordx4 v11, s[8:11], s45 offen offset:1024 lds
  v_mfma_f32_16x16x32_bf16 v[76:79], v[140:143], v[44:47], v[76:79]
  ds_read_b128 v[140:143], v6 offset:1024
  s_waitcnt lgkmcnt(6)
  v_mfma_f32_16x16x32_bf16 v[80:83], v[144:147], v[40:43], v[80:83]
  v_mfma_f32_16x16x32_bf16 v[84:87], v[144:147], v[44:47], v[84:87]
  ds_read_b128 v[144:147], v6 offset:2048
  v_mfma_f32_16x16x32_bf16 v[88:91], v[148:151], v[40:43], v[88:91]
  v_mfma_f32_16x16x32_bf16 v[92:95], v[148:151], v[44:47], v[92:95]
  ds_read_b128 v[148:151], v6 offset:3072
  s_waitcnt lgkmcnt(6)
  v_mfma_f32_16x16x32_bf16 v[96:99], v[152:155], a[0:3], 0
  s_add_u32 s43, s59, 13762560
  v_mul_f32_e64 v64, v64, |v64|
  v_mfma_f32_16x16x32_bf16 v[100:103], v[152:155], a[4:7], 0
  ds_read_b128 v[152:155], v6 offset:4096
  v_mul_f32_e64 v72, v72, |v72|
  v_mfma_f32_16x16x32_bf16 v[104:107], v[156:159], a[0:3], 0
  v_cvt_pk_bf16_f32 v216, v64, v72
  v_pk_max_i16 v216, v216, 0
  v_mfma_f32_16x16x32_bf16 v[108:111], v[156:159], a[4:7], 0
  ds_read_b128 v[156:159], v6 offset:5120
  s_waitcnt lgkmcnt(6)
  v_mfma_f32_16x16x32_bf16 v[112:115], v[128:131], a[0:3], 0
  v_mul_f32_e64 v65, v65, |v65|
  v_mul_f32_e64 v73, v73, |v73|
  v_mfma_f32_16x16x32_bf16 v[116:119], v[128:131], a[4:7], 0
  ds_read_b128 v[128:131], v6 offset:6144
  v_cvt_pk_bf16_f32 v217, v65, v73
  v_mfma_f32_16x16x32_bf16 v[96:99], v[132:135], a[8:11], v[96:99]
  v_pk_max_i16 v217, v217, 0
  s_add_u32 m0, s30, 24576
  v_mfma_f32_16x16x32_bf16 v[100:103], v[132:135], a[12:15], v[100:103]
  ds_read_b128 v[132:135], v6 offset:7168
  s_waitcnt lgkmcnt(6)
  v_mfma_f32_16x16x32_bf16 v[104:107], v[136:139], a[8:11], v[104:107]
  s_add_u32 s45, s34, 49152
  buffer_load_dwordx4 v11, s[8:11], s45 offen lds
  buffer_load_dwordx4 v11, s[8:11], s45 offen offset:1024 lds
  s_barrier
  v_mfma_f32_16x16x32_bf16 v[108:111], v[136:139], a[12:15], v[108:111]
  ds_read_b128 v[136:139], v6 offset:8192
  v_mul_f32_e64 v66, v66, |v66|
  v_mfma_f32_16x16x32_bf16 v[112:115], v[140:143], a[8:11], v[112:115]
  v_mul_f32_e64 v74, v74, |v74|
  v_cvt_pk_bf16_f32 v218, v66, v74
  v_mfma_f32_16x16x32_bf16 v[116:119], v[140:143], a[12:15], v[116:119]
  ds_read_b128 v[140:143], v6 offset:9216
  s_waitcnt lgkmcnt(6)
  v_mfma_f32_16x16x32_bf16 v[96:99], v[144:147], a[16:19], v[96:99]
  v_pk_max_i16 v218, v218, 0
  v_mul_f32_e64 v67, v67, |v67|
  v_mfma_f32_16x16x32_bf16 v[100:103], v[144:147], a[20:23], v[100:103]
  ds_read_b128 v[144:147], v6 offset:10240
  s_add_u32 m0, s30, 32768
  v_mfma_f32_16x16x32_bf16 v[104:107], v[148:151], a[16:19], v[104:107]
  s_add_u32 s45, s34, 57344
  buffer_load_dwordx4 v11, s[8:11], s45 offen lds
  v_mfma_f32_16x16x32_bf16 v[108:111], v[148:151], a[20:23], v[108:111]
  ds_read_b128 v[148:151], v6 offset:11264
  s_waitcnt lgkmcnt(6)
  v_mfma_f32_16x16x32_bf16 v[112:115], v[152:155], a[16:19], v[112:115]
  v_mul_f32_e64 v75, v75, |v75|
  v_cvt_pk_bf16_f32 v219, v67, v75
  v_mfma_f32_16x16x32_bf16 v[116:119], v[152:155], a[20:23], v[116:119]
  ds_read_b128 v[152:155], v6 offset:12288
  v_pk_max_i16 v219, v219, 0
  v_mfma_f32_16x16x32_bf16 v[96:99], v[156:159], a[24:27], v[96:99]
  buffer_store_dwordx4 v[216:219], v34, s[8:11], s43 offen sc1
  v_mul_f32_e64 v80, v80, |v80|
  v_mfma_f32_16x16x32_bf16 v[100:103], v[156:159], a[28:31], v[100:103]
  ds_read_b128 v[156:159], v6 offset:13312
  s_waitcnt lgkmcnt(6)
  v_mfma_f32_16x16x32_bf16 v[104:107], v[128:131], a[24:27], v[104:107]
  v_mul_f32_e64 v88, v88, |v88|
  v_cvt_pk_bf16_f32 v220, v80, v88
  v_mfma_f32_16x16x32_bf16 v[108:111], v[128:131], a[28:31], v[108:111]
  ds_read_b128 v[128:131], v6 offset:14336
  v_pk_max_i16 v220, v220, 0
  v_mfma_f32_16x16x32_bf16 v[112:115], v[132:135], a[24:27], v[112:115]
  v_mul_f32_e64 v81, v81, |v81|
  v_mul_f32_e64 v89, v89, |v89|
  v_mfma_f32_16x16x32_bf16 v[116:119], v[132:135], a[28:31], v[116:119]
  ds_read_b128 v[132:135], v6 offset:15360
  s_waitcnt lgkmcnt(6)
  v_mfma_f32_16x16x32_bf16 v[96:99], v[136:139], a[32:35], v[96:99]
  buffer_load_dwordx4 v11, s[8:11], s45 offen offset:1024 lds
  v_cvt_pk_bf16_f32 v221, v81, v89
  v_mfma_f32_16x16x32_bf16 v[100:103], v[136:139], a[36:39], v[100:103]
  ds_read_b128 v[136:139], v6 offset:16384
  v_pk_max_i16 v221, v221, 0
  v_mfma_f32_16x16x32_bf16 v[104:107], v[140:143], a[32:35], v[104:107]
  v_mul_f32_e64 v82, v82, |v82|
  v_mul_f32_e64 v90, v90, |v90|
  v_mfma_f32_16x16x32_bf16 v[108:111], v[140:143], a[36:39], v[108:111]
  ds_read_b128 v[140:143], v6 offset:17408
  s_waitcnt lgkmcnt(6)
  v_mfma_f32_16x16x32_bf16 v[112:115], v[144:147], a[32:35], v[112:115]
  v_cvt_pk_bf16_f32 v222, v82, v90
  v_pk_max_i16 v222, v222, 0
  v_mfma_f32_16x16x32_bf16 v[116:119], v[144:147], a[36:39], v[116:119]
  ds_read_b128 v[144:147], v6 offset:18432
  s_add_u32 m0, s30, 40960
  v_mfma_f32_16x16x32_bf16 v[96:99], v[148:151], a[40:43], v[96:99]
  s_add_u32 s45, s34, 65536
  buffer_load_dwordx4 v11, s[8:11], s45 offen lds
  v_mfma_f32_16x16x32_bf16 v[100:103], v[148:151], a[44:47], v[100:103]
  ds_read_b128 v[148:151], v6 offset:19456
  s_waitcnt lgkmcnt(6)
  v_mfma_f32_16x16x32_bf16 v[104:107], v[152:155], a[40:43], v[104:107]
  v_mul_f32_e64 v83, v83, |v83|
  v_mul_f32_e64 v91, v91, |v91|
  v_mfma_f32_16x16x32_bf16 v[108:111], v[152:155], a[44:47], v[108:111]
  ds_read_b128 v[152:155], v6 offset:20480
  v_cvt_pk_bf16_f32 v223, v83, v91
  v_mfma_f32_16x16x32_bf16 v[112:115], v[156:159], a[40:43], v[112:115]
  v_pk_max_i16 v223, v223, 0
  buffer_store_dwordx4 v[220:223], v34, s[8:11], s43 offen offset:1024 sc1
  v_mfma_f32_16x16x32_bf16 v[116:119], v[156:159], a[44:47], v[116:119]
  ds_read_b128 v[156:159], v6 offset:21504
  s_waitcnt lgkmcnt(6)
  v_mfma_f32_16x16x32_bf16 v[96:99], v[128:131], a[48:51], v[96:99]
  s_add_u32 s44, s59, 13817856
  v_mul_f32_e64 v68, v68, |v68|
  v_mfma_f32_16x16x32_bf16 v[100:103], v[128:131], a[52:55], v[100:103]
  ds_read_b128 v[128:131], v6 offset:22528
  v_mul_f32_e64 v76, v76, |v76|
  v_mfma_f32_16x16x32_bf16 v[104:107], v[132:135], a[48:51], v[104:107]
  v_cvt_pk_bf16_f32 v224, v68, v76
  v_pk_max_i16 v224, v224, 0
  v_mfma_f32_16x16x32_bf16 v[108:111], v[132:135], a[52:55], v[108:111]
  ds_read_b128 v[132:135], v6 offset:23552
  s_waitcnt lgkmcnt(6)
  v_mfma_f32_16x16x32_bf16 v[112:115], v[136:139], a[48:51], v[112:115]
  buffer_load_dwordx4 v11, s[8:11], s45 offen offset:1024 lds
  v_mul_f32_e64 v69, v69, |v69|
  v_mfma_f32_16x16x32_bf16 v[116:119], v[136:139], a[52:55], v[116:119]
  ds_read_b128 v[136:139], v6 offset:24576
  v_mul_f32_e64 v77, v77, |v77|
  v_mfma_f32_16x16x32_bf16 v[96:99], v[140:143], a[56:59], v[96:99]
  v_cvt_pk_bf16_f32 v225, v69, v77
  v_pk_max_i16 v225, v225, 0
  v_mfma_f32_16x16x32_bf16 v[100:103], v[140:143], a[60:63], v[100:103]
  ds_read_b128 v[140:143], v6 offset:25600
  s_waitcnt lgkmcnt(6)
  v_mfma_f32_16x16x32_bf16 v[104:107], v[144:147], a[56:59], v[104:107]
  v_mul_f32_e64 v70, v70, |v70|
  v_mul_f32_e64 v78, v78, |v78|
  v_mfma_f32_16x16x32_bf16 v[108:111], v[144:147], a[60:63], v[108:111]
  ds_read_b128 v[144:147], v6 offset:26624
  v_cvt_pk_bf16_f32 v226, v70, v78
  v_mfma_f32_16x16x32_bf16 v[112:115], v[148:151], a[56:59], v[112:115]
  s_add_u32 m0, s30, 49152
  s_add_u32 s45, s34, 73728
  v_mfma_f32_16x16x32_bf16 v[116:119], v[148:151], a[60:63], v[116:119]
  ds_read_b128 v[148:151], v6 offset:27648
  s_waitcnt lgkmcnt(6)
  v_mfma_f32_16x16x32_bf16 v[96:99], v[152:155], a[64:67], v[96:99]
  buffer_load_dwordx4 v11, s[8:11], s45 offen lds
  v_pk_max_i16 v226, v226, 0
  v_mfma_f32_16x16x32_bf16 v[100:103], v[152:155], a[68:71], v[100:103]
  ds_read_b128 v[152:155], v6 offset:28672
  v_mul_f32_e64 v71, v71, |v71|
  v_mfma_f32_16x16x32_bf16 v[104:107], v[156:159], a[64:67], v[104:107]
  v_mul_f32_e64 v79, v79, |v79|
  v_cvt_pk_bf16_f32 v227, v71, v79
  v_mfma_f32_16x16x32_bf16 v[108:111], v[156:159], a[68:71], v[108:111]
  ds_read_b128 v[156:159], v6 offset:29696
  s_waitcnt lgkmcnt(6)
  v_mfma_f32_16x16x32_bf16 v[112:115], v[128:131], a[64:67], v[112:115]
  buffer_load_dwordx4 v11, s[8:11], s45 offen offset:1024 lds
  v_pk_max_i16 v227, v227, 0
  v_mfma_f32_16x16x32_bf16 v[116:119], v[128:131], a[68:71], v[116:119]
  ds_read_b128 v[128:131], v6 offset:30720
  buffer_store_dwordx4 v[224:227], v34, s[8:11], s44 offen sc1
  v_mfma_f32_16x16x32_bf16 v[96:99], v[132:135], a[72:75], v[96:99]
  v_mul_f32_e64 v84, v84, |v84|
  v_mul_f32_e64 v92, v92, |v92|
  v_mfma_f32_16x16x32_bf16 v[100:103], v[132:135], a[76:79], v[100:103]
  ds_read_b128 v[132:135], v6 offset:31744
  s_waitcnt lgkmcnt(6)
  v_mfma_f32_16x16x32_bf16 v[104:107], v[136:139], a[72:75], v[104:107]
  s_waitcnt vmcnt(24)
  s_barrier
  v_mfma_f32_16x16x32_bf16 v[108:111], v[136:139], a[76:79], v[108:111]
  ds_read_b128 v[136:139], v6 offset:32768
  v_cvt_pk_bf16_f32 v228, v84, v92
  v_mfma_f32_16x16x32_bf16 v[112:115], v[140:143], a[72:75], v[112:115]
  v_pk_max_i16 v228, v228, 0
  s_add_u32 m0, s30, 57344
  v_mfma_f32_16x16x32_bf16 v[116:119], v[140:143], a[76:79], v[116:119]
  ds_read_b128 v[140:143], v6 offset:33792
  s_waitcnt lgkmcnt(6)
  v_mfma_f32_16x16x32_bf16 v[96:99], v[144:147], a[80:83], v[96:99]
  s_add_u32 s45, s34, 81920
  buffer_load_dwordx4 v11, s[8:11], s45 offen lds
  v_mfma_f32_16x16x32_bf16 v[100:103], v[144:147], a[84:87], v[100:103]
  ds_read_b128 v[144:147], v6 offset:34816
  v_mul_f32_e64 v85, v85, |v85|
  v_mfma_f32_16x16x32_bf16 v[104:107], v[148:151], a[80:83], v[104:107]
  v_mul_f32_e64 v93, v93, |v93|
  v_cvt_pk_bf16_f32 v229, v85, v93
  v_mfma_f32_16x16x32_bf16 v[108:111], v[148:151], a[84:87], v[108:111]
  ds_read_b128 v[148:151], v6 offset:35840
  s_waitcnt lgkmcnt(6)
  v_mfma_f32_16x16x32_bf16 v[112:115], v[152:155], a[80:83], v[112:115]
  buffer_load_dwordx4 v11, s[8:11], s45 offen offset:1024 lds
  v_pk_max_i16 v229, v229, 0
  v_mfma_f32_16x16x32_bf16 v[116:119], v[152:155], a[84:87], v[116:119]
  ds_read_b128 v[152:155], v6 offset:36864
  v_mul_f32_e64 v86, v86, |v86|
  v_mfma_f32_16x16x32_bf16 v[96:99], v[156:159], a[88:91], v[96:99]
  v_mul_f32_e64 v94, v94, |v94|
  v_cvt_pk_bf16_f32 v230, v86, v94
  v_mfma_f32_16x16x32_bf16 v[100:103], v[156:159], a[92:95], v[100:103]
  ds_read_b128 v[156:159], v6 offset:37888
  s_waitcnt lgkmcnt(6)
  v_mfma_f32_16x16x32_bf16 v[104:107], v[128:131], a[88:91], v[104:107]
  v_pk_max_i16 v230, v230, 0
  v_mul_f32_e64 v87, v87, |v87|
  v_mfma_f32_16x16x32_bf16 v[108:111], v[128:131], a[92:95], v[108:111]
  ds_read_b128 v[128:131], v6 offset:38912
  s_add_u32 m0, s30, 65536
  v_mfma_f32_16x16x32_bf16 v[112:115], v[132:135], a[88:91], v[112:115]
  s_add_u32 s45, s34, 90112
  buffer_load_dwordx4 v11, s[8:11], s45 offen lds
  v_mfma_f32_16x16x32_bf16 v[116:119], v[132:135], a[92:95], v[116:119]
  ds_read_b128 v[132:135], v6 offset:39936
  s_waitcnt lgkmcnt(6)
  v_mfma_f32_16x16x32_bf16 v[96:99], v[136:139], a[96:99], v[96:99]
  v_mul_f32_e64 v95, v95, |v95|
  v_cvt_pk_bf16_f32 v231, v87, v95
  v_mfma_f32_16x16x32_bf16 v[100:103], v[136:139], a[100:103], v[100:103]
  ds_read_b128 v[136:139], v6 offset:40960
  v_pk_max_i16 v231, v231, 0
  v_mfma_f32_16x16x32_bf16 v[104:107], v[140:143], a[96:99], v[104:107]
  buffer_store_dwordx4 v[228:231], v34, s[8:11], s44 offen offset:1024 sc1
  v_mfma_f32_16x16x32_bf16 v[108:111], v[140:143], a[100:103], v[108:111]
  ds_read_b128 v[140:143], v6 offset:41984
  s_waitcnt lgkmcnt(6)
  v_mfma_f32_16x16x32_bf16 v[112:115], v[144:147], a[96:99], v[112:115]
  v_mfma_f32_16x16x32_bf16 v[116:119], v[144:147], a[100:103], v[116:119]
  ds_read_b128 v[144:147], v6 offset:43008
  v_mfma_f32_16x16x32_bf16 v[96:99], v[148:151], a[104:107], v[96:99]
  v_mfma_f32_16x16x32_bf16 v[100:103], v[148:151], a[108:111], v[100:103]
  ds_read_b128 v[148:151], v6 offset:44032
  s_waitcnt lgkmcnt(6)
  v_mfma_f32_16x16x32_bf16 v[104:107], v[152:155], a[104:107], v[104:107]
here_38:
  v_add_u32 v51, here_38-interleave_layers__linear_attn_block__dense_activation_squared_relu__prompt_kernel+1024, v38
  v_min_u32 v51, 57340, v51
  global_load_dword v49, v51, s[96:97]
  v_mfma_f32_16x16x32_bf16 v[108:111], v[152:155], a[108:111], v[108:111]
  ds_read_b128 v[152:155], v6 offset:45056
  v_mfma_f32_16x16x32_bf16 v[112:115], v[156:159], a[104:107], v[112:115]
  v_mfma_f32_16x16x32_bf16 v[116:119], v[156:159], a[108:111], v[116:119]
  ds_read_b128 v[156:159], v6 offset:46080
  s_waitcnt lgkmcnt(6)
  v_mfma_f32_16x16x32_bf16 v[96:99], v[128:131], a[112:115], v[96:99]
  v_mfma_f32_16x16x32_bf16 v[100:103], v[128:131], a[116:119], v[100:103]
  ds_read_b128 v[128:131], v6 offset:47104
  buffer_load_dwordx4 v11, s[8:11], s45 offen offset:1024 lds
  v_mfma_f32_16x16x32_bf16 v[104:107], v[132:135], a[112:115], v[104:107]
  v_mfma_f32_16x16x32_bf16 v[108:111], v[132:135], a[116:119], v[108:111]
  ds_read_b128 v[132:135], v6 offset:48128
  s_waitcnt lgkmcnt(6)
  v_mfma_f32_16x16x32_bf16 v[112:115], v[136:139], a[112:115], v[112:115]
  v_mfma_f32_16x16x32_bf16 v[116:119], v[136:139], a[116:119], v[116:119]
  ds_read_b128 v[136:139], v6 offset:49152
  v_mfma_f32_16x16x32_bf16 v[96:99], v[140:143], a[120:123], v[96:99]
  s_add_u32 m0, s30, 73728
  s_add_u32 s45, s34, 98304
  v_mfma_f32_16x16x32_bf16 v[100:103], v[140:143], a[124:127], v[100:103]
  ds_read_b128 v[140:143], v6 offset:50176
  s_waitcnt lgkmcnt(6)
  v_mfma_f32_16x16x32_bf16 v[104:107], v[144:147], a[120:123], v[104:107]
  buffer_load_dwordx4 v11, s[8:11], s45 offen lds
  v_mfma_f32_16x16x32_bf16 v[108:111], v[144:147], a[124:127], v[108:111]
  ds_read_b128 v[144:147], v6 offset:51200
  v_mfma_f32_16x16x32_bf16 v[112:115], v[148:151], a[120:123], v[112:115]
  v_mfma_f32_16x16x32_bf16 v[116:119], v[148:151], a[124:127], v[116:119]
  ds_read_b128 v[148:151], v6 offset:52224
  s_waitcnt lgkmcnt(6)
  v_mfma_f32_16x16x32_bf16 v[96:99], v[152:155], a[128:131], v[96:99]
  buffer_load_dwordx4 v11, s[8:11], s45 offen offset:1024 lds
  v_mfma_f32_16x16x32_bf16 v[100:103], v[152:155], a[132:135], v[100:103]
  ds_read_b128 v[152:155], v6 offset:53248
  v_mfma_f32_16x16x32_bf16 v[104:107], v[156:159], a[128:131], v[104:107]
  v_mfma_f32_16x16x32_bf16 v[108:111], v[156:159], a[132:135], v[108:111]
  ds_read_b128 v[156:159], v6 offset:54272
  s_waitcnt lgkmcnt(6)
  v_mfma_f32_16x16x32_bf16 v[112:115], v[128:131], a[128:131], v[112:115]
  s_add_u32 m0, s30, 81920
  s_add_u32 s45, s34, 106496
  v_mfma_f32_16x16x32_bf16 v[116:119], v[128:131], a[132:135], v[116:119]
  ds_read_b128 v[128:131], v6 offset:55296
  buffer_load_dwordx4 v11, s[8:11], s45 offen lds
  v_mfma_f32_16x16x32_bf16 v[96:99], v[132:135], a[136:139], v[96:99]
  v_mfma_f32_16x16x32_bf16 v[100:103], v[132:135], a[140:143], v[100:103]
  ds_read_b128 v[132:135], v6 offset:56320
  s_waitcnt lgkmcnt(6)
  v_mfma_f32_16x16x32_bf16 v[104:107], v[136:139], a[136:139], v[104:107]
  buffer_load_dwordx4 v11, s[8:11], s45 offen offset:1024 lds
  s_waitcnt vmcnt(33)
  s_barrier
  v_mfma_f32_16x16x32_bf16 v[108:111], v[136:139], a[140:143], v[108:111]
  ds_read_b128 v[136:139], v6 offset:57344
  v_mfma_f32_16x16x32_bf16 v[112:115], v[140:143], a[136:139], v[112:115]
  v_mfma_f32_16x16x32_bf16 v[116:119], v[140:143], a[140:143], v[116:119]
  ds_read_b128 v[140:143], v6 offset:58368
  s_waitcnt lgkmcnt(6)
  v_mfma_f32_16x16x32_bf16 v[96:99], v[144:147], a[144:147], v[96:99]
  v_mfma_f32_16x16x32_bf16 v[100:103], v[144:147], a[148:151], v[100:103]
  ds_read_b128 v[144:147], v6 offset:59392
  s_add_u32 m0, s30, 90112
  v_mfma_f32_16x16x32_bf16 v[104:107], v[148:151], a[144:147], v[104:107]
  s_add_u32 s45, s34, 114688
  buffer_load_dwordx4 v11, s[8:11], s45 offen lds
  v_mfma_f32_16x16x32_bf16 v[108:111], v[148:151], a[148:151], v[108:111]
  s_waitcnt lgkmcnt(5)
  v_mfma_f32_16x16x32_bf16 v[112:115], v[152:155], a[144:147], v[112:115]
  v_mfma_f32_16x16x32_bf16 v[116:119], v[152:155], a[148:151], v[116:119]
  v_mfma_f32_16x16x32_bf16 v[96:99], v[156:159], a[152:155], v[96:99]
  v_mfma_f32_16x16x32_bf16 v[100:103], v[156:159], a[156:159], v[100:103]
  buffer_load_dwordx4 v11, s[8:11], s45 offen offset:1024 lds
  s_waitcnt lgkmcnt(3)
  v_mfma_f32_16x16x32_bf16 v[104:107], v[128:131], a[152:155], v[104:107]
  v_mfma_f32_16x16x32_bf16 v[108:111], v[128:131], a[156:159], v[108:111]
  v_mfma_f32_16x16x32_bf16 v[112:115], v[132:135], a[152:155], v[112:115]
  v_mfma_f32_16x16x32_bf16 v[116:119], v[132:135], a[156:159], v[116:119]
  s_add_u32 m0, s30, 98304
  s_waitcnt lgkmcnt(1)
  v_mfma_f32_16x16x32_bf16 v[96:99], v[136:139], v[40:43], v[96:99]
  s_add_u32 s45, s34, 122880
  buffer_load_dwordx4 v11, s[8:11], s45 offen lds
  v_mfma_f32_16x16x32_bf16 v[100:103], v[136:139], v[44:47], v[100:103]
  v_mfma_f32_16x16x32_bf16 v[104:107], v[140:143], v[40:43], v[104:107]
  buffer_load_dwordx4 v11, s[8:11], s45 offen offset:1024 lds
  s_barrier
  v_mfma_f32_16x16x32_bf16 v[108:111], v[140:143], v[44:47], v[108:111]
  s_waitcnt lgkmcnt(0)
  v_mfma_f32_16x16x32_bf16 v[112:115], v[144:147], v[40:43], v[112:115]
  v_mfma_f32_16x16x32_bf16 v[116:119], v[144:147], v[44:47], v[116:119]
  s_add_u32 s43, s59, 13762560
  v_mul_f32_e64 v96, v96, |v96|
  v_mul_f32_e64 v104, v104, |v104|
  v_cvt_pk_bf16_f32 v216, v96, v104
  v_pk_max_i16 v216, v216, 0
  v_mul_f32_e64 v97, v97, |v97|
  v_mul_f32_e64 v105, v105, |v105|
  v_cvt_pk_bf16_f32 v217, v97, v105
  v_pk_max_i16 v217, v217, 0
  v_mul_f32_e64 v98, v98, |v98|
  v_mul_f32_e64 v106, v106, |v106|
  v_cvt_pk_bf16_f32 v218, v98, v106
  v_pk_max_i16 v218, v218, 0
  v_mul_f32_e64 v99, v99, |v99|
  v_mul_f32_e64 v107, v107, |v107|
  v_cvt_pk_bf16_f32 v219, v99, v107
  v_pk_max_i16 v219, v219, 0
  buffer_store_dwordx4 v[216:219], v34, s[8:11], s43 offen offset:2048 sc1
  s_add_u32 s44, s59, 13817856
  v_mul_f32_e64 v100, v100, |v100|
  v_mul_f32_e64 v108, v108, |v108|
  v_cvt_pk_bf16_f32 v220, v100, v108
  v_pk_max_i16 v220, v220, 0
  v_mul_f32_e64 v101, v101, |v101|
  v_mul_f32_e64 v109, v109, |v109|
  v_cvt_pk_bf16_f32 v221, v101, v109
  v_pk_max_i16 v221, v221, 0
  v_mul_f32_e64 v102, v102, |v102|
  v_mul_f32_e64 v110, v110, |v110|
  v_cvt_pk_bf16_f32 v222, v102, v110
  v_pk_max_i16 v222, v222, 0
  v_mul_f32_e64 v103, v103, |v103|
  v_mul_f32_e64 v111, v111, |v111|
  v_cvt_pk_bf16_f32 v223, v103, v111
  v_pk_max_i16 v223, v223, 0
  buffer_store_dwordx4 v[220:223], v34, s[8:11], s44 offen offset:2048 sc1
  v_mul_f32_e64 v112, v112, |v112|
  v_mul_f32_e64 v113, v113, |v113|
  v_mul_f32_e64 v114, v114, |v114|
  v_mul_f32_e64 v115, v115, |v115|
  v_cvt_pk_bf16_f32 v232, v112, v113
  v_pk_max_i16 v232, v232, 0
  v_cvt_pk_bf16_f32 v233, v114, v115
  v_pk_max_i16 v233, v233, 0
  v_mul_f32_e64 v116, v116, |v116|
  v_mul_f32_e64 v117, v117, |v117|
  v_mul_f32_e64 v118, v118, |v118|
  v_mul_f32_e64 v119, v119, |v119|
  v_cvt_pk_bf16_f32 v234, v116, v117
  v_pk_max_i16 v234, v234, 0
  v_cvt_pk_bf16_f32 v235, v118, v119
  v_pk_max_i16 v235, v235, 0
  s_add_u32 s41, s60, 13762560
  s_add_u32 s42, s60, 13817856
  buffer_store_dwordx2 v[232:233], v35, s[8:11], s41 offen sc1
  buffer_store_dwordx2 v[234:235], v35, s[8:11], s42 offen sc1
  s_waitcnt vmcnt(0)
  s_barrier
  s_lshl_b32 s41, s47, 2
  s_add_u32 s41, s41, s24
  s_cmp_lg_u32 s41, 1
  s_cbranch_scc1 noflag_39
  s_lshl_b32 s41, s26, 2
  v_mov_b32 v237, s41
  s_add_u32 s41, s92, 4
  v_mov_b32 v238, s41
  s_mov_b64 exec, 1
  buffer_store_dword v238, v237, s[8:11], s39 offen sc1
  s_mov_b64 exec, -1
noflag_39:
  s_cmp_lg_u32 s24, 2
  s_cbranch_scc1 noflag_40
  s_lshl_b32 s41, s26, 2
  v_mov_b32 v237, s41
  s_add_u32 s41, s92, 4
  v_mov_b32 v238, s41
  s_mov_b64 exec, 1
  buffer_store_dword v238, v237, s[8:11], s38 offen
  s_mov_b64 exec, -1
noflag_40:
  s_add_u32 m0, s30, 106496
  s_add_u32 s45, s34, 131072
  buffer_load_dwordx4 v11, s[8:11], s45 offen lds
  buffer_load_dwordx4 v11, s[8:11], s45 offen offset:1024 lds
  s_add_u32 m0, s30, 114688
  s_add_u32 s45, s34, 139264
  buffer_load_dwordx4 v11, s[8:11], s45 offen lds
  buffer_load_dwordx4 v11, s[8:11], s45 offen offset:1024 lds
  s_add_u32 m0, s30, 122880
  s_add_u32 s45, s34, 147456
  buffer_load_dwordx4 v11, s[8:11], s45 offen lds
  buffer_load_dwordx4 v11, s[8:11], s45 offen offset:1024 lds
  ds_read_b128 v[148:151], v10
  ds_read_b128 v[152:155], v10 offset:2048
  ds_read_b128 v[156:159], v10 offset:4096
  ds_read_b128 v[128:131], v10 offset:6144
  ds_read_b128 v[132:135], v10 offset:8192
  ds_read_b128 v[136:139], v10 offset:10240
  ds_read_b128 v[140:143], v10 offset:12288
  ds_read_b128 v[144:147], v10 offset:14336
  s_cmp_lg_u32 s24, 0
  s_cbranch_scc1 nopoll_41
  s_mov_b32 s50, 0
  s_mov_b64 s[94:95], 0
  s_add_u32 s42, s92, 4
  s_cmp_eq_u32 s47, 0
  s_cselect_b32 s43, 3, -1
poll_42:
  buffer_load_dword v238, v36, s[8:11], s38 offen sc1
  s_add_u32 s50, s50, 1
  s_waitcnt vmcnt(0)
  v_subrev_u32 v238, s42, v238
  v_cmp_ge_u32 vcc, 1, v238
  s_or_b64 s[94:95], s[94:95], vcc
  s_cmp_eq_u64 s[94:95], -1
  s_cbranch_scc1 nopoll_41
  s_and_b32 s41, s50, s43
  s_cbranch_scc1 pollnext_43
  buffer_load_dword v238, v36, s[8:11], s39 offen sc1
  s_waitcnt vmcnt(0)
  v_subrev_u32 v238, s42, v238
  v_cmp_ge_u32 vcc, 1, v238
  s_or_b64 s[94:95], s[94:95], vcc
  s_cmp_eq_u64 s[94:95], -1
  s_cbranch_scc1 nopoll_41
pollnext_43:
  s_cmp_lt_u32 s50, 0x80000
  s_cbranch_scc1 poll_42
nopoll_41:
  s_barrier
  s_add_u32 s46, s36, 13762560
  buffer_load_dwordx4 a[0:3], v16, s[8:11], s46 offen sc1
  buffer_load_dwordx4 a[4:7], v17, s[8:11], s46 offen sc1
  buffer_load_dwordx4 a[8:11], v16, s[8:11], s46 offen offset:1024 sc1
  buffer_load_dwordx4 a[12:15], v17, s[8:11], s46 offen offset:1024 sc1
  buffer_load_dwordx4 a[16:19], v16, s[8:11], s46 offen offset:2048 sc1
  buffer_load_dwordx4 a[20:23], v17, s[8:11], s46 offen offset:2048 sc1
  buffer_load_dwordx4 a[24:27], v16, s[8:11], s46 offen offset:3072 sc1
  buffer_load_dwordx4 a[28:31], v17, s[8:11], s46 offen offset:3072 sc1
  ds_read_b32 v202, v27
  s_waitcnt vmcnt(6) lgkmcnt(7)
  v_mfma_f32_16x16x32_bf16 v[84:87], v[148:151], a[4:7], 0
  s_add_u32 s46, s36, 13766656
  buffer_load_dwordx4 a[32:35], v16, s[8:11], s46 offen sc1
  v_mfma_f32_16x16x32_bf16 v[64:67], v[148:151], a[0:3], 0
  ds_read_b128 v[148:151], v10 offset:16384
  buffer_load_dwordx4 a[36:39], v17, s[8:11], s46 offen sc1
  v_mfma_f32_16x16x32_bf16 v[88:91], v[152:155], a[4:7], 0
  buffer_load_dwordx4 a[40:43], v16, s[8:11], s46 offen offset:1024 sc1
  buffer_load_dwordx4 a[44:47], v17, s[8:11], s46 offen offset:1024 sc1
  v_mfma_f32_16x16x32_bf16 v[68:71], v[152:155], a[0:3], 0
  ds_read_b128 v[152:155], v10 offset:18432
  s_waitcnt lgkmcnt(7)
  v_mfma_f32_16x16x32_bf16 v[92:95], v[156:159], a[4:7], 0
  buffer_load_dwordx4 a[48:51], v16, s[8:11], s46 offen offset:2048 sc1
  buffer_load_dwordx4 a[52:55], v17, s[8:11], s46 offen offset:2048 sc1
  v_mfma_f32_16x16x32_bf16 v[72:75], v[156:159], a[0:3], 0
  ds_read_b128 v[156:159], v10 offset:20480
  v_mfma_f32_16x16x32_bf16 v[96:99], v[128:131], a[4:7], 0
  buffer_load_dwordx4 a[56:59], v16, s[8:11], s46 offen offset:3072 sc1
  v_mfma_f32_16x16x32_bf16 v[76:79], v[128:131], a[0:3], 0
  ds_read_b128 v[128:131], v10 offset:22528
  s_waitcnt vmcnt(11) lgkmcnt(7)
  v_mfma_f32_16x16x32_bf16 v[100:103], v[132:135], a[4:7], 0
  s_barrier
  v_mfma_f32_16x16x32_bf16 v[80:83], v[132:135], a[0:3], 0
  ds_read_b128 v[132:135], v10 offset:24576
  buffer_load_dwordx4 a[60:63], v17, s[8:11], s46 offen offset:3072 sc1
  v_mfma_f32_16x16x32_bf16 v[84:87], v[136:139], a[12:15], v[84:87]
  v_mfma_f32_16x16x32_bf16 v[64:67], v[136:139], a[8:11], v[64:67]
  ds_read_b128 v[136:139], v10 offset:26624
  s_waitcnt lgkmcnt(7)
  v_mfma_f32_16x16x32_bf16 v[88:91], v[140:143], a[12:15], v[88:91]
  s_add_u32 s46, s36, 13770752
  buffer_load_dwordx4 a[64:67], v16, s[8:11], s46 offen sc1
  v_mfma_f32_16x16x32_bf16 v[68:71], v[140:143], a[8:11], v[68:71]
  ds_read_b128 v[140:143], v10 offset:28672
  v_mfma_f32_16x16x32_bf16 v[92:95], v[144:147], a[12:15], v[92:95]
  buffer_load_dwordx4 a[68:71], v17, s[8:11], s46 offen sc1
  v_mfma_f32_16x16x32_bf16 v[72:75], v[144:147], a[8:11], v[72:75]
  ds_read_b128 v[144:147], v10 offset:30720
  s_waitcnt lgkmcnt(6)
  v_mfma_f32_16x16x32_bf16 v[96:99], v[148:151], a[12:15], v[96:99]
  buffer_load_dwordx4 a[72:75], v16, s[8:11], s46 offen offset:1024 sc1
  v_mfma_f32_16x16x32_bf16 v[76:79], v[148:151], a[8:11], v[76:79]
  ds_read_b128 v[148:151], v8 offset:8192
  v_mfma_f32_16x16x32_bf16 v[100:103], v[152:155], a[12:15], v[100:103]
  v_mfma_f32_16x16x32_bf16 v[80:83], v[152:155], a[8:11], v[80:83]
  ds_read_b128 v[152:155], v8 offset:10240
  s_waitcnt vmcnt(13) lgkmcnt(6)
  v_mfma_f32_16x16x32_bf16 v[84:87], v[156:159], a[20:23], v[84:87]
  v_mfma_f32_16x16x32_bf16 v[64:67], v[156:159], a[16:19], v[64:67]
  ds_read_b128 v[156:159], v8 offset:12288
  buffer_load_dwordx4 a[76:79], v17, s[8:11], s46 offen offset:1024 sc1
  v_mfma_f32_16x16x32_bf16 v[88:91], v[128:131], a[20:23], v[88:91]
  v_mfma_f32_16x16x32_bf16 v[68:71], v[128:131], a[16:19], v[68:71]
  ds_read_b128 v[128:131], v8 offset:14336
  s_waitcnt lgkmcnt(6)
  v_mfma_f32_16x16x32_bf16 v[92:95], v[132:135], a[20:23], v[92:95]
  v_mfma_f32_16x16x32_bf16 v[72:75], v[132:135], a[16:19], v[72:75]
  ds_read_b128 v[132:135], v8 offset:16384
  v_mfma_f32_16x16x32_bf16 v[96:99], v[136:139], a[20:23], v[96:99]
  buffer_load_dwordx4 a[80:83], v16, s[8:11], s46 offen offset:2048 sc1
  v_mfma_f32_16x16x32_bf16 v[76:79], v[136:139], a[16:19], v[76:79]
  ds_read_b128 v[136:139], v8 offset:18432
  s_waitcnt vmcnt(13) lgkmcnt(6)
  v_mfma_f32_16x16x32_bf16 v[100:103], v[140:143], a[20:23], v[100:103]
  v_mfma_f32_16x16x32_bf16 v[80:83], v[140:143], a[16:19], v[80:83]
  ds_read_b128 v[140:143], v8 offset:20480
  v_mfma_f32_16x16x32_bf16 v[84:87], v[144:147], a[28:31], v[84:87]
  v_mfma_f32_16x16x32_bf16 v[64:67], v[144:147], a[24:27], v[64:67]
  ds_read_b128 v[144:147], v8 offset:22528
  s_waitcnt lgkmcnt(6)
  v_mfma_f32_16x16x32_bf16 v[88:91], v[148:151], a[28:31], v[88:91]
  s_barrier
  v_mfma_f32_16x16x32_bf16 v[68:71], v[148:151], a[24:27], v[68:71]
  ds_read_b128 v[148:151], v8 offset:24576
  v_mfma_f32_16x16x32_bf16 v[92:95], v[152:155], a[28:31], v[92:95]
  v_mfma_f32_16x16x32_bf16 v[72:75], v[152:155], a[24:27], v[72:75]
  ds_read_b128 v[152:155], v8 offset:26624
  s_waitcnt lgkmcnt(6)
  v_mfma_f32_16x16x32_bf16 v[96:99], v[156:159], a[28:31], v[96:99]
  v_mfma_f32_16x16x32_bf16 v[76:79], v[156:159], a[24:27], v[76:79]
  ds_read_b128 v[156:159], v8 offset:28672
  buffer_load_dwordx4 a[84:87], v17, s[8:11], s46 offen offset:2048 sc1
  v_mfma_f32_16x16x32_bf16 v[100:103], v[128:131], a[28:31], v[100:103]
  v_mfma_f32_16x16x32_bf16 v[80:83], v[128:131], a[24:27], v[80:83]
  ds_read_b128 v[128:131], v8 offset:30720
  s_waitcnt vmcnt(12) lgkmcnt(6)
  v_mfma_f32_16x16x32_bf16 v[84:87], v[132:135], a[36:39], v[84:87]
  buffer_load_dwordx4 a[88:91], v16, s[8:11], s46 offen offset:3072 sc1
  v_add_u32 v200, 69632, v39
  v_mfma_f32_16x16x32_bf16 v[64:67], v[132:135], a[32:35], v[64:67]
  ds_read_b128 v[132:135], v8 offset:32768
  s_xor_b32 s41, s24, 1
  v_mfma_f32_16x16x32_bf16 v[88:91], v[136:139], a[36:39], v[88:91]
  s_mul_i32 s41, s41, 5120
  s_add_u32 s41, s41, 69632
  v_mfma_f32_16x16x32_bf16 v[68:71], v[136:139], a[32:35], v[68:71]
  ds_read_b128 v[136:139], v8 offset:34816
  s_waitcnt lgkmcnt(6)
  v_mfma_f32_16x16x32_bf16 v[92:95], v[140:143], a[36:39], v[92:95]
  buffer_load_dwordx4 a[92:95], v17, s[8:11], s46 offen offset:3072 sc1
  v_add_u32 v201, s41, v4
  v_mfma_f32_16x16x32_bf16 v[72:75], v[140:143], a[32:35], v[72:75]
  ds_read_b128 v[140:143], v8 offset:36864
  v_mul_f32 v202, v202, v202
  v_mfma_f32_16x16x32_bf16 v[96:99], v[144:147], a[36:39], v[96:99]
  s_add_u32 s41, s54, 8388608
  s_add_u32 s42, s55, 8388608
  v_mfma_f32_16x16x32_bf16 v[76:79], v[144:147], a[32:35], v[76:79]
  ds_read_b128 v[144:147], v8 offset:38912
  s_waitcnt vmcnt(12) lgkmcnt(6)
  v_mfma_f32_16x16x32_bf16 v[100:103], v[148:151], a[36:39], v[100:103]
  s_add_u32 m0, s30, 131072
  s_add_u32 s45, s34, 155648
  v_mfma_f32_16x16x32_bf16 v[80:83], v[148:151], a[32:35], v[80:83]
  ds_read_b128 v[148:151], v8 offset:40960
  buffer_load_dwordx4 v11, s[8:11], s45 offen lds
  v_mfma_f32_16x16x32_bf16 v[84:87], v[152:155], a[44:47], v[84:87]
  s_add_u32 s43, s56, 11010048
  v_mfma_f32_16x16x32_bf16 v[64:67], v[152:155], a[40:43], v[64:67]
  ds_read_b128 v[152:155], v8 offset:43008
  s_waitcnt lgkmcnt(6)
  v_mfma_f32_16x16x32_bf16 v[88:91], v[156:159], a[44:47], v[88:91]
  buffer_load_dwordx4 v11, s[8:11], s45 offen offset:1024 lds
  v_mfma_f32_16x16x32_bf16 v[68:71], v[156:159], a[40:43], v[68:71]
  ds_read_b128 v[156:159], v8 offset:45056
  v_mfma_f32_16x16x32_bf16 v[92:95], v[128:131], a[44:47], v[92:95]
  v_mfma_f32_16x16x32_bf16 v[72:75], v[128:131], a[40:43], v[72:75]
  ds_read_b128 v[128:131], v8 offset:47104
  s_waitcnt lgkmcnt(6)
  v_mfma_f32_16x16x32_bf16 v[96:99], v[132:135], a[44:47], v[96:99]
  s_barrier
  v_mfma_f32_16x16x32_bf16 v[76:79], v[132:135], a[40:43], v[76:79]
  ds_read_b128 v[132:135], v8 offset:49152
  s_add_u32 s46, s36, 13774848
  v_mfma_f32_16x16x32_bf16 v[100:103], v[136:139], a[44:47], v[100:103]
  buffer_load_dwordx4 a[96:99], v16, s[8:11], s46 offen sc1
  v_mfma_f32_16x16x32_bf16 v[80:83], v[136:139], a[40:43], v[80:83]
  ds_read_b128 v[136:139], v8 offset:51200
  s_waitcnt vmcnt(13) lgkmcnt(6)
  v_mfma_f32_16x16x32_bf16 v[84:87], v[140:143], a[52:55], v[84:87]
  buffer_load_dwordx4 a[100:103], v17, s[8:11], s46 offen sc1
  s_add_u32 m0, s30, 139264
  v_mfma_f32_16x16x32_bf16 v[64:67], v[140:143], a[48:51], v[64:67]
  ds_read_b128 v[140:143], v8 offset:53248
  s_add_u32 s45, s34, 163840
  v_mfma_f32_16x16x32_bf16 v[88:91], v[144:147], a[52:55], v[88:91]
  buffer_load_dwordx4 v11, s[8:11], s45 offen lds
  buffer_load_dwordx4 v11, s[8:11], s45 offen offset:1024 lds
  v_mfma_f32_16x16x32_bf16 v[68:71], v[144:147], a[48:51], v[68:71]
  ds_read_b128 v[144:147], v8 offset:55296
  s_waitcnt lgkmcnt(6)
  v_mfma_f32_16x16x32_bf16 v[92:95], v[148:151], a[52:55], v[92:95]
  v_mfma_f32_16x16x32_bf16 v[72:75], v[148:151], a[48:51], v[72:75]
  ds_read_b128 v[148:151], v8 offset:57344
  v_mfma_f32_16x16x32_bf16 v[96:99], v[152:155], a[52:55], v[96:99]
  v_mfma_f32_16x16x32_bf16 v[76:79], v[152:155], a[48:51], v[76:79]
  ds_read_b128 v[152:155], v8 offset:59392
  s_waitcnt vmcnt(14) lgkmcnt(6)
  v_mfma_f32_16x16x32_bf16 v[100:103], v[156:159], a[52:55], v[100:103]
  s_add_u32 m0, s30, 147456
  s_add_u32 s45, s34, 172032
  v_mfma_f32_16x16x32_bf16 v[80:83], v[156:159], a[48:51], v[80:83]
  ds_read_b128 v[156:159], v8 offset:61440
  buffer_load_dwordx4 v11, s[8:11], s45 offen lds
  v_mfma_f32_16x16x32_bf16 v[84:87], v[128:131], a[60:63], v[84:87]
  buffer_load_dwordx4 v11, s[8:11], s45 offen offset:1024 lds
  buffer_load_dwordx4 a[104:107], v16, s[8:11], s46 offen offset:1024 sc1
  v_mfma_f32_16x16x32_bf16 v[64:67], v[128:131], a[56:59], v[64:67]
  ds_read_b128 v[128:131], v8 offset:63488
  s_waitcnt lgkmcnt(6)
  v_mfma_f32_16x16x32_bf16 v[88:91], v[132:135], a[60:63], v[88:91]
  buffer_load_dwordx4 a[108:111], v17, s[8:11], s46 offen offset:1024 sc1
  v_mfma_f32_16x16x32_bf16 v[68:71], v[132:135], a[56:59], v[68:71]
  ds_read_b128 v[132:135], v9
  v_mfma_f32_16x16x32_bf16 v[92:95], v[136:139], a[60:63], v[92:95]
  v_mfma_f32_16x16x32_bf16 v[72:75], v[136:139], a[56:59], v[72:75]
  ds_read_b128 v[136:139], v9 offset:2048
  s_waitcnt lgkmcnt(6)
  v_mfma_f32_16x16x32_bf16 v[96:99], v[140:143], a[60:63], v[96:99]
  s_add_u32 m0, s30, 155648
  s_add_u32 s45, s34, 180224
  v_mfma_f32_16x16x32_bf16 v[76:79], v[140:143], a[56:59], v[76:79]
  ds_read_b128 v[140:143], v9 offset:4096
  buffer_load_dwordx4 v11, s[8:11], s45 offen lds
  v_mfma_f32_16x16x32_bf16 v[100:103], v[144:147], a[60:63], v[100:103]
  buffer_load_dwordx4 v11, s[8:11], s45 offen offset:1024 lds
  v_mfma_f32_16x16x32_bf16 v[80:83], v[144:147], a[56:59], v[80:83]
  ds_read_b128 v[144:147], v9 offset:6144
  s_waitcnt vmcnt(18) lgkmcnt(6)
  v_mfma_f32_16x16x32_bf16 v[84:87], v[148:151], a[68:71], v[84:87]
  s_barrier
  v_mfma_f32_16x16x32_bf16 v[64:67], v[148:151], a[64:67], v[64:67]
  ds_read_b128 v[148:151], v9 offset:8192
  buffer_load_dwordx4 a[112:115], v16, s[8:11], s46 offen offset:2048 sc1
  v_mfma_f32_16x16x32_bf16 v[88:91], v[152:155], a[68:71], v[88:91]
  buffer_load_dwordx4 a[116:119], v17, s[8:11], s46 offen offset:2048 sc1
  v_mfma_f32_16x16x32_bf16 v[68:71], v[152:155], a[64:67], v[68:71]
  ds_read_b128 v[152:155], v9 offset:10240
  s_waitcnt lgkmcnt(6)
  v_mfma_f32_16x16x32_bf16 v[92:95], v[156:159], a[68:71], v[92:95]
  s_add_u32 m0, s30, 8192
  s_add_u32 s45, s34, 188416
  v_mfma_f32_16x16x32_bf16 v[72:75], v[156:159], a[64:67], v[72:75]
  ds_read_b128 v[156:159], v9 offset:12288
  buffer_load_dwordx4 v11, s[8:11], s45 offen lds
  v_mfma_f32_16x16x32_bf16 v[96:99], v[128:131], a[68:71], v[96:99]
  buffer_load_dwordx4 v11, s[8:11], s45 offen offset:1024 lds
  v_mfma_f32_16x16x32_bf16 v[76:79], v[128:131], a[64:67], v[76:79]
  ds_read_b128 v[128:131], v9 offset:14336
  s_waitcnt vmcnt(20) lgkmcnt(6)
  v_mfma_f32_16x16x32_bf16 v[100:103], v[132:135], a[68:71], v[100:103]
  v_mfma_f32_16x16x32_bf16 v[80:83], v[132:135], a[64:67], v[80:83]
  ds_read_b128 v[132:135], v9 offset:16384
  v_mfma_f32_16x16x32_bf16 v[84:87], v[136:139], a[76:79], v[84:87]
  buffer_load_dwordx4 a[120:123], v16, s[8:11], s46 offen offset:3072 sc1
  buffer_load_dwordx4 a[124:127], v17, s[8:11], s46 offen offset:3072 sc1
  v_mfma_f32_16x16x32_bf16 v[64:67], v[136:139], a[72:75], v[64:67]
  ds_read_b128 v[136:139], v9 offset:18432
  s_waitcnt lgkmcnt(6)
  v_mfma_f32_16x16x32_bf16 v[88:91], v[140:143], a[76:79], v[88:91]
  s_add_u32 m0, s30, 16384
  s_add_u32 s45, s34, 196608
  v_mfma_f32_16x16x32_bf16 v[68:71], v[140:143], a[72:75], v[68:71]
  ds_read_b128 v[140:143], v9 offset:20480
  buffer_load_dwordx4 v11, s[8:11], s45 offen lds
  v_mfma_f32_16x16x32_bf16 v[92:95], v[144:147], a[76:79], v[92:95]
  buffer_load_dwordx4 v11, s[8:11], s45 offen offset:1024 lds
  v_mfma_f32_16x16x32_bf16 v[72:75], v[144:147], a[72:75], v[72:75]
  ds_read_b128 v[144:147], v9 offset:22528
  s_waitcnt lgkmcnt(6)
  v_mfma_f32_16x16x32_bf16 v[96:99], v[148:151], a[76:79], v[96:99]
  v_mfma_f32_16x16x32_bf16 v[76:79], v[148:151], a[72:75], v[76:79]
  ds_read_b128 v[148:151], v9 offset:24576
  v_mfma_f32_16x16x32_bf16 v[100:103], v[152:155], a[76:79], v[100:103]
  v_mfma_f32_16x16x32_bf16 v[80:83], v[152:155], a[72:75], v[80:83]
  ds_read_b128 v[152:155], v9 offset:26624
  s_waitcnt vmcnt(22) lgkmcnt(6)
  v_mfma_f32_16x16x32_bf16 v[84:87], v[156:159], a[84:87], v[84:87]
  s_add_u32 s46, s36, 13778944
  buffer_load_dwordx4 a[128:131], v16, s[8:11], s46 offen sc1
  v_mfma_f32_16x16x32_bf16 v[64:67], v[156:159], a[80:83], v[64:67]
  ds_read_b128 v[156:159], v9 offset:28672
  buffer_load_dwordx4 a[132:135], v17, s[8:11], s46 offen sc1
  v_mfma_f32_16x16x32_bf16 v[88:91], v[128:131], a[84:87], v[88:91]
  s_add_u32 m0, s30, 24576
  s_add_u32 s45, s34, 204800
  v_mfma_f32_16x16x32_bf16 v[68:71], v[128:131], a[80:83], v[68:71]
  ds_read_b128 v[128:131], v9 offset:30720
  s_waitcnt lgkmcnt(6)
  v_mfma_f32_16x16x32_bf16 v[92:95], v[132:135], a[84:87], v[92:95]
  buffer_load_dwordx4 v11, s[8:11], s45 offen lds
  buffer_load_dwordx4 v11, s[8:11], s45 offen offset:1024 lds
  s_barrier
  v_mfma_f32_16x16x32_bf16 v[72:75], v[132:135], a[80:83], v[72:75]
  ds_read_b128 v[132:135], v9 offset:32768
  v_mfma_f32_16x16x32_bf16 v[96:99], v[136:139], a[84:87], v[96:99]
  v_mfma_f32_16x16x32_bf16 v[76:79], v[136:139], a[80:83], v[76:79]
  ds_read_b128 v[136:139], v9 offset:34816
  s_waitcnt vmcnt(24) lgkmcnt(6)
  v_mfma_f32_16x16x32_bf16 v[100:103], v[140:143], a[84:87], v[100:103]
  s_add_u32 m0, s30, 32768
  s_add_u32 s45, s34, 212992
  v_mfma_f32_16x16x32_bf16 v[80:83], v[140:143], a[80:83], v[80:83]
  ds_read_b128 v[140:143], v9 offset:36864
  buffer_load_dwordx4 v11, s[8:11], s45 offen lds
  v_mfma_f32_16x16x32_bf16 v[84:87], v[144:147], a[92:95], v[84:87]
  buffer_load_dwordx4 v11, s[8:11], s45 offen offset:1024 lds
  buffer_load_dwordx4 a[136:139], v16, s[8:11], s46 offen offset:1024 sc1
  v_mfma_f32_16x16x32_bf16 v[64:67], v[144:147], a[88:91], v[64:67]
  ds_read_b128 v[144:147], v9 offset:38912
  s_waitcnt lgkmcnt(6)
  v_mfma_f32_16x16x32_bf16 v[88:91], v[148:151], a[92:95], v[88:91]
  buffer_load_dwordx4 a[140:143], v17, s[8:11], s46 offen offset:1024 sc1
  v_mfma_f32_16x16x32_bf16 v[68:71], v[148:151], a[88:91], v[68:71]
  ds_read_b128 v[148:151], v9 offset:40960
  v_mfma_f32_16x16x32_bf16 v[92:95], v[152:155], a[92:95], v[92:95]
  v_mfma_f32_16x16x32_bf16 v[72:75], v[152:155], a[88:91], v[72:75]
  ds_read_b128 v[152:155], v9 offset:43008
  s_waitcnt lgkmcnt(6)
  v_mfma_f32_16x16x32_bf16 v[96:99], v[156:159], a[92:95], v[96:99]
  s_add_u32 m0, s30, 40960
  s_add_u32 s45, s34, 221184
  v_mfma_f32_16x16x32_bf16 v[76:79], v[156:159], a[88:91], v[76:79]
  ds_read_b128 v[156:159], v9 offset:45056
  buffer_load_dwordx4 v11, s[8:11], s45 offen lds
  v_mfma_f32_16x16x32_bf16 v[100:103], v[128:131], a[92:95], v[100:103]
  buffer_load_dwordx4 v11, s[8:11], s45 offen offset:1024 lds
  v_mfma_f32_16x16x32_bf16 v[80:83], v[128:131], a[88:91], v[80:83]
  ds_read_b128 v[128:131], v9 offset:47104
  s_waitcnt vmcnt(26) lgkmcnt(6)
  v_mfma_f32_16x16x32_bf16 v[84:87], v[132:135], a[100:103], v[84:87]
  buffer_load_dwordx4 a[144:147], v16, s[8:11], s46 offen offset:2048 sc1
  buffer_load_dwordx4 a[148:151], v17, s[8:11], s46 offen offset:2048 sc1
  v_mfma_f32_16x16x32_bf16 v[64:67], v[132:135], a[96:99], v[64:67]
  ds_read_b128 v[132:135], v9 offset:49152
  v_mfma_f32_16x16x32_bf16 v[88:91], v[136:139], a[100:103], v[88:91]
  v_mfma_f32_16x16x32_bf16 v[68:71], v[136:139], a[96:99], v[68:71]
  ds_read_b128 v[136:139], v9 offset:51200
  s_waitcnt lgkmcnt(6)
  v_mfma_f32_16x16x32_bf16 v[92:95], v[140:143], a[100:103], v[92:95]
  s_add_u32 m0, s30, 49152
  s_add_u32 s45, s34, 229376
  v_mfma_f32_16x16x32_bf16 v[72:75], v[140:143], a[96:99], v[72:75]
  ds_read_b128 v[140:143], v9 offset:53248
  buffer_load_dwordx4 v11, s[8:11], s45 offen lds
  v_mfma_f32_16x16x32_bf16 v[96:99], v[144:147], a[100:103], v[96:99]
  buffer_load_dwordx4 v11, s[8:11], s45 offen offset:1024 lds
  v_mfma_f32_16x16x32_bf16 v[76:79], v[144:147], a[96:99], v[76:79]
  ds_read_b128 v[144:147], v9 offset:55296
  s_waitcnt vmcnt(24) lgkmcnt(6)
  v_mfma_f32_16x16x32_bf16 v[100:103], v[148:151], a[100:103], v[100:103]
  s_barrier
  v_mfma_f32_16x16x32_bf16 v[80:83], v[148:151], a[96:99], v[80:83]
  ds_read_b128 v[148:151], v9 offset:57344
  v_mfma_f32_16x16x32_bf16 v[84:87], v[152:155], a[108:111], v[84:87]
  buffer_load_dwordx4 a[152:155], v16, s[8:11], s46 offen offset:3072 sc1
  buffer_load_dwordx4 a[156:159], v17, s[8:11], s46 offen offset:3072 sc1
  v_mfma_f32_16x16x32_bf16 v[64:67], v[152:155], a[104:107], v[64:67]
  ds_read_b128 v[152:155], v9 offset:59392
  s_waitcnt lgkmcnt(6)
  v_mfma_f32_16x16x32_bf16 v[88:91], v[156:159], a[108:111], v[88:91]
  s_add_u32 m0, s30, 57344
  s_add_u32 s45, s34, 237568
  v_mfma_f32_16x16x32_bf16 v[68:71], v[156:159], a[104:107], v[68:71]
  ds_read_b128 v[156:159], v9 offset:61440
  buffer_load_dwordx4 v11, s[8:11], s45 offen lds
  v_mfma_f32_16x16x32_bf16 v[92:95], v[128:131], a[108:111], v[92:95]
  buffer_load_dwordx4 v11, s[8:11], s45 offen offset:1024 lds
  v_mfma_f32_16x16x32_bf16 v[72:75], v[128:131], a[104:107], v[72:75]
  ds_read_b128 v[128:131], v9 offset:63488
  s_waitcnt lgkmcnt(6)
  v_mfma_f32_16x16x32_bf16 v[96:99], v[132:135], a[108:111], v[96:99]
  v_mfma_f32_16x16x32_bf16 v[76:79], v[132:135], a[104:107], v[76:79]
  ds_read_b128 v[132:135], v10
  v_mfma_f32_16x16x32_bf16 v[100:103], v[136:139], a[108:111], v[100:103]
  v_mfma_f32_16x16x32_bf16 v[80:83], v[136:139], a[104:107], v[80:83]
  ds_read_b128 v[136:139], v10 offset:2048
  s_waitcnt vmcnt(24) lgkmcnt(6)
  v_mfma_f32_16x16x32_bf16 v[84:87], v[140:143], a[116:119], v[84:87]
  s_add_u32 s46, s36, 13783040
  buffer_load_dwordx4 a[0:3], v16, s[8:11], s46 offen sc1
  v_mfma_f32_16x16x32_bf16 v[64:67], v[140:143], a[112:115], v[64:67]
  ds_read_b128 v[140:143], v10 offset:4096
  buffer_load_dwordx4 a[4:7], v17, s[8:11], s46 offen sc1
  v_mfma_f32_16x16x32_bf16 v[88:91], v[144:147], a[116:119], v[88:91]
  s_add_u32 m0, s30, 65536
  s_add_u32 s45, s34, 245760
  v_mfma_f32_16x16x32_bf16 v[68:71], v[144:147], a[112:115], v[68:71]
  ds_read_b128 v[144:147], v10 offset:6144
  s_waitcnt lgkmcnt(6)
  v_mfma_f32_16x16x32_bf16 v[92:95], v[148:151], a[116:119], v[92:95]
  buffer_load_dwordx4 v11, s[8:11], s45 offen lds
  buffer_load_dwordx4 v11, s[8:11], s45 offen offset:1024 lds
  v_mfma_f32_16x16x32_bf16 v[72:75], v[148:151], a[112:115], v[72:75]
  ds_read_b128 v[148:151], v10 offset:8192
  v_mfma_f32_16x16x32_bf16 v[96:99], v[152:155], a[116:119], v[96:99]
  v_mfma_f32_16x16x32_bf16 v[76:79], v[152:155], a[112:115], v[76:79]
  ds_read_b128 v[152:155], v10 offset:10240
  s_waitcnt vmcnt(24) lgkmcnt(6)
  v_mfma_f32_16x16x32_bf16 v[100:103], v[156:159], a[116:119], v[100:103]
  s_add_u32 m0, s30, 73728
  s_add_u32 s45, s34, 253952
  v_mfma_f32_16x16x32_bf16 v[80:83], v[156:159], a[112:115], v[80:83]
  ds_read_b128 v[156:159], v10 offset:12288
  buffer_load_dwordx4 v11, s[8:11], s45 offen lds
  v_mfma_f32_16x16x32_bf16 v[84:87], v[128:131], a[124:127], v[84:87]
  buffer_load_dwordx4 v11, s[8:11], s45 offen offset:1024 lds
  buffer_load_dwordx4 a[8:11], v16, s[8:11], s46 offen offset:1024 sc1
  v_mfma_f32_16x16x32_bf16 v[64:67], v[128:131], a[120:123], v[64:67]
  ds_read_b128 v[128:131], v10 offset:14336
  s_waitcnt lgkmcnt(6)
  v_mfma_f32_16x16x32_bf16 v[88:91], v[132:135], a[124:127], v[88:91]
  s_barrier
  v_mfma_f32_16x16x32_bf16 v[68:71], v[132:135], a[120:123], v[68:71]
  ds_read_b128 v[132:135], v10 offset:16384
  buffer_load_dwordx4 a[12:15], v17, s[8:11], s46 offen offset:1024 sc1
  v_mfma_f32_16x16x32_bf16 v[92:95], v[136:139], a[124:127], v[92:95]
  v_mfma_f32_16x16x32_bf16 v[72:75], v[136:139], a[120:123], v[72:75]
  ds_read_b128 v[136:139], v10 offset:18432
  s_waitcnt lgkmcnt(6)
  v_mfma_f32_16x16x32_bf16 v[96:99], v[140:143], a[124:127], v[96:99]
  s_add_u32 m0, s30, 81920
  s_add_u32 s45, s34, 262144
  v_mfma_f32_16x16x32_bf16 v[76:79], v[140:143], a[120:123], v[76:79]
  ds_read_b128 v[140:143], v10 offset:20480
  buffer_load_dwordx4 v11, s[8:11], s45 offen lds
  v_mfma_f32_16x16x32_bf16 v[100:103], v[144:147], a[124:127], v[100:103]
  buffer_load_dwordx4 v11, s[8:11], s45 offen offset:1024 lds
  v_mfma_f32_16x16x32_bf16 v[80:83], v[144:147], a[120:123], v[80:83]
  ds_read_b128 v[144:147], v10 offset:22528
  s_waitcnt vmcnt(26) lgkmcnt(6)
  v_mfma_f32_16x16x32_bf16 v[84:87], v[148:151], a[132:135], v[84:87]
  buffer_load_dwordx4 a[16:19], v16, s[8:11], s46 offen offset:2048 sc1
  buffer_load_dwordx4 a[20:23], v17, s[8:11], s46 offen offset:2048 sc1
  v_mfma_f32_16x16x32_bf16 v[64:67], v[148:151], a[128:131], v[64:67]
  ds_read_b128 v[148:151], v10 offset:24576
  v_mfma_f32_16x16x32_bf16 v[88:91], v[152:155], a[132:135], v[88:91]
  v_mfma_f32_16x16x32_bf16 v[68:71], v[152:155], a[128:131], v[68:71]
  ds_read_b128 v[152:155], v10 offset:26624
  s_waitcnt lgkmcnt(6)
  v_mfma_f32_16x16x32_bf16 v[92:95], v[156:159], a[132:135], v[92:95]
  s_add_u32 m0, s30, 90112
  s_add_u32 s45, s34, 270336
  v_mfma_f32_16x16x32_bf16 v[72:75], v[156:159], a[128:131], v[72:75]
  ds_read_b128 v[156:159], v10 offset:28672
  s_cmp_ge_u32 s24, 3
  s_cbranch_scc1 nopad_44
  buffer_load_dwordx4 v11, s[8:11], s45 offen lds
nopad_44:
  v_mfma_f32_16x16x32_bf16 v[96:99], v[128:131], a[132:135], v[96:99]
  s_cmp_ge_u32 s24, 3
  s_cbranch_scc1 nopad_45
  buffer_load_dwordx4 v11, s[8:11], s45 offen offset:1024 lds
nopad_45:
  v_mfma_f32_16x16x32_bf16 v[76:79], v[128:131], a[128:131], v[76:79]
  ds_read_b128 v[128:131], v10 offset:30720
  s_waitcnt vmcnt(22) lgkmcnt(6)
  v_mfma_f32_16x16x32_bf16 v[100:103], v[132:135], a[132:135], v[100:103]
  buffer_load_dwordx4 a[24:27], v16, s[8:11], s46 offen offset:3072 sc1
  v_mfma_f32_16x16x32_bf16 v[80:83], v[132:135], a[128:131], v[80:83]
  ds_read_b128 v[132:135], v8 offset:8192
  v_mfma_f32_16x16x32_bf16 v[84:87], v[136:139], a[140:143], v[84:87]
  buffer_load_dwordx4 a[28:31], v17, s[8:11], s46 offen offset:3072 sc1
  v_mfma_f32_16x16x32_bf16 v[64:67], v[136:139], a[136:139], v[64:67]
  ds_read_b128 v[136:139], v8 offset:10240
  s_waitcnt lgkmcnt(6)
  v_mfma_f32_16x16x32_bf16 v[88:91], v[140:143], a[140:143], v[88:91]
  v_mfma_f32_16x16x32_bf16 v[68:71], v[140:143], a[136:139], v[68:71]
  ds_read_b128 v[140:143], v8 offset:12288
  v_mfma_f32_16x16x32_bf16 v[92:95], v[144:147], a[140:143], v[92:95]
here_46:
  v_add_u32 v51, here_46-interleave_layers__linear_attn_block__dense_activation_squared_relu__prompt_kernel+1024, v38
  v_min_u32 v51, 57340, v51
  global_load_dword v49, v51, s[96:97]
  v_mfma_f32_16x16x32_bf16 v[72:75], v[144:147], a[136:139], v[72:75]
  ds_read_b128 v[144:147], v8 offset:14336
  s_waitcnt lgkmcnt(6)
  v_mfma_f32_16x16x32_bf16 v[96:99], v[148:151], a[140:143], v[96:99]
  s_barrier
  v_mfma_f32_16x16x32_bf16 v[76:79], v[148:151], a[136:139], v[76:79]
  ds_read_b128 v[148:151], v8 offset:16384
  v_mfma_f32_16x16x32_bf16 v[100:103], v[152:155], a[140:143], v[100:103]
  v_mfma_f32_16x16x32_bf16 v[80:83], v[152:155], a[136:139], v[80:83]
  ds_read_b128 v[152:155], v8 offset:18432
  s_waitcnt vmcnt(21) lgkmcnt(6)
  v_mfma_f32_16x16x32_bf16 v[84:87], v[156:159], a[148:151], v[84:87]
  s_add_u32 s46, s36, 13787136
  buffer_load_dwordx4 a[32:35], v16, s[8:11], s46 offen sc1
  v_mfma_f32_16x16x32_bf16 v[64:67], v[156:159], a[144:147], v[64:67]
  ds_read_b128 v[156:159], v8 offset:20480
  buffer_load_dwordx4 a[36:39], v17, s[8:11], s46 offen sc1
  v_mfma_f32_16x16x32_bf16 v[88:91], v[128:131], a[148:151], v[88:91]
  v_mfma_f32_16x16x32_bf16 v[68:71], v[128:131], a[144:147], v[68:71]
  ds_read_b128 v[128:131], v8 offset:22528
  s_waitcnt lgkmcnt(6)
  v_mfma_f32_16x16x32_bf16 v[92:95], v[132:135], a[148:151], v[92:95]
  v_mfma_f32_16x16x32_bf16 v[72:75], v[132:135], a[144:147], v[72:75]
  ds_read_b128 v[132:135], v8 offset:24576
  v_mfma_f32_16x16x32_bf16 v[96:99], v[136:139], a[148:151], v[96:99]
  v_mfma_f32_16x16x32_bf16 v[76:79], v[136:139], a[144:147], v[76:79]
  ds_read_b128 v[136:139], v8 offset:26624
  s_waitcnt vmcnt(19) lgkmcnt(6)
  v_mfma_f32_16x16x32_bf16 v[100:103], v[140:143], a[148:151], v[100:103]
  buffer_load_dwordx4 a[40:43], v16, s[8:11], s46 offen offset:1024 sc1
  v_mfma_f32_16x16x32_bf16 v[80:83], v[140:143], a[144:147], v[80:83]
  ds_read_b128 v[140:143], v8 offset:28672
  v_mfma_f32_16x16x32_bf16 v[84:87], v[144:147], a[156:159], v[84:87]
  buffer_load_dwordx4 a[44:47], v17, s[8:11], s46 offen offset:1024 sc1
  v_mfma_f32_16x16x32_bf16 v[64:67], v[144:147], a[152:155], v[64:67]
  ds_read_b128 v[144:147], v8 offset:30720
  s_waitcnt lgkmcnt(6)
  v_mfma_f32_16x16x32_bf16 v[88:91], v[148:151], a[156:159], v[88:91]
  v_mfma_f32_16x16x32_bf16 v[68:71], v[148:151], a[152:155], v[68:71]
  ds_read_b128 v[148:151], v8 offset:32768
  v_mfma_f32_16x16x32_bf16 v[92:95], v[152:155], a[156:159], v[92:95]
  v_mfma_f32_16x16x32_bf16 v[72:75], v[152:155], a[152:155], v[72:75]
  ds_read_b128 v[152:155], v8 offset:34816
  s_waitcnt lgkmcnt(6)
  v_mfma_f32_16x16x32_bf16 v[96:99], v[156:159], a[156:159], v[96:99]
  buffer_load_dwordx4 a[48:51], v16, s[8:11], s46 offen offset:2048 sc1
  v_mfma_f32_16x16x32_bf16 v[76:79], v[156:159], a[152:155], v[76:79]
  ds_read_b128 v[156:159], v8 offset:36864
  v_mfma_f32_16x16x32_bf16 v[100:103], v[128:131], a[156:159], v[100:103]
  v_mfma_f32_16x16x32_bf16 v[80:83], v[128:131], a[152:155], v[80:83]
  ds_read_b128 v[128:131], v8 offset:38912
  s_waitcnt vmcnt(18) lgkmcnt(6)
  v_mfma_f32_16x16x32_bf16 v[84:87], v[132:135], a[4:7], v[84:87]
  s_barrier
  v_mfma_f32_16x16x32_bf16 v[64:67], v[132:135], a[0:3], v[64:67]
  ds_read_b128 v[132:135], v8 offset:40960
  buffer_load_dwordx4 a[52:55], v17, s[8:11], s46 offen offset:2048 sc1
  v_mfma_f32_16x16x32_bf16 v[88:91], v[136:139], a[4:7], v[88:91]
  v_mfma_f32_16x16x32_bf16 v[68:71], v[136:139], a[0:3], v[68:71]
  ds_read_b128 v[136:139], v8 offset:43008
  s_waitcnt lgkmcnt(6)
  v_mfma_f32_16x16x32_bf16 v[92:95], v[140:143], a[4:7], v[92:95]
  v_mfma_f32_16x16x32_bf16 v[72:75], v[140:143], a[0:3], v[72:75]
  ds_read_b128 v[140:143], v8 offset:45056
  s_add_u32 m0, s30, 98304
  v_mfma_f32_16x16x32_bf16 v[96:99], v[144:147], a[4:7], v[96:99]
  s_add_u32 s45, s31, 0
  buffer_load_dwordx4 v11, s[8:11], s45 offen lds
  v_mfma_f32_16x16x32_bf16 v[76:79], v[144:147], a[0:3], v[76:79]
  ds_read_b128 v[144:147], v8 offset:47104
  s_waitcnt vmcnt(14) lgkmcnt(6)
  v_mfma_f32_16x16x32_bf16 v[100:103], v[148:151], a[4:7], v[100:103]
  v_mfma_f32_16x16x32_bf16 v[80:83], v[148:151], a[0:3], v[80:83]
  ds_read_b128 v[148:151], v8 offset:49152
  v_mfma_f32_16x16x32_bf16 v[84:87], v[152:155], a[12:15], v[84:87]
  v_mfma_f32_16x16x32_bf16 v[64:67], v[152:155], a[8:11], v[64:67]
  ds_read_b128 v[152:155], v8 offset:51200
  s_waitcnt lgkmcnt(6)
  v_mfma_f32_16x16x32_bf16 v[88:91], v[156:159], a[12:15], v[88:91]
  buffer_load_dwordx4 v11, s[8:11], s45 offen offset:1024 lds
  v_mfma_f32_16x16x32_bf16 v[68:71], v[156:159], a[8:11], v[68:71]
  ds_read_b128 v[156:159], v8 offset:53248
  v_mfma_f32_16x16x32_bf16 v[92:95], v[128:131], a[12:15], v[92:95]
  v_mfma_f32_16x16x32_bf16 v[72:75], v[128:131], a[8:11], v[72:75]
  ds_read_b128 v[128:131], v8 offset:55296
  s_waitcnt lgkmcnt(6)
  v_mfma_f32_16x16x32_bf16 v[96:99], v[132:135], a[12:15], v[96:99]
  s_add_u32 m0, s30, 106496
  s_add_u32 s45, s31, 8192
  v_mfma_f32_16x16x32_bf16 v[76:79], v[132:135], a[8:11], v[76:79]
  ds_read_b128 v[132:135], v8 offset:57344
  buffer_load_dwordx4 v11, s[8:11], s45 offen lds
  v_mfma_f32_16x16x32_bf16 v[100:103], v[136:139], a[12:15], v[100:103]
  v_mfma_f32_16x16x32_bf16 v[80:83], v[136:139], a[8:11], v[80:83]
  ds_read_b128 v[136:139], v8 offset:59392
  s_waitcnt vmcnt(12) lgkmcnt(6)
  v_mfma_f32_16x16x32_bf16 v[84:87], v[140:143], a[20:23], v[84:87]
  buffer_load_dwordx4 v11, s[8:11], s45 offen offset:1024 lds
  v_mfma_f32_16x16x32_bf16 v[64:67], v[140:143], a[16:19], v[64:67]
  ds_read_b128 v[140:143], v8 offset:61440
  v_mfma_f32_16x16x32_bf16 v[88:91], v[144:147], a[20:23], v[88:91]
  v_mfma_f32_16x16x32_bf16 v[68:71], v[144:147], a[16:19], v[68:71]
  ds_read_b128 v[144:147], v8 offset:63488
  s_waitcnt lgkmcnt(6)
  v_mfma_f32_16x16x32_bf16 v[92:95], v[148:151], a[20:23], v[92:95]
  s_barrier
  v_mfma_f32_16x16x32_bf16 v[72:75], v[148:151], a[16:19], v[72:75]
  ds_read_b128 v[148:151], v9
  s_add_u32 m0, s30, 114688
  v_mfma_f32_16x16x32_bf16 v[96:99], v[152:155], a[20:23], v[96:99]
  s_add_u32 s45, s31, 16384
  buffer_load_dwordx4 v11, s[8:11], s45 offen lds
  v_mfma_f32_16x16x32_bf16 v[76:79], v[152:155], a[16:19], v[76:79]
  ds_read_b128 v[152:155], v9 offset:2048
  s_waitcnt vmcnt(12) lgkmcnt(6)
  v_mfma_f32_16x16x32_bf16 v[100:103], v[156:159], a[20:23], v[100:103]
  buffer_load_dwordx4 v11, s[8:11], s45 offen offset:1024 lds
  v_mfma_f32_16x16x32_bf16 v[80:83], v[156:159], a[16:19], v[80:83]
  ds_read_b128 v[156:159], v9 offset:4096
  v_mfma_f32_16x16x32_bf16 v[84:87], v[128:131], a[28:31], v[84:87]
  v_mfma_f32_16x16x32_bf16 v[64:67], v[128:131], a[24:27], v[64:67]
  ds_read_b128 v[128:131], v9 offset:6144
  s_waitcnt lgkmcnt(6)
  v_mfma_f32_16x16x32_bf16 v[88:91], v[132:135], a[28:31], v[88:91]
  v_mfma_f32_16x16x32_bf16 v[68:71], v[132:135], a[24:27], v[68:71]
  ds_read_b128 v[132:135], v9 offset:8192
  v_mfma_f32_16x16x32_bf16 v[92:95], v[136:139], a[28:31], v[92:95]
  v_mfma_f32_16x16x32_bf16 v[72:75], v[136:139], a[24:27], v[72:75]
  ds_read_b128 v[136:139], v9 offset:10240
  s_waitcnt lgkmcnt(6)
  v_mfma_f32_16x16x32_bf16 v[96:99], v[140:143], a[28:31], v[96:99]
  v_mfma_f32_16x16x32_bf16 v[76:79], v[140:143], a[24:27], v[76:79]
  ds_read_b128 v[140:143], v9 offset:12288
  v_mfma_f32_16x16x32_bf16 v[100:103], v[144:147], a[28:31], v[100:103]
  v_mfma_f32_16x16x32_bf16 v[80:83], v[144:147], a[24:27], v[80:83]
  ds_read_b128 v[144:147], v9 offset:14336
  s_waitcnt vmcnt(10) lgkmcnt(6)
  v_mfma_f32_16x16x32_bf16 v[84:87], v[148:151], a[36:39], v[84:87]
  v_mfma_f32_16x16x32_bf16 v[64:67], v[148:151], a[32:35], v[64:67]
  ds_read_b128 v[148:151], v9 offset:16384
  v_mfma_f32_16x16x32_bf16 v[88:91], v[152:155], a[36:39], v[88:91]
  v_mfma_f32_16x16x32_bf16 v[68:71], v[152:155], a[32:35], v[68:71]
  ds_read_b128 v[152:155], v9 offset:18432
  s_waitcnt lgkmcnt(6)
  v_mfma_f32_16x16x32_bf16 v[92:95], v[156:159], a[36:39], v[92:95]
  v_mfma_f32_16x16x32_bf16 v[72:75], v[156:159], a[32:35], v[72:75]
  ds_read_b128 v[156:159], v9 offset:20480
  v_mfma_f32_16x16x32_bf16 v[96:99], v[128:131], a[36:39], v[96:99]
  v_mfma_f32_16x16x32_bf16 v[76:79], v[128:131], a[32:35], v[76:79]
  ds_read_b128 v[128:131], v9 offset:22528
  s_waitcnt vmcnt(8) lgkmcnt(6)
  v_mfma_f32_16x16x32_bf16 v[100:103], v[132:135], a[36:39], v[100:103]
  s_barrier
  v_mfma_f32_16x16x32_bf16 v[80:83], v[132:135], a[32:35], v[80:83]
  ds_read_b128 v[132:135], v9 offset:24576
  v_mfma_f32_16x16x32_bf16 v[84:87], v[136:139], a[44:47], v[84:87]
  v_mfma_f32_16x16x32_bf16 v[64:67], v[136:139], a[40:43], v[64:67]
  ds_read_b128 v[136:139], v9 offset:26624
  s_waitcnt lgkmcnt(6)
  v_mfma_f32_16x16x32_bf16 v[88:91], v[140:143], a[44:47], v[88:91]
  v_mfma_f32_16x16x32_bf16 v[68:71], v[140:143], a[40:43], v[68:71]
  ds_read_b128 v[140:143], v9 offset:28672
  v_mfma_f32_16x16x32_bf16 v[92:95], v[144:147], a[44:47], v[92:95]
  v_mfma_f32_16x16x32_bf16 v[72:75], v[144:147], a[40:43], v[72:75]
  s_waitcnt lgkmcnt(5)
  v_mfma_f32_16x16x32_bf16 v[96:99], v[148:151], a[44:47], v[96:99]
  v_mfma_f32_16x16x32_bf16 v[76:79], v[148:151], a[40:43], v[76:79]
  v_mfma_f32_16x16x32_bf16 v[100:103], v[152:155], a[44:47], v[100:103]
  v_mfma_f32_16x16x32_bf16 v[80:83], v[152:155], a[40:43], v[80:83]
  s_waitcnt vmcnt(6) lgkmcnt(3)
  v_mfma_f32_16x16x32_bf16 v[84:87], v[156:159], a[52:55], v[84:87]
  v_mfma_f32_16x16x32_bf16 v[64:67], v[156:159], a[48:51], v[64:67]
  v_mfma_f32_16x16x32_bf16 v[88:91], v[128:131], a[52:55], v[88:91]
  v_mfma_f32_16x16x32_bf16 v[68:71], v[128:131], a[48:51], v[68:71]
  s_waitcnt lgkmcnt(1)
  v_mfma_f32_16x16x32_bf16 v[92:95], v[132:135], a[52:55], v[92:95]
  s_barrier
  v_mfma_f32_16x16x32_bf16 v[72:75], v[132:135], a[48:51], v[72:75]
  v_mfma_f32_16x16x32_bf16 v[96:99], v[136:139], a[52:55], v[96:99]
  v_mfma_f32_16x16x32_bf16 v[76:79], v[136:139], a[48:51], v[76:79]
  s_waitcnt lgkmcnt(0)
  v_mfma_f32_16x16x32_bf16 v[100:103], v[140:143], a[52:55], v[100:103]
  v_mfma_f32_16x16x32_bf16 v[80:83], v[140:143], a[48:51], v[80:83]
  ds_write_b128 v200, v[84:87]
  ds_write_b128 v200, v[88:91] offset:1024
  ds_write_b128 v200, v[92:95] offset:2048
  s_nop 0
  ds_write_b128 v200, v[96:99] offset:3072
  s_nop 1
  ds_write_b128 v200, v[100:103] offset:4096
  s_waitcnt lgkmcnt(0)
  s_barrier
  ds_read_b128 v[204:207], v201
  ds_read_b128 v[208:211], v201 offset:1024
  ds_read_b128 v[212:215], v201 offset:2048
  ds_read_b128 v[216:219], v201 offset:3072
  ds_read_b128 v[220:223], v201 offset:4096
  s_waitcnt lgkmcnt(4)
  v_pk_add_f32 v[64:65], v[64:65], v[204:205]
  v_pk_fma_f32 v[64:65], v[64:65], v[202:203], v[160:161] op_sel_hi:[1,0,1]
  v_pk_add_f32 v[66:67], v[66:67], v[206:207]
  v_pk_fma_f32 v[66:67], v[66:67], v[202:203], v[162:163] op_sel_hi:[1,0,1]
  s_waitcnt lgkmcnt(3)
  v_pk_add_f32 v[68:69], v[68:69], v[208:209]
  v_pk_fma_f32 v[68:69], v[68:69], v[202:203], v[164:165] op_sel_hi:[1,0,1]
  v_pk_add_f32 v[70:71], v[70:71], v[210:211]
  v_pk_fma_f32 v[70:71], v[70:71], v[202:203], v[166:167] op_sel_hi:[1,0,1]
  s_waitcnt lgkmcnt(2)
  v_pk_add_f32 v[72:73], v[72:73], v[212:213]
  v_pk_fma_f32 v[72:73], v[72:73], v[202:203], v[168:169] op_sel_hi:[1,0,1]
  v_pk_add_f32 v[74:75], v[74:75], v[214:215]
  v_pk_fma_f32 v[74:75], v[74:75], v[202:203], v[170:171] op_sel_hi:[1,0,1]
  s_waitcnt lgkmcnt(1)
  v_pk_add_f32 v[76:77], v[76:77], v[216:217]
  v_pk_fma_f32 v[76:77], v[76:77], v[202:203], v[172:173] op_sel_hi:[1,0,1]
  v_pk_add_f32 v[78:79], v[78:79], v[218:219]
  v_pk_fma_f32 v[78:79], v[78:79], v[202:203], v[174:175] op_sel_hi:[1,0,1]
  s_waitcnt lgkmcnt(0)
  v_pk_add_f32 v[80:81], v[80:81], v[220:221]
  v_pk_fma_f32 v[80:81], v[80:81], v[202:203], v[176:177] op_sel_hi:[1,0,1]
  v_pk_add_f32 v[82:83], v[82:83], v[222:223]
  v_pk_fma_f32 v[82:83], v[82:83], v[202:203], v[178:179] op_sel_hi:[1,0,1]
  v_cvt_pk_bf16_f32 v224, v64, v68
  v_cvt_pk_bf16_f32 v225, v65, v69
  v_cvt_pk_bf16_f32 v226, v66, v70
  v_cvt_pk_bf16_f32 v227, v67, v71
  v_cvt_pk_bf16_f32 v228, v72, v76
  v_cvt_pk_bf16_f32 v229, v73, v77
  v_cvt_pk_bf16_f32 v230, v74, v78
  v_cvt_pk_bf16_f32 v231, v75, v79
  v_cvt_pk_bf16_f32 v232, v80, v81
  v_cvt_pk_bf16_f32 v233, v82, v83
  s_cmp_eq_u32 s47, 0
  s_cbranch_scc1 st_safe_47
  buffer_store_dwordx4 v[224:227], v32, s[8:11], s41 offen
  buffer_store_dwordx4 v[228:231], v32, s[8:11], s41 offen offset:1024
  buffer_store_dwordx2 v[232:233], v33, s[8:11], s42 offen
  s_branch st_end_48
st_safe_47:
  buffer_store_dwordx4 v[224:227], v32, s[8:11], s41 offen sc1
  buffer_store_dwordx4 v[228:231], v32, s[8:11], s41 offen offset:1024 sc1
  buffer_store_dwordx2 v[232:233], v33, s[8:11], s42 offen sc1
st_end_48:
  v_mov_b32 v236, 0
  v_mov_b32 v237, 0
  v_dot2c_f32_bf16 v236, v224, v30
  v_dot2c_f32_bf16 v237, v224, v224
  v_dot2c_f32_bf16 v236, v225, v30
  v_dot2c_f32_bf16 v237, v225, v225
  v_dot2c_f32_bf16 v236, v226, v30
  v_dot2c_f32_bf16 v237, v226, v226
  v_dot2c_f32_bf16 v236, v227, v30
  v_dot2c_f32_bf16 v237, v227, v227
  v_dot2c_f32_bf16 v236, v228, v30
  v_dot2c_f32_bf16 v237, v228, v228
  v_dot2c_f32_bf16 v236, v229, v30
  v_dot2c_f32_bf16 v237, v229, v229
  v_dot2c_f32_bf16 v236, v230, v30
  v_dot2c_f32_bf16 v237, v230, v230
  v_dot2c_f32_bf16 v236, v231, v30
  v_dot2c_f32_bf16 v237, v231, v231
  v_dot2c_f32_bf16 v236, v232, v30
  v_dot2c_f32_bf16 v237, v232, v232
  v_dot2c_f32_bf16 v236, v233, v30
  v_dot2c_f32_bf16 v237, v233, v233
  s_nop 2
  v_permlane32_swap_b32 v236, v237
  v_add_f32 v236, v236, v237
  v_mov_b32 v238, v236
  s_nop 1
  v_permlane16_swap_b32 v236, v238
  v_add_f32 v236, v236, v238
  s_cmp_eq_u32 s47, 0
  s_cbranch_scc1 st_safe_49
  buffer_store_dword v236, v19, s[8:11], s43 offen
  s_branch st_end_50
st_safe_49:
  buffer_store_dword v236, v19, s[8:11], s43 offen sc1
st_end_50:
  v_add_u32 v55, 122880, v11
  ds_write_b128 v55, a[160:163]
  ds_write_b128 v55, a[164:167] offset:1024
  v_add_u32 v55, 131072, v11
  ds_read_b128 a[160:163], v55
  ds_read_b128 a[164:167], v55 offset:1024
  ds_write_b128 v55, a[168:171]
  ds_write_b128 v55, a[172:175] offset:1024
  s_waitcnt lgkmcnt(0)
  s_waitcnt vmcnt(0)
  s_barrier
  s_lshl_b32 s41, s47, 2
  s_add_u32 s41, s41, s24
  s_cmp_lg_u32 s41, 1
  s_cbranch_scc1 noflag_51
  s_lshl_b32 s41, s26, 2
  v_mov_b32 v237, s41
  s_add_u32 s41, s92, 5
  v_mov_b32 v238, s41
  s_mov_b64 exec, 1
  buffer_store_dword v238, v237, s[8:11], s39 offen sc1
  s_mov_b64 exec, -1
noflag_51:
  s_cmp_lg_u32 s24, 2
  s_cbranch_scc1 noflag_52
  s_lshl_b32 s41, s26, 2
  v_mov_b32 v237, s41
  s_add_u32 s41, s92, 5
  v_mov_b32 v238, s41
  s_mov_b64 exec, 1
  buffer_store_dword v238, v237, s[8:11], s38 offen
  s_mov_b64 exec, -1
noflag_52:
  s_add_u32 m0, s30, 65536
  s_add_u32 s45, s31, 122880
  buffer_load_dwordx4 v11, s[8:11], s45 offen lds
  buffer_load_dwordx4 v11, s[8:11], s45 offen offset:1024 lds
  s_add_u32 m0, s30, 73728
  s_add_u32 s45, s31, 131072
  buffer_load_dwordx4 v11, s[8:11], s45 offen lds
  buffer_load_dwordx4 v11, s[8:11], s45 offen offset:1024 lds
  ds_read_b128 v[144:147], v6 offset:32768
  ds_read_b128 v[148:151], v6 offset:33792
  ds_read_b128 v[152:155], v6 offset:34816
  ds_read_b128 v[156:159], v6 offset:35840
  ds_read_b128 v[128:131], v6 offset:36864
  ds_read_b128 v[132:135], v6 offset:37888
  ds_read_b128 v[136:139], v6 offset:38912
  ds_read_b128 v[140:143], v6 offset:39936
  v_add_u32 v55, 139264, v11
  ds_read_b128 a[168:171], v55
  ds_read_b128 a[172:175], v55 offset:1024
  ds_write_b128 v55, a[176:179]
  ds_write_b128 v55, a[180:183] offset:1024
  v_add_u32 v55, 147456, v11
  ds_read_b128 a[176:179], v55
  ds_read_b128 a[180:183], v55 offset:1024
  ds_write_b128 v55, a[184:187]
  ds_write_b128 v55, a[188:191] offset:1024
  v_add_u32 v55, 155648, v11
  ds_read_b128 a[184:187], v55
  ds_read_b128 a[188:191], v55 offset:1024
  ds_write_b128 v55, a[192:195]
  ds_write_b128 v55, a[196:199] offset:1024
  v_add_u32 v55, 8192, v11
  ds_read_b128 a[192:195], v55
  ds_read_b128 a[196:199], v55 offset:1024
  ds_write_b128 v55, a[200:203]
  ds_write_b128 v55, a[204:207] offset:1024
  v_add_u32 v55, 16384, v11
  ds_read_b128 a[200:203], v55
  ds_read_b128 a[204:207], v55 offset:1024
  ds_write_b128 v55, a[208:211]
  ds_write_b128 v55, a[212:215] offset:1024
  v_add_u32 v55, 24576, v11
  ds_read_b128 a[208:211], v55
  ds_read_b128 a[212:215], v55 offset:1024
  ds_write_b128 v55, a[216:219]
  ds_write_b128 v55, a[220:223] offset:1024
  v_add_u32 v55, 32768, v11
  ds_read_b128 a[216:219], v55
  ds_read_b128 a[220:223], v55 offset:1024
  ds_write_b128 v55, a[224:227]
  ds_write_b128 v55, a[228:231] offset:1024
  v_add_u32 v55, 40960, v11
  ds_read_b128 a[224:227], v55
  ds_read_b128 a[228:231], v55 offset:1024
  ds_write_b128 v55, a[232:235]
  ds_write_b128 v55, a[236:239] offset:1024
  v_lshlrev_b32 v160, 16, v224
  v_and_b32 v164, 0xffff0000, v224
  v_lshlrev_b32 v161, 16, v225
  v_and_b32 v165, 0xffff0000, v225
  v_lshlrev_b32 v162, 16, v226
  v_and_b32 v166, 0xffff0000, v226
  v_lshlrev_b32 v163, 16, v227
  v_and_b32 v167, 0xffff0000, v227
  v_lshlrev_b32 v168, 16, v228
  v_and_b32 v172, 0xffff0000, v228
  v_lshlrev_b32 v169, 16, v229
  v_and_b32 v173, 0xffff0000, v229
  v_lshlrev_b32 v170, 16, v230
  v_and_b32 v174, 0xffff0000, v230
  v_lshlrev_b32 v171, 16, v231
  v_and_b32 v175, 0xffff0000, v231
  v_lshlrev_b32 v176, 16, v232
  v_and_b32 v177, 0xffff0000, v232
  v_lshlrev_b32 v178, 16, v233
  v_and_b32 v179, 0xffff0000, v233
  s_cmp_lg_u32 s24, 0
  s_cbranch_scc1 nopoll_53
  s_mov_b32 s50, 0
  s_mov_b64 s[94:95], 0
  s_add_u32 s42, s92, 5
  s_cmp_eq_u32 s47, 0
  s_cselect_b32 s43, 3, -1
poll_54:
  buffer_load_dword v238, v36, s[8:11], s38 offen sc1
  s_add_u32 s50, s50, 1
  s_waitcnt vmcnt(0)
  v_subrev_u32 v238, s42, v238
  v_cmp_ge_u32 vcc, 1, v238
  s_or_b64 s[94:95], s[94:95], vcc
  s_cmp_eq_u64 s[94:95], -1
  s_cbranch_scc1 nopoll_53
  s_and_b32 s41, s50, s43
  s_cbranch_scc1 pollnext_55
  buffer_load_dword v238, v36, s[8:11], s39 offen sc1
  s_waitcnt vmcnt(0)
  v_subrev_u32 v238, s42, v238
  v_cmp_ge_u32 vcc, 1, v238
  s_or_b64 s[94:95], s[94:95], vcc
  s_cmp_eq_u64 s[94:95], -1
  s_cbranch_scc1 nopoll_53
pollnext_55:
  s_cmp_lt_u32 s50, 0x80000
  s_cbranch_scc1 poll_54
nopoll_53:
  s_barrier
  s_add_u32 s46, s35, 8388608
  buffer_load_dwordx4 a[0:3], v12, s[8:11], s46 offen sc1
  buffer_load_dwordx4 a[4:7], v13, s[8:11], s46 offen sc1
  buffer_load_dwordx4 a[8:11], v12, s[8:11], s46 offen offset:1024 sc1
  buffer_load_dwordx4 a[12:15], v13, s[8:11], s46 offen offset:1024 sc1
  buffer_load_dwordx4 a[16:19], v12, s[8:11], s46 offen offset:2048 sc1
  buffer_load_dwordx4 a[20:23], v13, s[8:11], s46 offen offset:2048 sc1
  buffer_load_dwordx4 a[24:27], v12, s[8:11], s46 offen offset:3072 sc1
  buffer_load_dwordx4 a[28:31], v13, s[8:11], s46 offen offset:3072 sc1
  s_add_u32 s41, s37, 11010048
  buffer_load_dwordx2 v[200:201], v18, s[8:11], s41 offen sc1
  buffer_load_dwordx2 v[202:203], v18, s[8:11], s41 offen offset:1024 sc1
  buffer_load_dwordx2 v[204:205], v18, s[8:11], s41 offen offset:128 sc1
  buffer_load_dwordx2 v[206:207], v18, s[8:11], s41 offen offset:1152 sc1
  s_waitcnt vmcnt(10) lgkmcnt(15)
  v_mfma_f32_16x16x32_bf16 v[64:67], a[0:3], v[144:147], 0
  s_add_u32 s46, s35, 8392704
  buffer_load_dwordx4 a[32:35], v12, s[8:11], s46 offen sc1
  v_mfma_f32_16x16x32_bf16 v[68:71], a[4:7], v[144:147], 0
  ds_read_b128 v[144:147], v6 offset:40960
  buffer_load_dwordx4 a[36:39], v13, s[8:11], s46 offen sc1
  v_mfma_f32_16x16x32_bf16 v[72:75], a[0:3], v[148:151], 0
  buffer_load_dwordx4 a[40:43], v12, s[8:11], s46 offen offset:1024 sc1
  buffer_load_dwordx4 a[44:47], v13, s[8:11], s46 offen offset:1024 sc1
  v_mfma_f32_16x16x32_bf16 v[76:79], a[4:7], v[148:151], 0
  ds_read_b128 v[148:151], v6 offset:41984
  s_waitcnt lgkmcnt(15)
  v_mfma_f32_16x16x32_bf16 v[80:83], a[0:3], v[152:155], 0
  buffer_load_dwordx4 a[48:51], v12, s[8:11], s46 offen offset:2048 sc1
  buffer_load_dwordx4 a[52:55], v13, s[8:11], s46 offen offset:2048 sc1
  v_mfma_f32_16x16x32_bf16 v[84:87], a[4:7], v[152:155], 0
  ds_read_b128 v[152:155], v6 offset:43008
  v_add_u32 v55, 49152, v11
  v_mfma_f32_16x16x32_bf16 v[88:91], a[0:3], v[156:159], 0
  ds_read_b128 a[232:235], v55
  ds_read_b128 a[236:239], v55 offset:1024
  v_mfma_f32_16x16x32_bf16 v[92:95], a[4:7], v[156:159], 0
  ds_read_b128 v[156:159], v6 offset:44032
  s_waitcnt vmcnt(14) lgkmcnt(15)
  v_mfma_f32_16x16x32_bf16 v[96:99], a[0:3], v[128:131], 0
  ds_write_b128 v55, a[240:243]
  buffer_load_dwordx4 a[56:59], v12, s[8:11], s46 offen offset:3072 sc1
  v_mfma_f32_16x16x32_bf16 v[100:103], a[4:7], v[128:131], 0
  ds_read_b128 v[128:131], v6 offset:45056
  ds_write_b128 v55, a[244:247] offset:1024
  v_mfma_f32_16x16x32_bf16 v[64:67], a[8:11], v[132:135], v[64:67]
  buffer_load_dwordx4 a[60:63], v13, s[8:11], s46 offen offset:3072 sc1
  v_add_u32 v55, 57344, v11
  v_mfma_f32_16x16x32_bf16 v[68:71], a[12:15], v[132:135], v[68:71]
  ds_read_b128 v[132:135], v6 offset:46080
  s_waitcnt lgkmcnt(15)
  v_mfma_f32_16x16x32_bf16 v[72:75], a[8:11], v[136:139], v[72:75]
  ds_read_b128 a[240:243], v55
  ds_read_b128 a[244:247], v55 offset:1024
  v_mfma_f32_16x16x32_bf16 v[76:79], a[12:15], v[136:139], v[76:79]
  ds_read_b128 v[136:139], v6 offset:47104
  ds_write_b128 v55, a[248:251]
  v_mfma_f32_16x16x32_bf16 v[80:83], a[8:11], v[140:143], v[80:83]
  s_add_u32 s46, s35, 8396800
  buffer_load_dwordx4 a[64:67], v12, s[8:11], s46 offen sc1
  v_mfma_f32_16x16x32_bf16 v[84:87], a[12:15], v[140:143], v[84:87]
  ds_read_b128 v[140:143], v6 offset:48128
  s_waitcnt lgkmcnt(13)
  v_mfma_f32_16x16x32_bf16 v[88:91], a[8:11], v[144:147], v[88:91]
  buffer_load_dwordx4 a[68:71], v13, s[8:11], s46 offen sc1
  ds_write_b128 v55, a[252:255] offset:1024
  v_mfma_f32_16x16x32_bf16 v[92:95], a[12:15], v[144:147], v[92:95]
  ds_read_b128 v[144:147], v6 offset:49152
  buffer_load_dwordx4 a[72:75], v12, s[8:11], s46 offen offset:1024 sc1
  v_mfma_f32_16x16x32_bf16 v[96:99], a[8:11], v[148:151], v[96:99]
  v_mfma_f32_16x16x32_bf16 v[100:103], a[12:15], v[148:151], v[100:103]
  ds_read_b128 v[148:151], v6 offset:50176
  s_waitcnt vmcnt(17) lgkmcnt(12)
  v_mfma_f32_16x16x32_bf16 v[64:67], a[16:19], v[152:155], v[64:67]
  buffer_load_dwordx4 a[76:79], v13, s[8:11], s46 offen offset:1024 sc1
  v_mfma_f32_16x16x32_bf16 v[68:71], a[20:23], v[152:155], v[68:71]
  ds_read_b128 v[152:155], v6 offset:51200
  v_mfma_f32_16x16x32_bf16 v[72:75], a[16:19], v[156:159], v[72:75]
  buffer_load_dwordx4 a[80:83], v12, s[8:11], s46 offen offset:2048 sc1
  v_mfma_f32_16x16x32_bf16 v[76:79], a[20:23], v[156:159], v[76:79]
  ds_read_b128 v[156:159], v6 offset:52224
  s_waitcnt lgkmcnt(10)
  v_mfma_f32_16x16x32_bf16 v[80:83], a[16:19], v[128:131], v[80:83]
  buffer_load_dwordx4 a[84:87], v13, s[8:11], s46 offen offset:2048 sc1
  v_mfma_f32_16x16x32_bf16 v[84:87], a[20:23], v[128:131], v[84:87]
  ds_read_b128 v[128:131], v6 offset:53248
  v_mfma_f32_16x16x32_bf16 v[88:91], a[16:19], v[132:135], v[88:91]
  buffer_load_dwordx4 a[88:91], v12, s[8:11], s46 offen offset:3072 sc1
  v_mfma_f32_16x16x32_bf16 v[92:95], a[20:23], v[132:135], v[92:95]
  ds_read_b128 v[132:135], v6 offset:54272
  s_waitcnt vmcnt(19) lgkmcnt(7)
  v_mfma_f32_16x16x32_bf16 v[96:99], a[16:19], v[136:139], v[96:99]
  v_mfma_f32_16x16x32_bf16 v[100:103], a[20:23], v[136:139], v[100:103]
  ds_read_b128 v[136:139], v6 offset:55296
  v_mfma_f32_16x16x32_bf16 v[64:67], a[24:27], v[140:143], v[64:67]
  v_mfma_f32_16x16x32_bf16 v[68:71], a[28:31], v[140:143], v[68:71]
  ds_read_b128 v[140:143], v6 offset:56320
  s_waitcnt lgkmcnt(6)
  v_mfma_f32_16x16x32_bf16 v[72:75], a[24:27], v[144:147], v[72:75]
  s_barrier
  v_mfma_f32_16x16x32_bf16 v[76:79], a[28:31], v[144:147], v[76:79]
  ds_read_b128 v[144:147], v6 offset:57344
  buffer_load_dwordx4 a[92:95], v13, s[8:11], s46 offen offset:3072 sc1
  v_mfma_f32_16x16x32_bf16 v[80:83], a[24:27], v[148:151], v[80:83]
  v_mfma_f32_16x16x32_bf16 v[84:87], a[28:31], v[148:151], v[84:87]
  ds_read_b128 v[148:151], v6 offset:58368
  s_waitcnt lgkmcnt(6)
  v_mfma_f32_16x16x32_bf16 v[88:91], a[24:27], v[152:155], v[88:91]
  s_add_u32 s46, s35, 8400896
  buffer_load_dwordx4 a[96:99], v12, s[8:11], s46 offen sc1
  v_mfma_f32_16x16x32_bf16 v[92:95], a[28:31], v[152:155], v[92:95]
  ds_read_b128 v[152:155], v6 offset:59392
  v_mfma_f32_16x16x32_bf16 v[96:99], a[24:27], v[156:159], v[96:99]
  v_mfma_f32_16x16x32_bf16 v[100:103], a[28:31], v[156:159], v[100:103]
  ds_read_b128 v[156:159], v6 offset:60416
  s_waitcnt vmcnt(15) lgkmcnt(6)
  v_mfma_f32_16x16x32_bf16 v[64:67], a[32:35], v[128:131], v[64:67]
  buffer_load_dwordx4 a[100:103], v13, s[8:11], s46 offen sc1
  v_mfma_f32_16x16x32_bf16 v[68:71], a[36:39], v[128:131], v[68:71]
  ds_read_b128 v[128:131], v6 offset:61440
  v_add_f32 v200, v200, v202
  v_mfma_f32_16x16x32_bf16 v[72:75], a[32:35], v[132:135], v[72:75]
  v_add_f32 v201, v201, v203
  v_mov_b32 v202, v200
  v_mfma_f32_16x16x32_bf16 v[76:79], a[36:39], v[132:135], v[76:79]
  ds_read_b128 v[132:135], v6 offset:62464
  s_waitcnt lgkmcnt(6)
  v_mfma_f32_16x16x32_bf16 v[80:83], a[32:35], v[136:139], v[80:83]
  buffer_load_dwordx4 a[104:107], v12, s[8:11], s46 offen offset:1024 sc1
  v_mov_b32 v203, v201
  v_mfma_f32_16x16x32_bf16 v[84:87], a[36:39], v[136:139], v[84:87]
  ds_read_b128 v[136:139], v6 offset:63488
  v_permlane32_swap_b32 v200, v202
  v_mfma_f32_16x16x32_bf16 v[88:91], a[32:35], v[140:143], v[88:91]
  v_permlane32_swap_b32 v201, v203
  v_add_f32 v200, v200, v202
  v_mfma_f32_16x16x32_bf16 v[92:95], a[36:39], v[140:143], v[92:95]
  ds_read_b128 v[140:143], v6 offset:64512
  s_waitcnt vmcnt(15) lgkmcnt(6)
  v_mfma_f32_16x16x32_bf16 v[96:99], a[32:35], v[144:147], v[96:99]
  v_add_f32 v201, v201, v203
  buffer_load_dwordx4 a[108:111], v13, s[8:11], s46 offen offset:1024 sc1
  v_mfma_f32_16x16x32_bf16 v[100:103], a[36:39], v[144:147], v[100:103]
  ds_read_b128 v[144:147], v7
  v_mov_b32 v202, v200
  v_mfma_f32_16x16x32_bf16 v[64:67], a[40:43], v[148:151], v[64:67]
  v_mov_b32 v203, v201
  v_permlane16_swap_b32 v200, v202
  v_mfma_f32_16x16x32_bf16 v[68:71], a[44:47], v[148:151], v[68:71]
  ds_read_b128 v[148:151], v7 offset:1024
  s_waitcnt lgkmcnt(6)
  v_mfma_f32_16x16x32_bf16 v[72:75], a[40:43], v[152:155], v[72:75]
  v_permlane16_swap_b32 v201, v203
  v_add_f32 v200, v200, v202
  v_mfma_f32_16x16x32_bf16 v[76:79], a[44:47], v[152:155], v[76:79]
  ds_read_b128 v[152:155], v7 offset:2048
  buffer_load_dwordx4 a[112:115], v12, s[8:11], s46 offen offset:2048 sc1
  v_mfma_f32_16x16x32_bf16 v[80:83], a[40:43], v[156:159], v[80:83]
  v_add_f32 v201, v201, v203
  v_mul_f32 v200, 0x3acccccd, v200
  v_mfma_f32_16x16x32_bf16 v[84:87], a[44:47], v[156:159], v[84:87]
  ds_read_b128 v[156:159], v7 offset:3072
  s_waitcnt lgkmcnt(6)
  v_mfma_f32_16x16x32_bf16 v[88:91], a[40:43], v[128:131], v[88:91]
  v_mul_f32 v202, v200, v200
  v_fma_f32 v201, v201, s63, -v202
  v_mfma_f32_16x16x32_bf16 v[92:95], a[44:47], v[128:131], v[92:95]
  ds_read_b128 v[128:131], v7 offset:4096
  buffer_load_dwordx4 a[116:119], v13, s[8:11], s46 offen offset:2048 sc1
  v_mfma_f32_16x16x32_bf16 v[96:99], a[40:43], v[132:135], v[96:99]
  v_max_f32 v201, 0, v201
  v_add_f32 v201, 0x3727c5ac, v201
  v_mfma_f32_16x16x32_bf16 v[100:103], a[44:47], v[132:135], v[100:103]
  ds_read_b128 v[132:135], v7 offset:5120
  s_waitcnt vmcnt(16) lgkmcnt(6)
  v_mfma_f32_16x16x32_bf16 v[64:67], a[48:51], v[136:139], v[64:67]
  v_rsq_f32 v202, v201
  v_cvt_pk_bf16_f32 v40, v200, v200
  v_mfma_f32_16x16x32_bf16 v[68:71], a[52:55], v[136:139], v[68:71]
  ds_read_b128 v[136:139], v7 offset:6144
  v_mul_f32 v201, v201, v202
  v_mfma_f32_16x16x32_bf16 v[72:75], a[48:51], v[140:143], v[72:75]
  buffer_load_dwordx4 a[120:123], v12, s[8:11], s46 offen offset:3072 sc1
  ds_write_b32 v26, v202
  v_mfma_f32_16x16x32_bf16 v[76:79], a[52:55], v[140:143], v[76:79]
  ds_read_b128 v[140:143], v7 offset:7168
  s_waitcnt lgkmcnt(7)
  v_mfma_f32_16x16x32_bf16 v[80:83], a[48:51], v[144:147], v[80:83]
  v_mul_f32 v48, 0x3fb8aa3b, v202
  v_lshlrev_b32 v203, 16, v40
  v_mfma_f32_16x16x32_bf16 v[84:87], a[52:55], v[144:147], v[84:87]
  ds_read_b128 v[144:147], v7 offset:8192
  v_sub_f32 v200, v200, v203
  v_mfma_f32_16x16x32_bf16 v[88:91], a[48:51], v[148:151], v[88:91]
  v_cvt_pk_bf16_f32 v41, v200, v201
  v_and_b32 v203, 0xffff0000, v41
  v_mfma_f32_16x16x32_bf16 v[92:95], a[52:55], v[148:151], v[92:95]
  ds_read_b128 v[148:151], v7 offset:9216
  s_waitcnt vmcnt(15) lgkmcnt(7)
  v_mfma_f32_16x16x32_bf16 v[96:99], a[48:51], v[152:155], v[96:99]
  buffer_load_dwordx4 a[124:127], v13, s[8:11], s46 offen offset:3072 sc1
  v_sub_f32 v203, v201, v203
  v_mfma_f32_16x16x32_bf16 v[100:103], a[52:55], v[152:155], v[100:103]
  ds_read_b128 v[152:155], v7 offset:10240
  v_cvt_pk_bf16_f32 v43, v200, v203
  v_mfma_f32_16x16x32_bf16 v[64:67], a[56:59], v[156:159], v[64:67]
  v_mov_b32 v42, v40
  v_add_f32 v204, v204, v206
  v_mfma_f32_16x16x32_bf16 v[68:71], a[60:63], v[156:159], v[68:71]
  ds_read_b128 v[156:159], v7 offset:11264
  s_waitcnt lgkmcnt(7)
  v_mfma_f32_16x16x32_bf16 v[72:75], a[56:59], v[128:131], v[72:75]
  s_add_u32 s46, s35, 8404992
  buffer_load_dwordx4 a[128:131], v12, s[8:11], s46 offen sc1
  v_mfma_f32_16x16x32_bf16 v[76:79], a[60:63], v[128:131], v[76:79]
  ds_read_b128 v[128:131], v7 offset:12288
  v_add_f32 v205, v205, v207
  v_mfma_f32_16x16x32_bf16 v[80:83], a[56:59], v[132:135], v[80:83]
  v_mov_b32 v206, v204
  v_mov_b32 v207, v205
  v_mfma_f32_16x16x32_bf16 v[84:87], a[60:63], v[132:135], v[84:87]
  ds_read_b128 v[132:135], v7 offset:13312
  s_waitcnt lgkmcnt(6)
  v_mfma_f32_16x16x32_bf16 v[88:91], a[56:59], v[136:139], v[88:91]
  buffer_load_dwordx4 a[132:135], v13, s[8:11], s46 offen sc1
  v_permlane32_swap_b32 v204, v206
  v_mfma_f32_16x16x32_bf16 v[92:95], a[60:63], v[136:139], v[92:95]
  ds_read_b128 v[136:139], v7 offset:14336
  v_permlane32_swap_b32 v205, v207
  v_mfma_f32_16x16x32_bf16 v[96:99], a[56:59], v[140:143], v[96:99]
  v_add_f32 v204, v204, v206
  v_add_f32 v205, v205, v207
  v_mfma_f32_16x16x32_bf16 v[100:103], a[60:63], v[140:143], v[100:103]
  ds_read_b128 v[140:143], v7 offset:15360
  s_waitcnt vmcnt(16) lgkmcnt(6)
  v_mfma_f32_16x16x32_bf16 v[64:67], a[64:67], v[144:147], v[64:67]
  s_barrier
  v_mfma_f32_16x16x32_bf16 v[68:71], a[68:71], v[144:147], v[68:71]
  ds_read_b128 v[144:147], v7 offset:16384
  buffer_load_dwordx4 a[136:139], v12, s[8:11], s46 offen offset:1024 sc1
  v_mfma_f32_16x16x32_bf16 v[72:75], a[64:67], v[148:151], v[72:75]
  v_mov_b32 v206, v204
  v_mov_b32 v207, v205
  v_mfma_f32_16x16x32_bf16 v[76:79], a[68:71], v[148:151], v[76:79]
  ds_read_b128 v[148:151], v7 offset:17408
  s_waitcnt lgkmcnt(6)
  v_mfma_f32_16x16x32_bf16 v[80:83], a[64:67], v[152:155], v[80:83]
  v_permlane16_swap_b32 v204, v206
  buffer_load_dwordx4 a[140:143], v13, s[8:11], s46 offen offset:1024 sc1
  v_mfma_f32_16x16x32_bf16 v[84:87], a[68:71], v[152:155], v[84:87]
  ds_read_b128 v[152:155], v7 offset:18432
  v_permlane16_swap_b32 v205, v207
  v_mfma_f32_16x16x32_bf16 v[88:91], a[64:67], v[156:159], v[88:91]
  v_add_f32 v204, v204, v206
  v_add_f32 v205, v205, v207
  v_mfma_f32_16x16x32_bf16 v[92:95], a[68:71], v[156:159], v[92:95]
  ds_read_b128 v[156:159], v7 offset:19456
  s_waitcnt vmcnt(16) lgkmcnt(6)
  v_mfma_f32_16x16x32_bf16 v[96:99], a[64:67], v[128:131], v[96:99]
  v_mul_f32 v204, 0x3acccccd, v204
  v_mul_f32 v206, v204, v204
  v_mfma_f32_16x16x32_bf16 v[100:103], a[68:71], v[128:131], v[100:103]
  ds_read_b128 v[128:131], v7 offset:20480
  buffer_load_dwordx4 a[144:147], v12, s[8:11], s46 offen offset:2048 sc1
  v_mfma_f32_16x16x32_bf16 v[64:67], a[72:75], v[132:135], v[64:67]
  v_fma_f32 v205, v205, s63, -v206
  v_max_f32 v205, 0, v205
  v_mfma_f32_16x16x32_bf16 v[68:71], a[76:79], v[132:135], v[68:71]
  ds_read_b128 v[132:135], v7 offset:21504
  s_waitcnt lgkmcnt(6)
  v_mfma_f32_16x16x32_bf16 v[72:75], a[72:75], v[136:139], v[72:75]
  v_add_f32 v205, 0x3727c5ac, v205
  v_rsq_f32 v206, v205
  v_mfma_f32_16x16x32_bf16 v[76:79], a[76:79], v[136:139], v[76:79]
  ds_read_b128 v[136:139], v7 offset:22528
  buffer_load_dwordx4 a[148:151], v13, s[8:11], s46 offen offset:2048 sc1
  v_mfma_f32_16x16x32_bf16 v[80:83], a[72:75], v[140:143], v[80:83]
  v_cvt_pk_bf16_f32 v44, v204, v204
  v_mul_f32 v205, v205, v206
  v_mfma_f32_16x16x32_bf16 v[84:87], a[76:79], v[140:143], v[84:87]
  ds_read_b128 v[140:143], v7 offset:23552
  s_waitcnt lgkmcnt(6)
  v_mfma_f32_16x16x32_bf16 v[88:91], a[72:75], v[144:147], v[88:91]
  ds_write_b32 v26, v206 offset:64
  v_mul_f32 v50, 0x3fb8aa3b, v206
  v_mfma_f32_16x16x32_bf16 v[92:95], a[76:79], v[144:147], v[92:95]
  ds_read_b128 v[144:147], v7 offset:24576
  v_lshlrev_b32 v207, 16, v44
  v_mfma_f32_16x16x32_bf16 v[96:99], a[72:75], v[148:151], v[96:99]
  buffer_load_dwordx4 a[152:155], v12, s[8:11], s46 offen offset:3072 sc1
  v_sub_f32 v204, v204, v207
  v_mfma_f32_16x16x32_bf16 v[100:103], a[76:79], v[148:151], v[100:103]
  ds_read_b128 v[148:151], v7 offset:25600
  s_waitcnt vmcnt(17) lgkmcnt(7)
  v_mfma_f32_16x16x32_bf16 v[64:67], a[80:83], v[152:155], v[64:67]
  v_cvt_pk_bf16_f32 v45, v204, v205
  v_and_b32 v207, 0xffff0000, v45
  v_mfma_f32_16x16x32_bf16 v[68:71], a[84:87], v[152:155], v[68:71]
  ds_read_b128 v[152:155], v7 offset:26624
  v_sub_f32 v207, v205, v207
  v_mfma_f32_16x16x32_bf16 v[72:75], a[80:83], v[156:159], v[72:75]
  v_cvt_pk_bf16_f32 v47, v204, v207
  buffer_load_dwordx4 a[156:159], v13, s[8:11], s46 offen offset:3072 sc1
  v_mfma_f32_16x16x32_bf16 v[76:79], a[84:87], v[156:159], v[76:79]
  ds_read_b128 v[156:159], v7 offset:27648
  s_waitcnt lgkmcnt(7)
  v_mfma_f32_16x16x32_bf16 v[80:83], a[80:83], v[128:131], v[80:83]
  v_mov_b32 v46, v44
  ds_read_b128 v[56:59], v25
  v_mfma_f32_16x16x32_bf16 v[84:87], a[84:87], v[128:131], v[84:87]
  ds_read_b128 v[128:131], v7 offset:28672
  ds_read_b128 v[60:63], v25 offset:64
  v_mfma_f32_16x16x32_bf16 v[88:91], a[80:83], v[132:135], v[88:91]
  s_mul_i32 s7, s24, 7168
  s_add_u32 s7, s7, 18432
  v_mfma_f32_16x16x32_bf16 v[92:95], a[84:87], v[132:135], v[92:95]
  ds_read_b128 v[132:135], v7 offset:29696
  s_waitcnt vmcnt(16) lgkmcnt(9)
  v_mfma_f32_16x16x32_bf16 v[96:99], a[80:83], v[136:139], v[96:99]
  s_add_u32 m0, s30, 81920
  s_add_u32 s45, s31, 139264
  v_mfma_f32_16x16x32_bf16 v[100:103], a[84:87], v[136:139], v[100:103]
  ds_read_b128 v[136:139], v7 offset:30720
  buffer_load_dwordx4 v11, s[8:11], s45 offen lds
  v_mfma_f32_16x16x32_bf16 v[64:67], a[88:91], v[140:143], v[64:67]
  v_add_u32 v224, s7, v4
  v_add_u32 v225, 18432, v20
  v_mfma_f32_16x16x32_bf16 v[68:71], a[92:95], v[140:143], v[68:71]
  ds_read_b128 v[140:143], v7 offset:31744
  s_waitcnt lgkmcnt(8)
  v_mfma_f32_16x16x32_bf16 v[72:75], a[88:91], v[144:147], v[72:75]
  buffer_load_dwordx4 v11, s[8:11], s45 offen offset:1024 lds
  s_mul_i32 s7, s25, 1792
  v_mfma_f32_16x16x32_bf16 v[76:79], a[92:95], v[144:147], v[76:79]
  ds_read_b128 v[144:147], v5 offset:8192
  s_add_u32 s7, s7, s61
  v_mfma_f32_16x16x32_bf16 v[80:83], a[88:91], v[148:151], v[80:83]
  s_add_u32 s7, s7, 21299200
  v_mfma_f32_16x16x32_bf16 v[84:87], a[92:95], v[148:151], v[84:87]
  ds_read_b128 v[148:151], v5 offset:9216
  s_waitcnt lgkmcnt(8)
  v_mfma_f32_16x16x32_bf16 v[88:91], a[88:91], v[152:155], v[88:91]
  v_mfma_f32_16x16x32_bf16 v[92:95], a[92:95], v[152:155], v[92:95]
  ds_read_b128 v[152:155], v5 offset:10240
  s_add_u32 m0, s30, 90112
  v_mfma_f32_16x16x32_bf16 v[96:99], a[88:91], v[156:159], v[96:99]
  s_add_u32 s45, s31, 147456
  buffer_load_dwordx4 v11, s[8:11], s45 offen lds
  v_mfma_f32_16x16x32_bf16 v[100:103], a[92:95], v[156:159], v[100:103]
  ds_read_b128 v[156:159], v5 offset:11264
  s_waitcnt vmcnt(17) lgkmcnt(6)
  v_mfma_f32_16x16x32_bf16 v[64:67], a[96:99], v[128:131], v[64:67]
  v_mfma_f32_16x16x32_bf16 v[68:71], a[100:103], v[128:131], v[68:71]
  ds_read_b128 v[128:131], v5 offset:12288
  buffer_load_dwordx4 v11, s[8:11], s45 offen offset:1024 lds
  v_mfma_f32_16x16x32_bf16 v[72:75], a[96:99], v[132:135], v[72:75]
  v_mfma_f32_16x16x32_bf16 v[76:79], a[100:103], v[132:135], v[76:79]
  ds_read_b128 v[132:135], v5 offset:13312
  s_waitcnt lgkmcnt(6)
  v_mfma_f32_16x16x32_bf16 v[80:83], a[96:99], v[136:139], v[80:83]
  v_mfma_f32_16x16x32_bf16 v[84:87], a[100:103], v[136:139], v[84:87]
  ds_read_b128 v[136:139], v5 offset:14336
  v_mfma_f32_16x16x32_bf16 v[88:91], a[96:99], v[140:143], v[88:91]
  s_add_u32 m0, s30, 98304
  s_add_u32 s45, s31, 155648
  v_mfma_f32_16x16x32_bf16 v[92:95], a[100:103], v[140:143], v[92:95]
  ds_read_b128 v[140:143], v5 offset:15360
  s_waitcnt vmcnt(16) lgkmcnt(6)
  v_mfma_f32_16x16x32_bf16 v[96:99], a[96:99], v[144:147], v[96:99]
  buffer_load_dwordx4 v11, s[8:11], s45 offen lds
  buffer_load_dwordx4 v11, s[8:11], s45 offen offset:1024 lds
  s_barrier
  v_mfma_f32_16x16x32_bf16 v[100:103], a[100:103], v[144:147], v[100:103]
  ds_read_b128 v[144:147], v5 offset:16384
  v_mfma_f32_16x16x32_bf16 v[64:67], a[104:107], v[148:151], v[64:67]
  v_mfma_f32_16x16x32_bf16 v[68:71], a[108:111], v[148:151], v[68:71]
  ds_read_b128 v[148:151], v5 offset:17408
  s_waitcnt lgkmcnt(6)
  v_mfma_f32_16x16x32_bf16 v[72:75], a[104:107], v[152:155], v[72:75]
  s_add_u32 m0, s30, 106496
  s_add_u32 s45, s31, 163840
  v_mfma_f32_16x16x32_bf16 v[76:79], a[108:111], v[152:155], v[76:79]
  ds_read_b128 v[152:155], v5 offset:18432
  buffer_load_dwordx4 v11, s[8:11], s45 offen lds
  v_mfma_f32_16x16x32_bf16 v[80:83], a[104:107], v[156:159], v[80:83]
  v_mul_f32 v104, 0x3fb8aa3b, v56
  v_mul_f32 v105, 0x3fb8aa3b, v57
  v_mfma_f32_16x16x32_bf16 v[84:87], a[108:111], v[156:159], v[84:87]
  ds_read_b128 v[156:159], v5 offset:19456
  s_waitcnt lgkmcnt(6)
  v_mfma_f32_16x16x32_bf16 v[88:91], a[104:107], v[128:131], v[88:91]
here_56:
  v_add_u32 v51, here_56-interleave_layers__linear_attn_block__dense_activation_squared_relu__prompt_kernel+1024, v38
  v_min_u32 v51, 57340, v51
  global_load_dword v49, v51, s[96:97]
  v_mfma_f32_16x16x32_bf16 v[92:95], a[108:111], v[128:131], v[92:95]
  ds_read_b128 v[128:131], v5 offset:20480
  v_mul_f32 v106, 0x3fb8aa3b, v58
  v_mfma_f32_16x16x32_bf16 v[96:99], a[104:107], v[132:135], v[96:99]
  v_mul_f32 v107, 0x3fb8aa3b, v59
  v_mul_f32 v108, 0x3fb8aa3b, v60
  v_mfma_f32_16x16x32_bf16 v[100:103], a[108:111], v[132:135], v[100:103]
  ds_read_b128 v[132:135], v5 offset:21504
  s_waitcnt vmcnt(18) lgkmcnt(6)
  v_mfma_f32_16x16x32_bf16 v[64:67], a[112:115], v[136:139], v[64:67]
  v_mul_f32 v109, 0x3fb8aa3b, v61
  v_mul_f32 v110, 0x3fb8aa3b, v62
  v_mfma_f32_16x16x32_bf16 v[68:71], a[116:119], v[136:139], v[68:71]
  ds_read_b128 v[136:139], v5 offset:22528
  buffer_load_dwordx4 v11, s[8:11], s45 offen offset:1024 lds
  v_mfma_f32_16x16x32_bf16 v[72:75], a[112:115], v[140:143], v[72:75]
  v_mul_f32 v111, 0x3fb8aa3b, v63
  v_mfma_f32_16x16x32_bf16 v[76:79], a[116:119], v[140:143], v[76:79]
  ds_read_b128 v[140:143], v5 offset:23552
  s_waitcnt lgkmcnt(6)
  v_mfma_f32_16x16x32_bf16 v[80:83], a[112:115], v[144:147], v[80:83]
  v_mfma_f32_16x16x32_bf16 v[84:87], a[116:119], v[144:147], v[84:87]
  ds_read_b128 v[144:147], v5 offset:24576
  v_mfma_f32_16x16x32_bf16 v[88:91], a[112:115], v[148:151], v[88:91]
  s_add_u32 m0, s30, 114688
  s_add_u32 s45, s32, 0
  v_mfma_f32_16x16x32_bf16 v[92:95], a[116:119], v[148:151], v[92:95]
  ds_read_b128 v[148:151], v5 offset:25600
  s_waitcnt vmcnt(17) lgkmcnt(6)
  v_mfma_f32_16x16x32_bf16 v[96:99], a[112:115], v[152:155], v[96:99]
  buffer_load_dwordx4 v11, s[8:11], s45 offen lds
  v_mfma_f32_16x16x32_bf16 v[100:103], a[116:119], v[152:155], v[100:103]
  ds_read_b128 v[152:155], v5 offset:26624
  v_mfma_f32_16x16x32_bf16 v[64:67], a[120:123], v[156:159], v[64:67]
  v_mfma_f32_16x16x32_bf16 v[68:71], a[124:127], v[156:159], v[68:71]
  ds_read_b128 v[156:159], v5 offset:27648
  s_waitcnt lgkmcnt(6)
  v_mfma_f32_16x16x32_bf16 v[72:75], a[120:123], v[128:131], v[72:75]
  buffer_load_dwordx4 v11, s[8:11], s45 offen offset:1024 lds
  v_mfma_f32_16x16x32_bf16 v[76:79], a[124:127], v[128:131], v[76:79]
  ds_read_b128 v[128:131], v5 offset:28672
  v_mfma_f32_16x16x32_bf16 v[80:83], a[120:123], v[132:135], v[80:83]
  v_mfma_f32_16x16x32_bf16 v[84:87], a[124:127], v[132:135], v[84:87]
  ds_read_b128 v[132:135], v5 offset:29696
  s_waitcnt lgkmcnt(6)
  v_mfma_f32_16x16x32_bf16 v[88:91], a[120:123], v[136:139], v[88:91]
  s_add_u32 m0, s30, 122880
  s_add_u32 s45, s32, 8192
  v_mfma_f32_16x16x32_bf16 v[92:95], a[124:127], v[136:139], v[92:95]
  ds_read_b128 v[136:139], v5 offset:30720
  buffer_load_dwordx4 v11, s[8:11], s45 offen lds
  v_mfma_f32_16x16x32_bf16 v[96:99], a[120:123], v[140:143], v[96:99]
  v_mfma_f32_16x16x32_bf16 v[100:103], a[124:127], v[140:143], v[100:103]
  ds_read_b128 v[140:143], v5 offset:31744
  s_waitcnt vmcnt(18) lgkmcnt(6)
  v_mfma_f32_16x16x32_bf16 v[64:67], a[128:131], v[144:147], v[64:67]
  v_mfma_f32_16x16x32_bf16 v[68:71], a[132:135], v[144:147], v[68:71]
  ds_read_b128 v[144:147], v5 offset:32768
  buffer_load_dwordx4 v11, s[8:11], s45 offen offset:1024 lds
  v_mfma_f32_16x16x32_bf16 v[72:75], a[128:131], v[148:151], v[72:75]
  v_mfma_f32_16x16x32_bf16 v[76:79], a[132:135], v[148:151], v[76:79]
  ds_read_b128 v[148:151], v5 offset:33792
  s_waitcnt lgkmcnt(6)
  v_mfma_f32_16x16x32_bf16 v[80:83], a[128:131], v[152:155], v[80:83]
  v_mfma_f32_16x16x32_bf16 v[84:87], a[132:135], v[152:155], v[84:87]
  ds_read_b128 v[152:155], v5 offset:34816
  s_add_u32 m0, s30, 131072
  v_mfma_f32_16x16x32_bf16 v[88:91], a[128:131], v[156:159], v[88:91]
  s_add_u32 s45, s32, 16384
  buffer_load_dwordx4 v11, s[8:11], s45 offen lds
  v_mfma_f32_16x16x32_bf16 v[92:95], a[132:135], v[156:159], v[92:95]
  ds_read_b128 v[156:159], v5 offset:35840
  s_waitcnt vmcnt(18) lgkmcnt(6)
  v_mfma_f32_16x16x32_bf16 v[96:99], a[128:131], v[128:131], v[96:99]
  v_mfma_f32_16x16x32_bf16 v[100:103], a[132:135], v[128:131], v[100:103]
  ds_read_b128 v[128:131], v5 offset:36864
  v_mfma_f32_16x16x32_bf16 v[64:67], a[136:139], v[132:135], v[64:67]
  v_mfma_f32_16x16x32_bf16 v[68:71], a[140:143], v[132:135], v[68:71]
  ds_read_b128 v[132:135], v5 offset:37888
  s_waitcnt lgkmcnt(6)
  v_mfma_f32_16x16x32_bf16 v[72:75], a[136:139], v[136:139], v[72:75]
  buffer_load_dwordx4 v11, s[8:11], s45 offen offset:1024 lds
  v_mfma_f32_16x16x32_bf16 v[76:79], a[140:143], v[136:139], v[76:79]
  ds_read_b128 v[136:139], v5 offset:38912
  v_mfma_f32_16x16x32_bf16 v[80:83], a[136:139], v[140:143], v[80:83]
  v_mfma_f32_16x16x32_bf16 v[84:87], a[140:143], v[140:143], v[84:87]
  ds_read_b128 v[140:143], v5 offset:39936
  s_waitcnt lgkmcnt(6)
  v_mfma_f32_16x16x32_bf16 v[88:91], a[136:139], v[144:147], v[88:91]
  s_barrier
  v_mfma_f32_16x16x32_bf16 v[92:95], a[140:143], v[144:147], v[92:95]
  ds_read_b128 v[144:147], v5 offset:40960
  v_mfma_f32_16x16x32_bf16 v[96:99], a[136:139], v[148:151], v[96:99]
  v_mfma_f32_16x16x32_bf16 v[100:103], a[140:143], v[148:151], v[100:103]
  ds_read_b128 v[148:151], v5 offset:41984
  s_waitcnt vmcnt(17) lgkmcnt(6)
  v_mfma_f32_16x16x32_bf16 v[64:67], a[144:147], v[152:155], v[64:67]
  v_mfma_f32_16x16x32_bf16 v[68:71], a[148:151], v[152:155], v[68:71]
  ds_read_b128 v[152:155], v5 offset:43008
  s_add_u32 m0, s30, 139264
  v_mfma_f32_16x16x32_bf16 v[72:75], a[144:147], v[156:159], v[72:75]
  s_add_u32 s45, s32, 24576
  buffer_load_dwordx4 v11, s[8:11], s45 offen lds
  v_mfma_f32_16x16x32_bf16 v[76:79], a[148:151], v[156:159], v[76:79]
  ds_read_b128 v[156:159], v5 offset:44032
  s_waitcnt lgkmcnt(6)
  v_mfma_f32_16x16x32_bf16 v[80:83], a[144:147], v[128:131], v[80:83]
  v_mfma_f32_16x16x32_bf16 v[84:87], a[148:151], v[128:131], v[84:87]
  ds_read_b128 v[128:131], v5 offset:45056
  v_mfma_f32_16x16x32_bf16 v[88:91], a[144:147], v[132:135], v[88:91]
  v_mfma_f32_16x16x32_bf16 v[92:95], a[148:151], v[132:135], v[92:95]
  ds_read_b128 v[132:135], v5 offset:46080
  s_waitcnt vmcnt(16) lgkmcnt(6)
  v_mfma_f32_16x16x32_bf16 v[96:99], a[144:147], v[136:139], v[96:99]
  v_mfma_f32_16x16x32_bf16 v[100:103], a[148:151], v[136:139], v[100:103]
  ds_read_b128 v[136:139], v5 offset:47104
  v_mfma_f32_16x16x32_bf16 v[64:67], a[152:155], v[140:143], v[64:67]
  buffer_load_dwordx4 v11, s[8:11], s45 offen offset:1024 lds
  v_mfma_f32_16x16x32_bf16 v[68:71], a[156:159], v[140:143], v[68:71]
  ds_read_b128 v[140:143], v5 offset:48128
  s_waitcnt lgkmcnt(6)
  v_mfma_f32_16x16x32_bf16 v[72:75], a[152:155], v[144:147], v[72:75]
  v_mfma_f32_16x16x32_bf16 v[76:79], a[156:159], v[144:147], v[76:79]
  ds_read_b128 v[144:147], v5 offset:49152
  v_mfma_f32_16x16x32_bf16 v[80:83], a[152:155], v[148:151], v[80:83]
  v_mfma_f32_16x16x32_bf16 v[84:87], a[156:159], v[148:151], v[84:87]
  ds_read_b128 v[148:151], v5 offset:50176
  s_waitcnt lgkmcnt(6)
  v_mfma_f32_16x16x32_bf16 v[88:91], a[152:155], v[152:155], v[88:91]
  v_mfma_f32_16x16x32_bf16 v[92:95], a[156:159], v[152:155], v[92:95]
  ds_read_b128 v[152:155], v5 offset:51200
  v_mfma_f32_16x16x32_bf16 v[96:99], a[152:155], v[156:159], v[96:99]
  v_mfma_f32_16x16x32_bf16 v[100:103], a[156:159], v[156:159], v[100:103]
  ds_read_b128 v[156:159], v5 offset:52224
  s_waitcnt lgkmcnt(6)
  v_mfma_f32_16x16x32_bf16 v[64:67], v[40:43], v[128:131], v[64:67]
  s_add_u32 m0, s30, 147456
  s_add_u32 s45, s32, 32768
  v_mfma_f32_16x16x32_bf16 v[68:71], v[44:47], v[128:131], v[68:71]
  ds_read_b128 v[128:131], v5 offset:53248
  buffer_load_dwordx4 v11, s[8:11], s45 offen lds
  v_mfma_f32_16x16x32_bf16 v[72:75], v[40:43], v[132:135], v[72:75]
  v_mfma_f32_16x16x32_bf16 v[76:79], v[44:47], v[132:135], v[76:79]
  ds_read_b128 v[132:135], v5 offset:54272
  s_waitcnt lgkmcnt(6)
  v_mfma_f32_16x16x32_bf16 v[80:83], v[40:43], v[136:139], v[80:83]
  buffer_load_dwordx4 v11, s[8:11], s45 offen offset:1024 lds
  s_barrier
  v_mfma_f32_16x16x32_bf16 v[84:87], v[44:47], v[136:139], v[84:87]
  ds_read_b128 v[136:139], v5 offset:55296
  v_mfma_f32_16x16x32_bf16 v[88:91], v[40:43], v[140:143], v[88:91]
  v_mfma_f32_16x16x32_bf16 v[92:95], v[44:47], v[140:143], v[92:95]
  ds_read_b128 v[140:143], v5 offset:56320
  s_waitcnt lgkmcnt(7)
  v_mfma_f32_16x16x32_bf16 v[96:99], v[40:43], v[144:147], v[96:99]
  v_mfma_f32_16x16x32_bf16 v[100:103], v[44:47], v[144:147], v[100:103]
  ds_read_b128 v[144:147], v5 offset:57344
  v_pk_mul_f32 v[112:113], v[64:65], v[104:105]
  v_exp_f32_e64 v114, v112 clamp
  v_exp_f32_e64 v115, v113 clamp
  v_max_f32 v112, 0, v112
  v_max_f32 v113, 0, v113
  v_pk_add_f32 v[114:115], v[114:115], v[54:55] op_sel_hi:[1,0]
  v_pk_fma_f32 v[112:113], v[112:113], v[52:53], v[114:115] op_sel_hi:[1,0,1]
  v_cvt_pk_bf16_f32 v208, v112, v113
  v_pk_mul_f32 v[116:117], v[66:67], v[106:107]
  v_exp_f32_e64 v118, v116 clamp
  s_add_u32 m0, s30, 155648
  s_add_u32 s45, s32, 40960
  buffer_load_dwordx4 v11, s[8:11], s45 offen lds
  v_exp_f32_e64 v119, v117 clamp
  v_max_f32 v116, 0, v116
  v_max_f32 v117, 0, v117
  v_pk_add_f32 v[118:119], v[118:119], v[54:55] op_sel_hi:[1,0]
  v_pk_fma_f32 v[116:117], v[116:117], v[52:53], v[118:119] op_sel_hi:[1,0,1]
  v_cvt_pk_bf16_f32 v209, v116, v117
  v_pk_mul_f32 v[112:113], v[68:69], v[108:109]
  v_exp_f32_e64 v114, v112 clamp
  v_exp_f32_e64 v115, v113 clamp
  buffer_load_dwordx4 v11, s[8:11], s45 offen offset:1024 lds
  v_max_f32 v112, 0, v112
  v_max_f32 v113, 0, v113
  v_pk_add_f32 v[114:115], v[114:115], v[54:55] op_sel_hi:[1,0]
  v_pk_fma_f32 v[112:113], v[112:113], v[52:53], v[114:115] op_sel_hi:[1,0,1]
  v_cvt_pk_bf16_f32 v210, v112, v113
  v_pk_mul_f32 v[116:117], v[70:71], v[110:111]
  v_exp_f32_e64 v118, v116 clamp
  v_exp_f32_e64 v119, v117 clamp
  v_max_f32 v116, 0, v116
  v_max_f32 v117, 0, v117
  v_pk_add_f32 v[118:119], v[118:119], v[54:55] op_sel_hi:[1,0]
  v_pk_fma_f32 v[116:117], v[116:117], v[52:53], v[118:119] op_sel_hi:[1,0,1]
  v_cvt_pk_bf16_f32 v211, v116, v117
  v_pk_mul_f32 v[112:113], v[72:73], v[104:105]
  v_exp_f32_e64 v114, v112 clamp
  v_exp_f32_e64 v115, v113 clamp
  v_max_f32 v112, 0, v112
  s_add_u32 m0, s30, 8192
  s_add_u32 s45, s32, 49152
  buffer_load_dwordx4 v11, s[8:11], s45 offen lds
  v_max_f32 v113, 0, v113
  v_pk_add_f32 v[114:115], v[114:115], v[54:55] op_sel_hi:[1,0]
  v_pk_fma_f32 v[112:113], v[112:113], v[52:53], v[114:115] op_sel_hi:[1,0,1]
  v_cvt_pk_bf16_f32 v212, v112, v113
  v_pk_mul_f32 v[116:117], v[74:75], v[106:107]
  v_exp_f32_e64 v118, v116 clamp
  v_exp_f32_e64 v119, v117 clamp
  v_max_f32 v116, 0, v116
  v_max_f32 v117, 0, v117
  v_pk_add_f32 v[118:119], v[118:119], v[54:55] op_sel_hi:[1,0]
  v_pk_fma_f32 v[116:117], v[116:117], v[52:53], v[118:119] op_sel_hi:[1,0,1]
  v_cvt_pk_bf16_f32 v213, v116, v117
  v_pk_mul_f32 v[112:113], v[76:77], v[108:109]
  v_exp_f32_e64 v114, v112 clamp
  v_exp_f32_e64 v115, v113 clamp
  buffer_load_dwordx4 v11, s[8:11], s45 offen offset:1024 lds
  v_max_f32 v112, 0, v112
  v_max_f32 v113, 0, v113
  v_pk_add_f32 v[114:115], v[114:115], v[54:55] op_sel_hi:[1,0]
  v_pk_fma_f32 v[112:113], v[112:113], v[52:53], v[114:115] op_sel_hi:[1,0,1]
  v_cvt_pk_bf16_f32 v214, v112, v113
  v_pk_mul_f32 v[116:117], v[78:79], v[110:111]
  v_exp_f32_e64 v118, v116 clamp
  v_exp_f32_e64 v119, v117 clamp
  v_max_f32 v116, 0, v116
  v_max_f32 v117, 0, v117
  v_pk_add_f32 v[118:119], v[118:119], v[54:55] op_sel_hi:[1,0]
  v_pk_fma_f32 v[116:117], v[116:117], v[52:53], v[118:119] op_sel_hi:[1,0,1]
  v_cvt_pk_bf16_f32 v215, v116, v117
  v_pk_mul_f32 v[112:113], v[80:81], v[104:105]
  v_exp_f32_e64 v114, v112 clamp
  v_exp_f32_e64 v115, v113 clamp
  v_max_f32 v112, 0, v112
  v_max_f32 v113, 0, v113
  v_pk_add_f32 v[114:115], v[114:115], v[54:55] op_sel_hi:[1,0]
  v_pk_fma_f32 v[112:113], v[112:113], v[52:53], v[114:115] op_sel_hi:[1,0,1]
  v_cvt_pk_bf16_f32 v216, v112, v113
  v_pk_mul_f32 v[116:117], v[82:83], v[106:107]
  v_exp_f32_e64 v118, v116 clamp
  v_exp_f32_e64 v119, v117 clamp
  v_max_f32 v116, 0, v116
  v_max_f32 v117, 0, v117
  v_pk_add_f32 v[118:119], v[118:119], v[54:55] op_sel_hi:[1,0]
  v_pk_fma_f32 v[116:117], v[116:117], v[52:53], v[118:119] op_sel_hi:[1,0,1]
  v_cvt_pk_bf16_f32 v217, v116, v117
  v_pk_mul_f32 v[112:113], v[84:85], v[108:109]
  v_exp_f32_e64 v114, v112 clamp
  v_exp_f32_e64 v115, v113 clamp
  v_max_f32 v112, 0, v112
  v_max_f32 v113, 0, v113
  v_pk_add_f32 v[114:115], v[114:115], v[54:55] op_sel_hi:[1,0]
  v_pk_fma_f32 v[112:113], v[112:113], v[52:53], v[114:115] op_sel_hi:[1,0,1]
  v_cvt_pk_bf16_f32 v218, v112, v113
  v_pk_mul_f32 v[116:117], v[86:87], v[110:111]
  v_exp_f32_e64 v118, v116 clamp
  v_exp_f32_e64 v119, v117 clamp
  v_max_f32 v116, 0, v116
  v_max_f32 v117, 0, v117
  v_pk_add_f32 v[118:119], v[118:119], v[54:55] op_sel_hi:[1,0]
  v_pk_fma_f32 v[116:117], v[116:117], v[52:53], v[118:119] op_sel_hi:[1,0,1]
  v_cvt_pk_bf16_f32 v219, v116, v117
  v_pk_mul_f32 v[88:89], v[88:89], v[56:57]
  v_pk_mul_f32 v[90:91], v[90:91], v[58:59]
  v_pk_mul_f32 v[92:93], v[92:93], v[60:61]
  v_pk_mul_f32 v[94:95], v[94:95], v[62:63]
  v_cvt_pk_bf16_f32 v220, v88, v89
  v_cvt_pk_bf16_f32 v221, v90, v91
  v_cvt_pk_bf16_f32 v222, v92, v93
  v_cvt_pk_bf16_f32 v223, v94, v95
  v_pk_mul_f32 v[96:97], v[96:97], v[56:57]
  v_pk_mul_f32 v[98:99], v[98:99], v[58:59]
  v_pk_mul_f32 v[100:101], v[100:101], v[60:61]
  v_pk_mul_f32 v[102:103], v[102:103], v[62:63]
  v_cvt_pk_bf16_f32 v120, v96, v97
  v_cvt_pk_bf16_f32 v121, v98, v99
  v_cvt_pk_bf16_f32 v122, v100, v101
  v_cvt_pk_bf16_f32 v123, v102, v103
  v_pk_mul_f32 v[80:81], v[80:81], v[56:57]
  v_pk_mul_f32 v[82:83], v[82:83], v[58:59]
  v_pk_mul_f32 v[84:85], v[84:85], v[60:61]
  v_pk_mul_f32 v[86:87], v[86:87], v[62:63]
  v_cvt_pk_bf16_f32 v124, v80, v81
  v_cvt_pk_bf16_f32 v125, v82, v83
  v_cvt_pk_bf16_f32 v126, v84, v85
  v_cvt_pk_bf16_f32 v127, v86, v87
  v_cndmask_b32 v124, v124, v30, s[48:49]
  v_cndmask_b32 v125, v125, v30, s[48:49]
  v_cndmask_b32 v126, v126, v30, s[48:49]
  v_cndmask_b32 v127, v127, v30, s[48:49]
  v_mfma_f32_16x16x32_bf16 v[64:67], v[208:211], v[220:223], 0
  s_nop 0
  v_mfma_f32_16x16x32_bf16 v[68:71], v[208:211], v[124:127], 0
  v_mfma_f32_16x16x32_bf16 v[72:75], v[212:215], v[120:123], 0
  v_mfma_f32_16x16x32_bf16 v[76:79], v[212:215], v[124:127], 0
  v_mfma_f32_16x16x32_bf16 v[80:83], v[216:219], v[220:223], 0
  v_mfma_f32_16x16x32_bf16 v[84:87], v[216:219], v[120:123], 0
  v_mfma_f32_16x16x32_bf16 v[88:91], v[216:219], v[124:127], 0
  s_nop 0
  ds_write_b128 v224, v[64:67]
  s_nop 0
  ds_write_b128 v224, v[68:71] offset:1024
  ds_write_b128 v224, v[72:75] offset:2048
  ds_write_b128 v224, v[76:79] offset:3072
  ds_write_b128 v224, v[80:83] offset:4096
  ds_write_b128 v224, v[84:87] offset:5120
  ds_write_b128 v224, v[88:91] offset:6144
  s_waitcnt lgkmcnt(0)
  s_barrier
  ds_read_b128 v[64:67], v225
  ds_read_b128 v[68:71], v225 offset:7168
  ds_read_b128 v[72:75], v225 offset:14336
  ds_read_b128 v[76:79], v225 offset:21504
  s_waitcnt lgkmcnt(2)
  v_pk_add_f32 v[64:65], v[64:65], v[68:69]
  s_waitcnt lgkmcnt(0)
  v_pk_add_f32 v[72:73], v[72:73], v[76:77]
  v_pk_add_f32 v[66:67], v[66:67], v[70:71]
  v_pk_add_f32 v[74:75], v[74:75], v[78:79]
  v_pk_add_f32 v[64:65], v[64:65], v[72:73]
  v_pk_add_f32 v[66:67], v[66:67], v[74:75]
  v_cvt_pk_bf16_f32 v68, v64, v65
  v_cvt_pk_bf16_f32 v69, v66, v67
  buffer_store_dwordx2 v[68:69], v22, s[8:11], s7 offen sc1
  v_mfma_f32_16x16x32_bf16 v[104:107], v[148:151], a[0:3], 0
  v_mfma_f32_16x16x32_bf16 v[108:111], v[148:151], a[4:7], 0
  ds_read_b128 v[148:151], v5 offset:58368
  v_mfma_f32_16x16x32_bf16 v[112:115], v[152:155], a[0:3], 0
  v_mfma_f32_16x16x32_bf16 v[116:119], v[152:155], a[4:7], 0
  ds_read_b128 v[152:155], v5 offset:59392
  v_mfma_f32_16x16x32_bf16 v[120:123], v[156:159], a[0:3], 0
  v_mfma_f32_16x16x32_bf16 v[124:127], v[156:159], a[4:7], 0
  ds_read_b128 v[156:159], v5 offset:60416
  v_mfma_f32_16x16x32_bf16 v[104:107], v[128:131], a[8:11], v[104:107]
  v_mfma_f32_16x16x32_bf16 v[108:111], v[128:131], a[12:15], v[108:111]
  ds_read_b128 v[128:131], v5 offset:61440
  v_mfma_f32_16x16x32_bf16 v[112:115], v[132:135], a[8:11], v[112:115]
  v_mfma_f32_16x16x32_bf16 v[116:119], v[132:135], a[12:15], v[116:119]
  ds_read_b128 v[132:135], v5 offset:62464
  v_mfma_f32_16x16x32_bf16 v[120:123], v[136:139], a[8:11], v[120:123]
  v_mfma_f32_16x16x32_bf16 v[124:127], v[136:139], a[12:15], v[124:127]
  ds_read_b128 v[136:139], v5 offset:63488
  v_mfma_f32_16x16x32_bf16 v[104:107], v[140:143], a[16:19], v[104:107]
  v_mfma_f32_16x16x32_bf16 v[108:111], v[140:143], a[20:23], v[108:111]
  ds_read_b128 v[140:143], v5 offset:64512
  v_mfma_f32_16x16x32_bf16 v[112:115], v[144:147], a[16:19], v[112:115]
  v_mfma_f32_16x16x32_bf16 v[116:119], v[144:147], a[20:23], v[116:119]
  ds_read_b128 v[144:147], v6
  s_waitcnt lgkmcnt(6)
  v_mfma_f32_16x16x32_bf16 v[120:123], v[148:151], a[16:19], v[120:123]
  v_mfma_f32_16x16x32_bf16 v[124:127], v[148:151], a[20:23], v[124:127]
  ds_read_b128 v[148:151], v6 offset:1024
  v_mfma_f32_16x16x32_bf16 v[104:107], v[152:155], a[24:27], v[104:107]
  v_mfma_f32_16x16x32_bf16 v[108:111], v[152:155], a[28:31], v[108:111]
  ds_read_b128 v[152:155], v6 offset:2048
  s_waitcnt lgkmcnt(6)
  v_mfma_f32_16x16x32_bf16 v[112:115], v[156:159], a[24:27], v[112:115]
  v_mfma_f32_16x16x32_bf16 v[116:119], v[156:159], a[28:31], v[116:119]
  ds_read_b128 v[156:159], v6 offset:3072
  v_mfma_f32_16x16x32_bf16 v[120:123], v[128:131], a[24:27], v[120:123]
  v_mfma_f32_16x16x32_bf16 v[124:127], v[128:131], a[28:31], v[124:127]
  ds_read_b128 v[128:131], v6 offset:4096
  s_waitcnt lgkmcnt(6)
  v_mfma_f32_16x16x32_bf16 v[104:107], v[132:135], a[32:35], v[104:107]
  v_mfma_f32_16x16x32_bf16 v[108:111], v[132:135], a[36:39], v[108:111]
  ds_read_b128 v[132:135], v6 offset:5120
  v_mfma_f32_16x16x32_bf16 v[112:115], v[136:139], a[32:35], v[112:115]
  v_mfma_f32_16x16x32_bf16 v[116:119], v[136:139], a[36:39], v[116:119]
  ds_read_b128 v[136:139], v6 offset:6144
  s_waitcnt lgkmcnt(6)
  v_mfma_f32_16x16x32_bf16 v[120:123], v[140:143], a[32:35], v[120:123]
  v_mfma_f32_16x16x32_bf16 v[124:127], v[140:143], a[36:39], v[124:127]
  ds_read_b128 v[140:143], v6 offset:7168
  v_mfma_f32_16x16x32_bf16 v[104:107], v[144:147], a[40:43], v[104:107]
  v_mfma_f32_16x16x32_bf16 v[108:111], v[144:147], a[44:47], v[108:111]
  ds_read_b128 v[144:147], v6 offset:8192
  s_waitcnt lgkmcnt(6)
  v_mfma_f32_16x16x32_bf16 v[112:115], v[148:151], a[40:43], v[112:115]
  s_waitcnt vmcnt(15)
  s_barrier
  v_mfma_f32_16x16x32_bf16 v[116:119], v[148:151], a[44:47], v[116:119]
  ds_read_b128 v[148:151], v6 offset:9216
  s_add_u32 m0, s30, 16384
  v_mfma_f32_16x16x32_bf16 v[120:123], v[152:155], a[40:43], v[120:123]
  s_add_u32 s45, s32, 57344
  buffer_load_dwordx4 v11, s[8:11], s45 offen lds
  v_mfma_f32_16x16x32_bf16 v[124:127], v[152:155], a[44:47], v[124:127]
  ds_read_b128 v[152:155], v6 offset:10240
  s_waitcnt lgkmcnt(6)
  v_mfma_f32_16x16x32_bf16 v[104:107], v[156:159], a[48:51], v[104:107]
  buffer_load_dwordx4 v11, s[8:11], s45 offen offset:1024 lds
  v_mfma_f32_16x16x32_bf16 v[108:111], v[156:159], a[52:55], v[108:111]
  ds_read_b128 v[156:159], v6 offset:11264
  v_mfma_f32_16x16x32_bf16 v[112:115], v[128:131], a[48:51], v[112:115]
  s_add_u32 m0, s30, 24576
  s_add_u32 s45, s32, 65536
  v_mfma_f32_16x16x32_bf16 v[116:119], v[128:131], a[52:55], v[116:119]
  ds_read_b128 v[128:131], v6 offset:12288
  s_waitcnt lgkmcnt(6)
  v_mfma_f32_16x16x32_bf16 v[120:123], v[132:135], a[48:51], v[120:123]
  buffer_load_dwordx4 v11, s[8:11], s45 offen lds
  v_mfma_f32_16x16x32_bf16 v[124:127], v[132:135], a[52:55], v[124:127]
  ds_read_b128 v[132:135], v6 offset:13312
  v_mfma_f32_16x16x32_bf16 v[104:107], v[136:139], a[56:59], v[104:107]
  buffer_load_dwordx4 v11, s[8:11], s45 offen offset:1024 lds
  v_mfma_f32_16x16x32_bf16 v[108:111], v[136:139], a[60:63], v[108:111]
  ds_read_b128 v[136:139], v6 offset:14336
  s_waitcnt lgkmcnt(6)
  v_mfma_f32_16x16x32_bf16 v[112:115], v[140:143], a[56:59], v[112:115]
  s_add_u32 m0, s30, 32768
  s_add_u32 s45, s32, 73728
  v_mfma_f32_16x16x32_bf16 v[116:119], v[140:143], a[60:63], v[116:119]
  ds_read_b128 v[140:143], v6 offset:15360
  buffer_load_dwordx4 v11, s[8:11], s45 offen lds
  v_mfma_f32_16x16x32_bf16 v[120:123], v[144:147], a[56:59], v[120:123]
  v_mfma_f32_16x16x32_bf16 v[124:127], v[144:147], a[60:63], v[124:127]
  ds_read_b128 v[144:147], v6 offset:16384
  s_waitcnt lgkmcnt(6)
  v_mfma_f32_16x16x32_bf16 v[104:107], v[148:151], a[64:67], v[104:107]
  buffer_load_dwordx4 v11, s[8:11], s45 offen offset:1024 lds
  v_mfma_f32_16x16x32_bf16 v[108:111], v[148:151], a[68:71], v[108:111]
  ds_read_b128 v[148:151], v6 offset:17408
  v_mfma_f32_16x16x32_bf16 v[112:115], v[152:155], a[64:67], v[112:115]
  s_add_u32 m0, s30, 40960
  s_add_u32 s45, s32, 81920
  v_mfma_f32_16x16x32_bf16 v[116:119], v[152:155], a[68:71], v[116:119]
  ds_read_b128 v[152:155], v6 offset:18432
  s_waitcnt lgkmcnt(6)
  v_mfma_f32_16x16x32_bf16 v[120:123], v[156:159], a[64:67], v[120:123]
  buffer_load_dwordx4 v11, s[8:11], s45 offen lds
  v_mfma_f32_16x16x32_bf16 v[124:127], v[156:159], a[68:71], v[124:127]
  ds_read_b128 v[156:159], v6 offset:19456
  v_mfma_f32_16x16x32_bf16 v[104:107], v[128:131], a[72:75], v[104:107]
  buffer_load_dwordx4 v11, s[8:11], s45 offen offset:1024 lds
  v_mfma_f32_16x16x32_bf16 v[108:111], v[128:131], a[76:79], v[108:111]
  ds_read_b128 v[128:131], v6 offset:20480
  s_waitcnt lgkmcnt(6)
  v_mfma_f32_16x16x32_bf16 v[112:115], v[132:135], a[72:75], v[112:115]
  s_add_u32 m0, s30, 49152
  s_add_u32 s45, s32, 90112
  v_mfma_f32_16x16x32_bf16 v[116:119], v[132:135], a[76:79], v[116:119]
  ds_read_b128 v[132:135], v6 offset:21504
  buffer_load_dwordx4 v11, s[8:11], s45 offen lds
  v_mfma_f32_16x16x32_bf16 v[120:123], v[136:139], a[72:75], v[120:123]
  v_mfma_f32_16x16x32_bf16 v[124:127], v[136:139], a[76:79], v[124:127]
  ds_read_b128 v[136:139], v6 offset:22528
  s_waitcnt lgkmcnt(6)
  v_mfma_f32_16x16x32_bf16 v[104:107], v[140:143], a[80:83], v[104:107]
  buffer_load_dwordx4 v11, s[8:11], s45 offen offset:1024 lds
  v_mfma_f32_16x16x32_bf16 v[108:111], v[140:143], a[84:87], v[108:111]
  ds_read_b128 v[140:143], v6 offset:23552
  v_mfma_f32_16x16x32_bf16 v[112:115], v[144:147], a[80:83], v[112:115]
  s_add_u32 m0, s30, 57344
  s_add_u32 s45, s32, 98304
  v_mfma_f32_16x16x32_bf16 v[116:119], v[144:147], a[84:87], v[116:119]
  ds_read_b128 v[144:147], v6 offset:24576
  s_waitcnt lgkmcnt(6)
  v_mfma_f32_16x16x32_bf16 v[120:123], v[148:151], a[80:83], v[120:123]
  s_cmp_ge_u32 s24, 2
  s_cbranch_scc1 nopad_57
  buffer_load_dwordx4 v11, s[8:11], s45 offen lds
nopad_57:
  v_mfma_f32_16x16x32_bf16 v[124:127], v[148:151], a[84:87], v[124:127]
  ds_read_b128 v[148:151], v6 offset:25600
  v_mfma_f32_16x16x32_bf16 v[104:107], v[152:155], a[88:91], v[104:107]
  s_cmp_ge_u32 s24, 2
  s_cbranch_scc1 nopad_58
  buffer_load_dwordx4 v11, s[8:11], s45 offen offset:1024 lds
nopad_58:
  v_mfma_f32_16x16x32_bf16 v[108:111], v[152:155], a[92:95], v[108:111]
  ds_read_b128 v[152:155], v6 offset:26624
  s_waitcnt lgkmcnt(6)
  v_mfma_f32_16x16x32_bf16 v[112:115], v[156:159], a[88:91], v[112:115]
  v_mfma_f32_16x16x32_bf16 v[116:119], v[156:159], a[92:95], v[116:119]
  ds_read_b128 v[156:159], v6 offset:27648
  v_mfma_f32_16x16x32_bf16 v[120:123], v[128:131], a[88:91], v[120:123]
  v_mfma_f32_16x16x32_bf16 v[124:127], v[128:131], a[92:95], v[124:127]
  ds_read_b128 v[128:131], v6 offset:28672
  s_waitcnt lgkmcnt(6)
  v_mfma_f32_16x16x32_bf16 v[104:107], v[132:135], a[96:99], v[104:107]
  v_mfma_f32_16x16x32_bf16 v[108:111], v[132:135], a[100:103], v[108:111]
  ds_read_b128 v[132:135], v6 offset:29696
  v_mfma_f32_16x16x32_bf16 v[112:115], v[136:139], a[96:99], v[112:115]
  v_mfma_f32_16x16x32_bf16 v[116:119], v[136:139], a[100:103], v[116:119]
  ds_read_b128 v[136:139], v6 offset:30720
  s_waitcnt lgkmcnt(6)
  v_mfma_f32_16x16x32_bf16 v[120:123], v[140:143], a[96:99], v[120:123]
  v_mfma_f32_16x16x32_bf16 v[124:127], v[140:143], a[100:103], v[124:127]
  ds_read_b128 v[140:143], v6 offset:31744
  v_mfma_f32_16x16x32_bf16 v[104:107], v[144:147], a[104:107], v[104:107]
  v_mfma_f32_16x16x32_bf16 v[108:111], v[144:147], a[108:111], v[108:111]
  ds_read_b128 v[144:147], v6 offset:32768
  s_waitcnt lgkmcnt(6)
  v_mfma_f32_16x16x32_bf16 v[112:115], v[148:151], a[104:107], v[112:115]
  s_barrier
  v_mfma_f32_16x16x32_bf16 v[116:119], v[148:151], a[108:111], v[116:119]
  ds_read_b128 v[148:151], v6 offset:33792
  s_add_u32 s42, s61, 21299200
  v_mfma_f32_16x16x32_bf16 v[120:123], v[152:155], a[104:107], v[120:123]
  buffer_load_dwordx4 v[64:67], v37, s[8:11], s42 offen sc1
here_59:
  v_add_u32 v51, here_59-interleave_layers__linear_attn_block__dense_activation_squared_relu__prompt_kernel+1024, v38
  v_min_u32 v51, 57340, v51
  global_load_dword v49, v51, s[96:97]
  v_mfma_f32_16x16x32_bf16 v[124:127], v[152:155], a[108:111], v[124:127]
  ds_read_b128 v[152:155], v6 offset:34816
  s_waitcnt lgkmcnt(6)
  v_mfma_f32_16x16x32_bf16 v[104:107], v[156:159], a[112:115], v[104:107]
  buffer_load_dwordx4 v[68:71], v37, s[8:11], s42 offen offset:1792 sc1
  v_mfma_f32_16x16x32_bf16 v[108:111], v[156:159], a[116:119], v[108:111]
  ds_read_b128 v[156:159], v6 offset:35840
  v_mfma_f32_16x16x32_bf16 v[112:115], v[128:131], a[112:115], v[112:115]
  s_add_u32 s42, s61, 21302784
  buffer_load_dwordx4 v[72:75], v37, s[8:11], s42 offen sc1
  v_mfma_f32_16x16x32_bf16 v[116:119], v[128:131], a[116:119], v[116:119]
  ds_read_b128 v[128:131], v6 offset:36864
  s_waitcnt lgkmcnt(6)
  v_mfma_f32_16x16x32_bf16 v[120:123], v[132:135], a[112:115], v[120:123]
  buffer_load_dwordx4 v[76:79], v37, s[8:11], s42 offen offset:1792 sc1
  v_mfma_f32_16x16x32_bf16 v[124:127], v[132:135], a[116:119], v[124:127]
  ds_read_b128 v[132:135], v6 offset:37888
  v_mfma_f32_16x16x32_bf16 v[104:107], v[136:139], a[120:123], v[104:107]
  s_add_u32 s42, s61, 21306368
  buffer_load_dwordx4 v[80:83], v37, s[8:11], s42 offen sc1
  v_mfma_f32_16x16x32_bf16 v[108:111], v[136:139], a[124:127], v[108:111]
  ds_read_b128 v[136:139], v6 offset:38912
  s_waitcnt lgkmcnt(6)
  v_mfma_f32_16x16x32_bf16 v[112:115], v[140:143], a[120:123], v[112:115]
  buffer_load_dwordx4 v[84:87], v37, s[8:11], s42 offen offset:1792 sc1
  v_mfma_f32_16x16x32_bf16 v[116:119], v[140:143], a[124:127], v[116:119]
  ds_read_b128 v[140:143], v6 offset:39936
  v_mfma_f32_16x16x32_bf16 v[120:123], v[144:147], a[120:123], v[120:123]
  s_add_u32 s42, s61, 21309952
  buffer_load_dwordx4 v[88:91], v37, s[8:11], s42 offen sc1
  v_mfma_f32_16x16x32_bf16 v[124:127], v[144:147], a[124:127], v[124:127]
  ds_read_b128 v[144:147], v6 offset:40960
  s_waitcnt lgkmcnt(6)
  v_mfma_f32_16x16x32_bf16 v[104:107], v[148:151], a[128:131], v[104:107]
  buffer_load_dwordx4 v[92:95], v37, s[8:11], s42 offen offset:1792 sc1
  v_mfma_f32_16x16x32_bf16 v[108:111], v[148:151], a[132:135], v[108:111]
  ds_read_b128 v[148:151], v6 offset:41984
  v_mfma_f32_16x16x32_bf16 v[112:115], v[152:155], a[128:131], v[112:115]
  v_mfma_f32_16x16x32_bf16 v[116:119], v[152:155], a[132:135], v[116:119]
  ds_read_b128 v[152:155], v6 offset:43008
  s_waitcnt lgkmcnt(6)
  v_mfma_f32_16x16x32_bf16 v[120:123], v[156:159], a[128:131], v[120:123]
  v_mfma_f32_16x16x32_bf16 v[124:127], v[156:159], a[132:135], v[124:127]
  ds_read_b128 v[156:159], v6 offset:44032
  v_mfma_f32_16x16x32_bf16 v[104:107], v[128:131], a[136:139], v[104:107]
  v_mfma_f32_16x16x32_bf16 v[108:111], v[128:131], a[140:143], v[108:111]
  ds_read_b128 v[128:131], v6 offset:45056
  s_waitcnt lgkmcnt(6)
  v_mfma_f32_16x16x32_bf16 v[112:115], v[132:135], a[136:139], v[112:115]
  s_add_u32 m0, s30, 65536
  s_add_u32 s45, s33, 0
  v_mfma_f32_16x16x32_bf16 v[116:119], v[132:135], a[140:143], v[116:119]
  ds_read_b128 v[132:135], v6 offset:46080
  buffer_load_dwordx4 v11, s[8:11], s45 offen lds
  v_mfma_f32_16x16x32_bf16 v[120:123], v[136:139], a[136:139], v[120:123]
  v_mfma_f32_16x16x32_bf16 v[124:127], v[136:139], a[140:143], v[124:127]
  ds_read_b128 v[136:139], v6 offset:47104
  s_waitcnt lgkmcnt(6)
  v_mfma_f32_16x16x32_bf16 v[104:107], v[140:143], a[144:147], v[104:107]
  buffer_load_dwordx4 v11, s[8:11], s45 offen offset:1024 lds
  v_mfma_f32_16x16x32_bf16 v[108:111], v[140:143], a[148:151], v[108:111]
  ds_read_b128 v[140:143], v6 offset:48128
  v_mfma_f32_16x16x32_bf16 v[112:115], v[144:147], a[144:147], v[112:115]
  v_mfma_f32_16x16x32_bf16 v[116:119], v[144:147], a[148:151], v[116:119]
  s_waitcnt lgkmcnt(5)
  v_mfma_f32_16x16x32_bf16 v[120:123], v[148:151], a[144:147], v[120:123]
  v_mfma_f32_16x16x32_bf16 v[124:127], v[148:151], a[148:151], v[124:127]
  v_mfma_f32_16x16x32_bf16 v[104:107], v[152:155], a[152:155], v[104:107]
  s_add_u32 m0, s30, 73728
  s_add_u32 s45, s33, 8192
  v_mfma_f32_16x16x32_bf16 v[108:111], v[152:155], a[156:159], v[108:111]
  buffer_load_dwordx4 v11, s[8:11], s45 offen lds
  s_waitcnt lgkmcnt(3)
  v_mfma_f32_16x16x32_bf16 v[112:115], v[156:159], a[152:155], v[112:115]
  v_mfma_f32_16x16x32_bf16 v[116:119], v[156:159], a[156:159], v[116:119]
  v_mfma_f32_16x16x32_bf16 v[120:123], v[128:131], a[152:155], v[120:123]
  v_mfma_f32_16x16x32_bf16 v[124:127], v[128:131], a[156:159], v[124:127]
  s_waitcnt lgkmcnt(1)
  v_mfma_f32_16x16x32_bf16 v[104:107], v[132:135], v[40:43], v[104:107]
  buffer_load_dwordx4 v11, s[8:11], s45 offen offset:1024 lds
  v_mfma_f32_16x16x32_bf16 v[108:111], v[132:135], v[44:47], v[108:111]
  v_mfma_f32_16x16x32_bf16 v[112:115], v[136:139], v[40:43], v[112:115]
  s_barrier
  v_mfma_f32_16x16x32_bf16 v[116:119], v[136:139], v[44:47], v[116:119]
  s_waitcnt lgkmcnt(0)
  v_mfma_f32_16x16x32_bf16 v[120:123], v[140:143], v[40:43], v[120:123]
  v_mfma_f32_16x16x32_bf16 v[124:127], v[140:143], v[44:47], v[124:127]
  v_pk_mul_f32 v[216:217], v[104:105], v[48:49] op_sel_hi:[1,0]
  v_exp_f32_e64 v218, v216 clamp
  v_exp_f32_e64 v219, v217 clamp
  v_max_f32 v216, 0, v216
  v_max_f32 v217, 0, v217
  v_pk_add_f32 v[218:219], v[218:219], v[54:55] op_sel_hi:[1,0]
  v_pk_fma_f32 v[216:217], v[216:217], v[52:53], v[218:219] op_sel_hi:[1,0,1]
  v_pk_mul_f32 v[220:221], v[112:113], v[48:49] op_sel_hi:[1,0]
  v_exp_f32_e64 v222, v220 clamp
  v_exp_f32_e64 v223, v221 clamp
  v_max_f32 v220, 0, v220
  v_max_f32 v221, 0, v221
  v_pk_add_f32 v[222:223], v[222:223], v[54:55] op_sel_hi:[1,0]
  v_pk_fma_f32 v[220:221], v[220:221], v[52:53], v[222:223] op_sel_hi:[1,0,1]
  s_add_u32 m0, s30, 81920
  s_add_u32 s45, s33, 16384
  buffer_load_dwordx4 v11, s[8:11], s45 offen lds
  v_cvt_pk_bf16_f32 v200, v216, v220
  v_cvt_pk_bf16_f32 v201, v217, v221
  v_pk_mul_f32 v[216:217], v[106:107], v[48:49] op_sel_hi:[1,0]
  v_exp_f32_e64 v218, v216 clamp
  v_exp_f32_e64 v219, v217 clamp
  buffer_load_dwordx4 v11, s[8:11], s45 offen offset:1024 lds
  v_max_f32 v216, 0, v216
  v_max_f32 v217, 0, v217
  v_pk_add_f32 v[218:219], v[218:219], v[54:55] op_sel_hi:[1,0]
  v_pk_fma_f32 v[216:217], v[216:217], v[52:53], v[218:219] op_sel_hi:[1,0,1]
  v_pk_mul_f32 v[220:221], v[114:115], v[48:49] op_sel_hi:[1,0]
  v_exp_f32_e64 v222, v220 clamp
  v_exp_f32_e64 v223, v221 clamp
  v_max_f32 v220, 0, v220
  v_max_f32 v221, 0, v221
  v_pk_add_f32 v[222:223], v[222:223], v[54:55] op_sel_hi:[1,0]
  v_pk_fma_f32 v[220:221], v[220:221], v[52:53], v[222:223] op_sel_hi:[1,0,1]
  v_cvt_pk_bf16_f32 v202, v216, v220
  v_cvt_pk_bf16_f32 v203, v217, v221
  v_pk_mul_f32 v[216:217], v[120:121], v[48:49] op_sel_hi:[1,0]
  v_exp_f32_e64 v218, v216 clamp
  v_exp_f32_e64 v219, v217 clamp
  v_max_f32 v216, 0, v216
  s_add_u32 m0, s30, 90112
  s_add_u32 s45, s33, 24576
  buffer_load_dwordx4 v11, s[8:11], s45 offen lds
  v_max_f32 v217, 0, v217
  v_pk_add_f32 v[218:219], v[218:219], v[54:55] op_sel_hi:[1,0]
  v_pk_fma_f32 v[216:217], v[216:217], v[52:53], v[218:219] op_sel_hi:[1,0,1]
  v_cvt_pk_bf16_f32 v208, v216, v217
  v_pk_mul_f32 v[220:221], v[122:123], v[48:49] op_sel_hi:[1,0]
  v_exp_f32_e64 v222, v220 clamp
  v_exp_f32_e64 v223, v221 clamp
  v_max_f32 v220, 0, v220
  v_max_f32 v221, 0, v221
  v_pk_add_f32 v[222:223], v[222:223], v[54:55] op_sel_hi:[1,0]
  v_pk_fma_f32 v[220:221], v[220:221], v[52:53], v[222:223] op_sel_hi:[1,0,1]
  v_cvt_pk_bf16_f32 v209, v220, v221
  v_mov_b32 v210, 0
  v_mov_b32 v211, 0
  v_pk_mul_f32 v[216:217], v[108:109], v[50:51] op_sel_hi:[1,0]
  v_exp_f32_e64 v218, v216 clamp
  v_exp_f32_e64 v219, v217 clamp
  v_max_f32 v216, 0, v216
  v_max_f32 v217, 0, v217
  v_pk_add_f32 v[218:219], v[218:219], v[54:55] op_sel_hi:[1,0]
  v_pk_fma_f32 v[216:217], v[216:217], v[52:53], v[218:219] op_sel_hi:[1,0,1]
  v_pk_mul_f32 v[220:221], v[116:117], v[50:51] op_sel_hi:[1,0]
  v_exp_f32_e64 v222, v220 clamp
  buffer_load_dwordx4 v11, s[8:11], s45 offen offset:1024 lds
  v_exp_f32_e64 v223, v221 clamp
  v_max_f32 v220, 0, v220
  v_max_f32 v221, 0, v221
  v_pk_add_f32 v[222:223], v[222:223], v[54:55] op_sel_hi:[1,0]
  v_pk_fma_f32 v[220:221], v[220:221], v[52:53], v[222:223] op_sel_hi:[1,0,1]
  v_cvt_pk_bf16_f32 v204, v216, v220
  v_cvt_pk_bf16_f32 v205, v217, v221
  v_pk_mul_f32 v[216:217], v[110:111], v[50:51] op_sel_hi:[1,0]
  v_exp_f32_e64 v218, v216 clamp
  v_exp_f32_e64 v219, v217 clamp
  v_max_f32 v216, 0, v216
  v_max_f32 v217, 0, v217
  v_pk_add_f32 v[218:219], v[218:219], v[54:55] op_sel_hi:[1,0]
  v_pk_fma_f32 v[216:217], v[216:217], v[52:53], v[218:219] op_sel_hi:[1,0,1]
  v_pk_mul_f32 v[220:221], v[118:119], v[50:51] op_sel_hi:[1,0]
  v_exp_f32_e64 v222, v220 clamp
  v_exp_f32_e64 v223, v221 clamp
  v_max_f32 v220, 0, v220
  v_max_f32 v221, 0, v221
  v_pk_add_f32 v[222:223], v[222:223], v[54:55] op_sel_hi:[1,0]
  v_pk_fma_f32 v[220:221], v[220:221], v[52:53], v[222:223] op_sel_hi:[1,0,1]
  v_cvt_pk_bf16_f32 v206, v216, v220
  v_cvt_pk_bf16_f32 v207, v217, v221
  s_add_u32 m0, s30, 98304
  s_add_u32 s45, s33, 32768
  buffer_load_dwordx4 v11, s[8:11], s45 offen lds
  v_pk_mul_f32 v[216:217], v[124:125], v[50:51] op_sel_hi:[1,0]
  v_exp_f32_e64 v218, v216 clamp
  v_exp_f32_e64 v219, v217 clamp
  v_max_f32 v216, 0, v216
  v_max_f32 v217, 0, v217
  v_pk_add_f32 v[218:219], v[218:219], v[54:55] op_sel_hi:[1,0]
  v_pk_fma_f32 v[216:217], v[216:217], v[52:53], v[218:219] op_sel_hi:[1,0,1]
  v_cvt_pk_bf16_f32 v212, v216, v217
  v_pk_mul_f32 v[220:221], v[126:127], v[50:51] op_sel_hi:[1,0]
  v_exp_f32_e64 v222, v220 clamp
  v_exp_f32_e64 v223, v221 clamp
  v_max_f32 v220, 0, v220
  v_max_f32 v221, 0, v221
  v_pk_add_f32 v[222:223], v[222:223], v[54:55] op_sel_hi:[1,0]
  v_pk_fma_f32 v[220:221], v[220:221], v[52:53], v[222:223] op_sel_hi:[1,0,1]
  v_cvt_pk_bf16_f32 v213, v220, v221
  v_mov_b32 v214, 0
  v_mov_b32 v215, 0
  s_waitcnt vmcnt(17)
  v_dot2_f32_bf16 v96, v64, s84, 0
  v_dot2_f32_bf16 v97, v64, s85, 0
  v_dot2_f32_bf16 v98, v65, s84, 0
  v_dot2_f32_bf16 v99, v65, s85, 0
  v_dot2_f32_bf16 v100, v66, s84, 0
  v_dot2_f32_bf16 v101, v66, s85, 0
  v_dot2_f32_bf16 v102, v67, s84, 0
  v_dot2_f32_bf16 v103, v67, s85, 0
  s_waitcnt vmcnt(15)
  v_dot2c_f32_bf16 v96, s84, v68
  v_dot2c_f32_bf16 v97, s85, v68
  v_dot2c_f32_bf16 v98, s84, v69
  v_dot2c_f32_bf16 v99, s85, v69
  v_dot2c_f32_bf16 v100, s84, v70
  v_dot2c_f32_bf16 v101, s85, v70
  v_dot2c_f32_bf16 v102, s84, v71
  v_dot2c_f32_bf16 v103, s85, v71
  s_waitcnt vmcnt(14)
  v_dot2c_f32_bf16 v96, s84, v72
  v_dot2c_f32_bf16 v97, s85, v72
  v_dot2c_f32_bf16 v98, s84, v73
  v_dot2c_f32_bf16 v99, s85, v73
  v_dot2c_f32_bf16 v100, s84, v74
  v_dot2c_f32_bf16 v101, s85, v74
  v_dot2c_f32_bf16 v102, s84, v75
  v_dot2c_f32_bf16 v103, s85, v75
  s_waitcnt vmcnt(13)
  v_dot2c_f32_bf16 v96, s84, v76
  v_dot2c_f32_bf16 v97, s85, v76
  v_dot2c_f32_bf16 v98, s84, v77
  v_dot2c_f32_bf16 v99, s85, v77
  v_dot2c_f32_bf16 v100, s84, v78
  v_dot2c_f32_bf16 v101, s85, v78
  v_dot2c_f32_bf16 v102, s84, v79
  v_dot2c_f32_bf16 v103, s85, v79
  s_waitcnt vmcnt(12)
  v_dot2c_f32_bf16 v96, s84, v80
  v_dot2c_f32_bf16 v97, s85, v80
  v_dot2c_f32_bf16 v98, s84, v81
  v_dot2c_f32_bf16 v99, s85, v81
  v_dot2c_f32_bf16 v100, s84, v82
  v_dot2c_f32_bf16 v101, s85, v82
  v_dot2c_f32_bf16 v102, s84, v83
  v_dot2c_f32_bf16 v103, s85, v83
  s_waitcnt vmcnt(11)
  v_dot2c_f32_bf16 v96, s84, v84
  v_dot2c_f32_bf16 v97, s85, v84
  v_dot2c_f32_bf16 v98, s84, v85
  v_dot2c_f32_bf16 v99, s85, v85
  v_dot2c_f32_bf16 v100, s84, v86
  v_dot2c_f32_bf16 v101, s85, v86
  v_dot2c_f32_bf16 v102, s84, v87
  v_dot2c_f32_bf16 v103, s85, v87
  s_waitcnt vmcnt(10)
  v_dot2c_f32_bf16 v96, s84, v88
  v_dot2c_f32_bf16 v97, s85, v88
  v_dot2c_f32_bf16 v98, s84, v89
  v_dot2c_f32_bf16 v99, s85, v89
  v_dot2c_f32_bf16 v100, s84, v90
  v_dot2c_f32_bf16 v101, s85, v90
  v_dot2c_f32_bf16 v102, s84, v91
  v_dot2c_f32_bf16 v103, s85, v91
  s_waitcnt vmcnt(9)
  v_dot2c_f32_bf16 v96, s84, v92
  v_dot2c_f32_bf16 v97, s85, v92
  v_dot2c_f32_bf16 v98, s84, v93
  v_dot2c_f32_bf16 v99, s85, v93
  v_dot2c_f32_bf16 v100, s84, v94
  v_dot2c_f32_bf16 v101, s85, v94
  v_dot2c_f32_bf16 v102, s84, v95
  v_dot2c_f32_bf16 v103, s85, v95
  v_add_f32_dpp v96, v96, v96 quad_perm:[1,0,3,2] row_mask:0xf bank_mask:0xf
  v_add_f32_dpp v97, v97, v97 quad_perm:[1,0,3,2] row_mask:0xf bank_mask:0xf
  v_add_f32_dpp v98, v98, v98 quad_perm:[1,0,3,2] row_mask:0xf bank_mask:0xf
  v_add_f32_dpp v99, v99, v99 quad_perm:[1,0,3,2] row_mask:0xf bank_mask:0xf
  v_add_f32_dpp v100, v100, v100 quad_perm:[1,0,3,2] row_mask:0xf bank_mask:0xf
  v_add_f32_dpp v101, v101, v101 quad_perm:[1,0,3,2] row_mask:0xf bank_mask:0xf
  v_add_f32_dpp v102, v102, v102 quad_perm:[1,0,3,2] row_mask:0xf bank_mask:0xf
  v_add_f32_dpp v103, v103, v103 quad_perm:[1,0,3,2] row_mask:0xf bank_mask:0xf
  v_cndmask_b32 v64, v96, v100, s[86:87]
  v_cndmask_b32 v65, v97, v101, s[86:87]
  v_cndmask_b32 v66, v98, v102, s[86:87]
  v_cndmask_b32 v67, v99, v103, s[86:87]
  v_cmp_u_f32 vcc, v64, v65
  v_cmp_u_f32 s[90:91], v66, v67
  s_or_b64 vcc, vcc, s[90:91]
  s_cbranch_scc0 kvok_60
  s_mov_b32 s50, 0
kvretry_61:
  s_sleep 4
  s_add_u32 s42, s61, 21299200
  buffer_load_dwordx4 v[64:67], v37, s[8:11], s42 offen sc1
  buffer_load_dwordx4 v[68:71], v37, s[8:11], s42 offen offset:1792 sc1
  s_add_u32 s42, s61, 21302784
  buffer_load_dwordx4 v[72:75], v37, s[8:11], s42 offen sc1
  buffer_load_dwordx4 v[76:79], v37, s[8:11], s42 offen offset:1792 sc1
  s_add_u32 s42, s61, 21306368
  buffer_load_dwordx4 v[80:83], v37, s[8:11], s42 offen sc1
  buffer_load_dwordx4 v[84:87], v37, s[8:11], s42 offen offset:1792 sc1
  s_add_u32 s42, s61, 21309952
  buffer_load_dwordx4 v[88:91], v37, s[8:11], s42 offen sc1
  buffer_load_dwordx4 v[92:95], v37, s[8:11], s42 offen offset:1792 sc1
  s_waitcnt vmcnt(7)
  v_dot2_f32_bf16 v96, v64, s84, 0
  v_dot2_f32_bf16 v97, v64, s85, 0
  v_dot2_f32_bf16 v98, v65, s84, 0
  v_dot2_f32_bf16 v99, v65, s85, 0
  v_dot2_f32_bf16 v100, v66, s84, 0
  v_dot2_f32_bf16 v101, v66, s85, 0
  v_dot2_f32_bf16 v102, v67, s84, 0
  v_dot2_f32_bf16 v103, v67, s85, 0
  s_waitcnt vmcnt(6)
  v_dot2c_f32_bf16 v96, s84, v68
  v_dot2c_f32_bf16 v97, s85, v68
  v_dot2c_f32_bf16 v98, s84, v69
  v_dot2c_f32_bf16 v99, s85, v69
  v_dot2c_f32_bf16 v100, s84, v70
  v_dot2c_f32_bf16 v101, s85, v70
  v_dot2c_f32_bf16 v102, s84, v71
  v_dot2c_f32_bf16 v103, s85, v71
  s_waitcnt vmcnt(5)
  v_dot2c_f32_bf16 v96, s84, v72
  v_dot2c_f32_bf16 v97, s85, v72
  v_dot2c_f32_bf16 v98, s84, v73
  v_dot2c_f32_bf16 v99, s85, v73
  v_dot2c_f32_bf16 v100, s84, v74
  v_dot2c_f32_bf16 v101, s85, v74
  v_dot2c_f32_bf16 v102, s84, v75
  v_dot2c_f32_bf16 v103, s85, v75
  s_waitcnt vmcnt(4)
  v_dot2c_f32_bf16 v96, s84, v76
  v_dot2c_f32_bf16 v97, s85, v76
  v_dot2c_f32_bf16 v98, s84, v77
  v_dot2c_f32_bf16 v99, s85, v77
  v_dot2c_f32_bf16 v100, s84, v78
  v_dot2c_f32_bf16 v101, s85, v78
  v_dot2c_f32_bf16 v102, s84, v79
  v_dot2c_f32_bf16 v103, s85, v79
  s_waitcnt vmcnt(3)
  v_dot2c_f32_bf16 v96, s84, v80
  v_dot2c_f32_bf16 v97, s85, v80
  v_dot2c_f32_bf16 v98, s84, v81
  v_dot2c_f32_bf16 v99, s85, v81
  v_dot2c_f32_bf16 v100, s84, v82
  v_dot2c_f32_bf16 v101, s85, v82
  v_dot2c_f32_bf16 v102, s84, v83
  v_dot2c_f32_bf16 v103, s85, v83
  s_waitcnt vmcnt(2)
  v_dot2c_f32_bf16 v96, s84, v84
  v_dot2c_f32_bf16 v97, s85, v84
  v_dot2c_f32_bf16 v98, s84, v85
  v_dot2c_f32_bf16 v99, s85, v85
  v_dot2c_f32_bf16 v100, s84, v86
  v_dot2c_f32_bf16 v101, s85, v86
  v_dot2c_f32_bf16 v102, s84, v87
  v_dot2c_f32_bf16 v103, s85, v87
  s_waitcnt vmcnt(1)
  v_dot2c_f32_bf16 v96, s84, v88
  v_dot2c_f32_bf16 v97, s85, v88
  v_dot2c_f32_bf16 v98, s84, v89
  v_dot2c_f32_bf16 v99, s85, v89
  v_dot2c_f32_bf16 v100, s84, v90
  v_dot2c_f32_bf16 v101, s85, v90
  v_dot2c_f32_bf16 v102, s84, v91
  v_dot2c_f32_bf16 v103, s85, v91
  s_waitcnt vmcnt(0)
  v_dot2c_f32_bf16 v96, s84, v92
  v_dot2c_f32_bf16 v97, s85, v92
  v_dot2c_f32_bf16 v98, s84, v93
  v_dot2c_f32_bf16 v99, s85, v93
  v_dot2c_f32_bf16 v100, s84, v94
  v_dot2c_f32_bf16 v101, s85, v94
  v_dot2c_f32_bf16 v102, s84, v95
  v_dot2c_f32_bf16 v103, s85, v95
  v_add_f32_dpp v96, v96, v96 quad_perm:[1,0,3,2] row_mask:0xf bank_mask:0xf
  v_add_f32_dpp v97, v97, v97 quad_perm:[1,0,3,2] row_mask:0xf bank_mask:0xf
  v_add_f32_dpp v98, v98, v98 quad_perm:[1,0,3,2] row_mask:0xf bank_mask:0xf
  v_add_f32_dpp v99, v99, v99 quad_perm:[1,0,3,2] row_mask:0xf bank_mask:0xf
  v_add_f32_dpp v100, v100, v100 quad_perm:[1,0,3,2] row_mask:0xf bank_mask:0xf
  v_add_f32_dpp v101, v101, v101 quad_perm:[1,0,3,2] row_mask:0xf bank_mask:0xf
  v_add_f32_dpp v102, v102, v102 quad_perm:[1,0,3,2] row_mask:0xf bank_mask:0xf
  v_add_f32_dpp v103, v103, v103 quad_perm:[1,0,3,2] row_mask:0xf bank_mask:0xf
  v_cndmask_b32 v64, v96, v100, s[86:87]
  v_cndmask_b32 v65, v97, v101, s[86:87]
  v_cndmask_b32 v66, v98, v102, s[86:87]
  v_cndmask_b32 v67, v99, v103, s[86:87]
  v_cmp_u_f32 vcc, v64, v65
  v_cmp_u_f32 s[90:91], v66, v67
  s_or_b64 vcc, vcc, s[90:91]
  s_cbranch_scc0 kvok_60
  s_add_u32 s50, s50, 1
  s_cmp_lt_u32 s50, 65536
  s_cbranch_scc1 kvretry_61
kvok_60:
  v_cvt_pk_bf16_f32 v216, v64, v65
  buffer_load_dwordx4 v11, s[8:11], s45 offen offset:1024 lds
  v_cvt_pk_bf16_f32 v217, v66, v67
  ds_write_b64 v21, v[216:217]
  s_waitcnt lgkmcnt(0)
  s_barrier
  ds_read_b128 v[104:107], v4
  ds_read_b128 v[108:111], v4 offset:1024
  ds_read_b128 v[112:115], v4 offset:2048
  ds_read_b128 v[116:119], v4 offset:3072
  ds_read_b128 v[120:123], v4 offset:4096
  ds_read_b128 v[124:127], v4 offset:5120
  ds_read_b128 v[216:219], v23
  ds_read_b128 v[224:227], v24
  ds_read_b128 v[220:223], v23 offset:64
  ds_read_b128 v[228:231], v24 offset:64
  s_waitcnt lgkmcnt(3)
  v_mfma_f32_16x16x32_bf16 v[88:91], v[216:219], v[200:203], 0
  s_waitcnt lgkmcnt(2)
  v_mfma_f32_16x16x32_bf16 v[96:99], v[224:227], v[200:203], 0
  v_mfma_f32_16x16x32_bf16 v[64:67], v[104:107], v[200:203], 0
  v_mfma_f32_16x16x32_bf16 v[72:75], v[112:115], v[200:203], 0
  v_mfma_f32_16x16x32_bf16 v[80:83], v[120:123], v[200:203], 0
  s_waitcnt lgkmcnt(1)
  v_mfma_f32_16x16x32_bf16 v[88:91], v[220:223], v[208:211], v[88:91]
  s_waitcnt lgkmcnt(0)
  v_mfma_f32_16x16x32_bf16 v[96:99], v[228:231], v[208:211], v[96:99]
  v_mfma_f32_16x16x32_bf16 v[64:67], v[108:111], v[208:211], v[64:67]
  v_mfma_f32_16x16x32_bf16 v[72:75], v[116:119], v[208:211], v[72:75]
  v_mfma_f32_16x16x32_bf16 v[80:83], v[124:127], v[208:211], v[80:83]
  s_add_u32 s41, s57, 11141120
  s_add_u32 s42, s58, 11141120
  v_mfma_f32_16x16x32_bf16 v[92:95], v[216:219], v[204:207], 0
  s_add_u32 s43, s58, 11161600
  v_mfma_f32_16x16x32_bf16 v[100:103], v[224:227], v[204:207], 0
  v_add_f32 v88, v54, v88
  v_add_f32 v90, v54, v90
  v_mfma_f32_16x16x32_bf16 v[68:71], v[104:107], v[204:207], 0
  v_add_f32 v96, v54, v96
  v_mfma_f32_16x16x32_bf16 v[76:79], v[112:115], v[204:207], 0
  v_rcp_f32 v88, v88
  v_mfma_f32_16x16x32_bf16 v[84:87], v[120:123], v[204:207], 0
  v_rcp_f32 v90, v90
  v_rcp_f32 v96, v96
  v_mfma_f32_16x16x32_bf16 v[92:95], v[220:223], v[212:215], v[92:95]
  v_mul_f32 v64, v64, v88
  v_mul_f32 v65, v65, v88
  v_mfma_f32_16x16x32_bf16 v[100:103], v[228:231], v[212:215], v[100:103]
  v_mul_f32 v66, v66, v90
  v_mul_f32 v67, v67, v90
  v_mfma_f32_16x16x32_bf16 v[68:71], v[108:111], v[212:215], v[68:71]
  v_mul_f32 v72, v72, v88
  v_mul_f32 v73, v73, v88
  v_mfma_f32_16x16x32_bf16 v[76:79], v[116:119], v[212:215], v[76:79]
  v_mul_f32 v74, v74, v90
  v_mul_f32 v75, v75, v90
  v_mfma_f32_16x16x32_bf16 v[84:87], v[124:127], v[212:215], v[84:87]
  v_mul_f32 v80, v80, v96
  v_mul_f32 v81, v81, v96
  v_mul_f32 v82, v82, v96
  v_mul_f32 v83, v83, v96
  v_cvt_pk_bf16_f32 v56, v64, v72
  v_cvt_pk_bf16_f32 v57, v65, v73
  v_cvt_pk_bf16_f32 v58, v66, v74
  v_cvt_pk_bf16_f32 v59, v67, v75
  v_cvt_pk_bf16_f32 v40, v80, v81
  v_cvt_pk_bf16_f32 v41, v82, v83
  s_cmp_eq_u32 s47, 0
  s_cbranch_scc1 st_safe_62
  buffer_store_dwordx4 v[56:59], v12, s[8:11], s41 offen
  buffer_store_dwordx2 v[40:41], v31, s[8:11], s42 offen
  s_branch st_end_63
st_safe_62:
  buffer_store_dwordx4 v[56:59], v12, s[8:11], s41 offen sc1
  buffer_store_dwordx2 v[40:41], v31, s[8:11], s42 offen sc1
st_end_63:
  v_add_f32 v92, v54, v92
  v_add_f32 v94, v54, v94
  v_add_f32 v100, v54, v100
  v_rcp_f32 v92, v92
  v_rcp_f32 v94, v94
  v_rcp_f32 v100, v100
  v_pk_mul_f32 v[68:69], v[68:69], v[92:93] op_sel_hi:[1,0]
  v_pk_mul_f32 v[70:71], v[70:71], v[94:95] op_sel_hi:[1,0]
  v_pk_mul_f32 v[76:77], v[76:77], v[92:93] op_sel_hi:[1,0]
  v_pk_mul_f32 v[78:79], v[78:79], v[94:95] op_sel_hi:[1,0]
  v_pk_mul_f32 v[84:85], v[84:85], v[100:101] op_sel_hi:[1,0]
  v_pk_mul_f32 v[86:87], v[86:87], v[100:101] op_sel_hi:[1,0]
  v_cvt_pk_bf16_f32 v60, v68, v76
  v_cvt_pk_bf16_f32 v61, v69, v77
  v_cvt_pk_bf16_f32 v62, v70, v78
  v_cvt_pk_bf16_f32 v63, v71, v79
  v_cvt_pk_bf16_f32 v44, v84, v85
  v_cvt_pk_bf16_f32 v45, v86, v87
  s_cmp_eq_u32 s47, 0
  s_cbranch_scc1 st_safe_64
  buffer_store_dwordx4 v[60:63], v13, s[8:11], s41 offen
  buffer_store_dwordx2 v[44:45], v31, s[8:11], s43 offen
  s_branch st_end_65
st_safe_64:
  buffer_store_dwordx4 v[60:63], v13, s[8:11], s41 offen sc1
  buffer_store_dwordx2 v[44:45], v31, s[8:11], s43 offen sc1
st_end_65:
  s_waitcnt vmcnt(0)
  s_barrier
  s_lshl_b32 s41, s47, 2
  s_add_u32 s41, s41, s24
  s_cmp_lg_u32 s41, 1
  s_cbranch_scc1 noflag_66
  s_lshl_b32 s41, s26, 2
  v_mov_b32 v237, s41
  s_add_u32 s41, s92, 6
  v_mov_b32 v238, s41
  s_mov_b64 exec, 1
  buffer_store_dword v238, v237, s[8:11], s39 offen sc1
  s_mov_b64 exec, -1
noflag_66:
  s_cmp_lg_u32 s24, 2
  s_cbranch_scc1 noflag_67
  s_lshl_b32 s41, s26, 2
  v_mov_b32 v237, s41
  s_add_u32 s41, s92, 6
  v_mov_b32 v238, s41
  s_mov_b64 exec, 1
  buffer_store_dword v238, v237, s[8:11], s38 offen
  s_mov_b64 exec, -1
noflag_67:
  s_add_u32 m0, s30, 106496
  s_add_u32 s45, s33, 40960
  buffer_load_dwordx4 v11, s[8:11], s45 offen lds
  buffer_load_dwordx4 v11, s[8:11], s45 offen offset:1024 lds
  ds_read_b128 v[144:147], v9 offset:49152
  ds_read_b128 v[148:151], v9 offset:51200
  ds_read_b128 v[152:155], v9 offset:53248
  ds_read_b128 v[156:159], v9 offset:55296
  ds_read_b128 v[128:131], v9 offset:57344
  ds_read_b128 v[132:135], v9 offset:59392
  ds_read_b128 v[136:139], v9 offset:61440
  ds_read_b128 v[140:143], v9 offset:63488
  s_mul_i32 s42, s27, 160
  v_lshl_add_u32 v202, v3, 4, s42
  v_lshl_add_u32 v203, v3, 3, s42
  buffer_load_dwordx4 v[104:107], v202, s[20:23], 0 offen
  buffer_load_dwordx4 v[108:111], v202, s[20:23], 0 offen offset:64
  buffer_load_dwordx2 v[112:113], v203, s[20:23], 0 offen offset:128
  s_cmp_lg_u32 s24, 0
  s_cbranch_scc1 nopoll_68
  s_mov_b32 s50, 0
  s_mov_b64 s[94:95], 0
  s_add_u32 s42, s92, 6
  s_cmp_eq_u32 s47, 0
  s_cselect_b32 s43, 3, -1
poll_69:
  buffer_load_dword v238, v36, s[8:11], s38 offen sc1
  s_add_u32 s50, s50, 1
  s_waitcnt vmcnt(0)
  v_subrev_u32 v238, s42, v238
  v_cmp_ge_u32 vcc, 1, v238
  s_or_b64 s[94:95], s[94:95], vcc
  s_cmp_eq_u64 s[94:95], -1
  s_cbranch_scc1 nopoll_68
  s_and_b32 s41, s50, s43
  s_cbranch_scc1 pollnext_70
  buffer_load_dword v238, v36, s[8:11], s39 offen sc1
  s_waitcnt vmcnt(0)
  v_subrev_u32 v238, s42, v238
  v_cmp_ge_u32 vcc, 1, v238
  s_or_b64 s[94:95], s[94:95], vcc
  s_cmp_eq_u64 s[94:95], -1
  s_cbranch_scc1 nopoll_68
pollnext_70:
  s_cmp_lt_u32 s50, 0x80000
  s_cbranch_scc1 poll_69
nopoll_68:
  s_barrier
  s_add_u32 s46, s35, 11141120
  buffer_load_dwordx4 a[0:3], v14, s[8:11], s46 offen sc1
  buffer_load_dwordx4 a[4:7], v15, s[8:11], s46 offen sc1
  buffer_load_dwordx4 a[8:11], v14, s[8:11], s46 offen offset:1024 sc1
  buffer_load_dwordx4 a[12:15], v15, s[8:11], s46 offen offset:1024 sc1
  buffer_load_dwordx4 a[16:19], v14, s[8:11], s46 offen offset:2048 sc1
  buffer_load_dwordx4 a[20:23], v15, s[8:11], s46 offen offset:2048 sc1
  buffer_load_dwordx4 a[24:27], v14, s[8:11], s46 offen offset:3072 sc1
  buffer_load_dwordx4 a[28:31], v15, s[8:11], s46 offen offset:3072 sc1
  s_waitcnt vmcnt(6) lgkmcnt(6)
  v_mfma_f32_16x16x32_bf16 v[84:87], v[144:147], a[4:7], 0
  s_add_u32 s46, s35, 11145216
  buffer_load_dwordx4 a[32:35], v14, s[8:11], s46 offen sc1
  v_mfma_f32_16x16x32_bf16 v[64:67], v[144:147], a[0:3], v[160:163]
  ds_read_b128 v[144:147], v10
  buffer_load_dwordx4 a[36:39], v15, s[8:11], s46 offen sc1
  v_mfma_f32_16x16x32_bf16 v[88:91], v[148:151], a[4:7], 0
  buffer_load_dwordx4 a[40:43], v14, s[8:11], s46 offen offset:1024 sc1
  buffer_load_dwordx4 a[44:47], v15, s[8:11], s46 offen offset:1024 sc1
  v_mfma_f32_16x16x32_bf16 v[68:71], v[148:151], a[0:3], v[164:167]
  ds_read_b128 v[148:151], v10 offset:2048
  s_waitcnt lgkmcnt(6)
  v_mfma_f32_16x16x32_bf16 v[92:95], v[152:155], a[4:7], 0
  buffer_load_dwordx4 a[48:51], v14, s[8:11], s46 offen offset:2048 sc1
  buffer_load_dwordx4 a[52:55], v15, s[8:11], s46 offen offset:2048 sc1
  v_mfma_f32_16x16x32_bf16 v[72:75], v[152:155], a[0:3], v[168:171]
  ds_read_b128 v[152:155], v10 offset:4096
  v_mfma_f32_16x16x32_bf16 v[96:99], v[156:159], a[4:7], 0
  buffer_load_dwordx4 a[56:59], v14, s[8:11], s46 offen offset:3072 sc1
  v_mfma_f32_16x16x32_bf16 v[76:79], v[156:159], a[0:3], v[172:175]
  ds_read_b128 v[156:159], v10 offset:6144
  s_waitcnt vmcnt(11) lgkmcnt(6)
  v_mfma_f32_16x16x32_bf16 v[100:103], v[128:131], a[4:7], 0
  s_barrier
  v_mfma_f32_16x16x32_bf16 v[80:83], v[128:131], a[0:3], v[176:179]
  ds_read_b128 v[128:131], v10 offset:8192
  buffer_load_dwordx4 a[60:63], v15, s[8:11], s46 offen offset:3072 sc1
  v_mfma_f32_16x16x32_bf16 v[84:87], v[132:135], a[12:15], v[84:87]
  v_mfma_f32_16x16x32_bf16 v[64:67], v[132:135], a[8:11], v[64:67]
  ds_read_b128 v[132:135], v10 offset:10240
  s_waitcnt lgkmcnt(6)
  v_mfma_f32_16x16x32_bf16 v[88:91], v[136:139], a[12:15], v[88:91]
  s_add_u32 s46, s35, 11149312
  buffer_load_dwordx4 a[64:67], v14, s[8:11], s46 offen sc1
  v_mfma_f32_16x16x32_bf16 v[68:71], v[136:139], a[8:11], v[68:71]
  ds_read_b128 v[136:139], v10 offset:12288
  v_mfma_f32_16x16x32_bf16 v[92:95], v[140:143], a[12:15], v[92:95]
  buffer_load_dwordx4 a[68:71], v15, s[8:11], s46 offen sc1
  v_mfma_f32_16x16x32_bf16 v[72:75], v[140:143], a[8:11], v[72:75]
  ds_read_b128 v[140:143], v10 offset:14336
  s_waitcnt lgkmcnt(6)
  v_mfma_f32_16x16x32_bf16 v[96:99], v[144:147], a[12:15], v[96:99]
  buffer_load_dwordx4 a[72:75], v14, s[8:11], s46 offen offset:1024 sc1
  v_mfma_f32_16x16x32_bf16 v[76:79], v[144:147], a[8:11], v[76:79]
  ds_read_b128 v[144:147], v10 offset:16384
  v_mfma_f32_16x16x32_bf16 v[100:103], v[148:151], a[12:15], v[100:103]
  v_mfma_f32_16x16x32_bf16 v[80:83], v[148:151], a[8:11], v[80:83]
  ds_read_b128 v[148:151], v10 offset:18432
  s_waitcnt vmcnt(13) lgkmcnt(6)
  v_mfma_f32_16x16x32_bf16 v[84:87], v[152:155], a[20:23], v[84:87]
  v_mfma_f32_16x16x32_bf16 v[64:67], v[152:155], a[16:19], v[64:67]
  ds_read_b128 v[152:155], v10 offset:20480
  buffer_load_dwordx4 a[76:79], v15, s[8:11], s46 offen offset:1024 sc1
  v_mfma_f32_16x16x32_bf16 v[88:91], v[156:159], a[20:23], v[88:91]
  v_mfma_f32_16x16x32_bf16 v[68:71], v[156:159], a[16:19], v[68:71]
  ds_read_b128 v[156:159], v10 offset:22528
  s_waitcnt lgkmcnt(6)
  v_mfma_f32_16x16x32_bf16 v[92:95], v[128:131], a[20:23], v[92:95]
  v_mfma_f32_16x16x32_bf16 v[72:75], v[128:131], a[16:19], v[72:75]
  ds_read_b128 v[128:131], v10 offset:24576
  v_mfma_f32_16x16x32_bf16 v[96:99], v[132:135], a[20:23], v[96:99]
  s_add_u32 m0, s30, 114688
  s_add_u32 s45, s33, 49152
  v_mfma_f32_16x16x32_bf16 v[76:79], v[132:135], a[16:19], v[76:79]
  ds_read_b128 v[132:135], v10 offset:26624
  s_waitcnt vmcnt(12) lgkmcnt(6)
  v_mfma_f32_16x16x32_bf16 v[100:103], v[136:139], a[20:23], v[100:103]
  buffer_load_dwordx4 v11, s[8:11], s45 offen lds
  v_mfma_f32_16x16x32_bf16 v[80:83], v[136:139], a[16:19], v[80:83]
  ds_read_b128 v[136:139], v10 offset:28672
  v_mfma_f32_16x16x32_bf16 v[84:87], v[140:143], a[28:31], v[84:87]
  v_mfma_f32_16x16x32_bf16 v[64:67], v[140:143], a[24:27], v[64:67]
  ds_read_b128 v[140:143], v10 offset:30720
  s_waitcnt lgkmcnt(6)
  v_mfma_f32_16x16x32_bf16 v[88:91], v[144:147], a[28:31], v[88:91]
  buffer_load_dwordx4 v11, s[8:11], s45 offen offset:1024 lds
  s_barrier
  v_mfma_f32_16x16x32_bf16 v[68:71], v[144:147], a[24:27], v[68:71]
  ds_read_b128 v[144:147], v8 offset:8192
  v_mfma_f32_16x16x32_bf16 v[92:95], v[148:151], a[28:31], v[92:95]
  v_mfma_f32_16x16x32_bf16 v[72:75], v[148:151], a[24:27], v[72:75]
  ds_read_b128 v[148:151], v8 offset:10240
  s_waitcnt lgkmcnt(6)
  v_mfma_f32_16x16x32_bf16 v[96:99], v[152:155], a[28:31], v[96:99]
  s_add_u32 m0, s30, 122880
  s_add_u32 s45, s33, 57344
  v_mfma_f32_16x16x32_bf16 v[76:79], v[152:155], a[24:27], v[76:79]
  ds_read_b128 v[152:155], v8 offset:12288
  buffer_load_dwordx4 v11, s[8:11], s45 offen lds
  v_mfma_f32_16x16x32_bf16 v[100:103], v[156:159], a[28:31], v[100:103]
  v_mfma_f32_16x16x32_bf16 v[80:83], v[156:159], a[24:27], v[80:83]
  ds_read_b128 v[156:159], v8 offset:14336
  s_waitcnt vmcnt(13) lgkmcnt(6)
  v_mfma_f32_16x16x32_bf16 v[84:87], v[128:131], a[36:39], v[84:87]
  v_mfma_f32_16x16x32_bf16 v[64:67], v[128:131], a[32:35], v[64:67]
  ds_read_b128 v[128:131], v8 offset:16384
  buffer_load_dwordx4 v11, s[8:11], s45 offen offset:1024 lds
  v_mfma_f32_16x16x32_bf16 v[88:91], v[132:135], a[36:39], v[88:91]
  v_mfma_f32_16x16x32_bf16 v[68:71], v[132:135], a[32:35], v[68:71]
  ds_read_b128 v[132:135], v8 offset:18432
  s_waitcnt lgkmcnt(6)
  v_mfma_f32_16x16x32_bf16 v[92:95], v[136:139], a[36:39], v[92:95]
  v_add_u32 v200, 34816, v39
  s_xor_b32 s41, s24, 1
  v_mfma_f32_16x16x32_bf16 v[72:75], v[136:139], a[32:35], v[72:75]
  ds_read_b128 v[136:139], v8 offset:20480
  s_mul_i32 s41, s41, 5120
  v_mfma_f32_16x16x32_bf16 v[96:99], v[140:143], a[36:39], v[96:99]
  s_add_u32 s41, s41, 34816
  v_add_u32 v201, s41, v4
  v_mfma_f32_16x16x32_bf16 v[76:79], v[140:143], a[32:35], v[76:79]
  ds_read_b128 v[140:143], v8 offset:22528
  s_waitcnt vmcnt(12) lgkmcnt(6)
  v_mfma_f32_16x16x32_bf16 v[100:103], v[144:147], a[36:39], v[100:103]
  s_add_u32 s41, s54, 8388608
  s_add_u32 s42, s55, 8388608
  v_mfma_f32_16x16x32_bf16 v[80:83], v[144:147], a[32:35], v[80:83]
  ds_read_b128 v[144:147], v8 offset:24576
  s_add_u32 s43, s56, 11010048
  v_mfma_f32_16x16x32_bf16 v[84:87], v[148:151], a[44:47], v[84:87]
  v_mfma_f32_16x16x32_bf16 v[64:67], v[148:151], a[40:43], v[64:67]
  ds_read_b128 v[148:151], v8 offset:26624
  s_waitcnt lgkmcnt(6)
  v_mfma_f32_16x16x32_bf16 v[88:91], v[152:155], a[44:47], v[88:91]
  v_mfma_f32_16x16x32_bf16 v[68:71], v[152:155], a[40:43], v[68:71]
  ds_read_b128 v[152:155], v8 offset:28672
  v_mfma_f32_16x16x32_bf16 v[92:95], v[156:159], a[44:47], v[92:95]
  v_mfma_f32_16x16x32_bf16 v[72:75], v[156:159], a[40:43], v[72:75]
  ds_read_b128 v[156:159], v8 offset:30720
  s_waitcnt lgkmcnt(6)
  v_mfma_f32_16x16x32_bf16 v[96:99], v[128:131], a[44:47], v[96:99]
  s_barrier
  v_mfma_f32_16x16x32_bf16 v[76:79], v[128:131], a[40:43], v[76:79]
  ds_read_b128 v[128:131], v8 offset:32768
  s_add_u32 m0, s30, 8192
  v_mfma_f32_16x16x32_bf16 v[100:103], v[132:135], a[44:47], v[100:103]
  s_add_u32 s45, s33, 98304
  buffer_load_dwordx4 v11, s[8:11], s45 offen lds
  v_mfma_f32_16x16x32_bf16 v[80:83], v[132:135], a[40:43], v[80:83]
  ds_read_b128 v[132:135], v8 offset:34816
  s_waitcnt vmcnt(11) lgkmcnt(6)
  v_mfma_f32_16x16x32_bf16 v[84:87], v[136:139], a[52:55], v[84:87]
  buffer_load_dwordx4 v11, s[8:11], s45 offen offset:1024 lds
  v_mfma_f32_16x16x32_bf16 v[64:67], v[136:139], a[48:51], v[64:67]
  ds_read_b128 v[136:139], v8 offset:36864
  v_mfma_f32_16x16x32_bf16 v[88:91], v[140:143], a[52:55], v[88:91]
  v_mfma_f32_16x16x32_bf16 v[68:71], v[140:143], a[48:51], v[68:71]
  ds_read_b128 v[140:143], v8 offset:38912
  s_waitcnt lgkmcnt(6)
  v_mfma_f32_16x16x32_bf16 v[92:95], v[144:147], a[52:55], v[92:95]
here_71:
  v_add_u32 v51, here_71-interleave_layers__linear_attn_block__dense_activation_squared_relu__prompt_kernel+1024, v38
  v_min_u32 v51, 57340, v51
  global_load_dword v49, v51, s[96:97]
  v_mfma_f32_16x16x32_bf16 v[72:75], v[144:147], a[48:51], v[72:75]
  ds_read_b128 v[144:147], v8 offset:40960
  v_mfma_f32_16x16x32_bf16 v[96:99], v[148:151], a[52:55], v[96:99]
  v_mfma_f32_16x16x32_bf16 v[76:79], v[148:151], a[48:51], v[76:79]
  ds_read_b128 v[148:151], v8 offset:43008
  s_waitcnt vmcnt(11) lgkmcnt(6)
  v_mfma_f32_16x16x32_bf16 v[100:103], v[152:155], a[52:55], v[100:103]
  v_mfma_f32_16x16x32_bf16 v[80:83], v[152:155], a[48:51], v[80:83]
  ds_read_b128 v[152:155], v8 offset:45056
  v_mfma_f32_16x16x32_bf16 v[84:87], v[156:159], a[60:63], v[84:87]
  v_mfma_f32_16x16x32_bf16 v[64:67], v[156:159], a[56:59], v[64:67]
  ds_read_b128 v[156:159], v8 offset:47104
  s_waitcnt lgkmcnt(6)
  v_mfma_f32_16x16x32_bf16 v[88:91], v[128:131], a[60:63], v[88:91]
  v_mfma_f32_16x16x32_bf16 v[68:71], v[128:131], a[56:59], v[68:71]
  ds_read_b128 v[128:131], v8 offset:49152
  v_mfma_f32_16x16x32_bf16 v[92:95], v[132:135], a[60:63], v[92:95]
  v_mfma_f32_16x16x32_bf16 v[72:75], v[132:135], a[56:59], v[72:75]
  ds_read_b128 v[132:135], v8 offset:51200
  s_waitcnt lgkmcnt(6)
  v_mfma_f32_16x16x32_bf16 v[96:99], v[136:139], a[60:63], v[96:99]
  v_mfma_f32_16x16x32_bf16 v[76:79], v[136:139], a[56:59], v[76:79]
  ds_read_b128 v[136:139], v8 offset:53248
  v_mfma_f32_16x16x32_bf16 v[100:103], v[140:143], a[60:63], v[100:103]
  v_mfma_f32_16x16x32_bf16 v[80:83], v[140:143], a[56:59], v[80:83]
  ds_read_b128 v[140:143], v8 offset:55296
  s_waitcnt vmcnt(9) lgkmcnt(6)
  v_mfma_f32_16x16x32_bf16 v[84:87], v[144:147], a[68:71], v[84:87]
  s_barrier
  v_mfma_f32_16x16x32_bf16 v[64:67], v[144:147], a[64:67], v[64:67]
  ds_read_b128 v[144:147], v8 offset:57344
  s_add_u32 m0, s30, 16384
  v_mfma_f32_16x16x32_bf16 v[88:91], v[148:151], a[68:71], v[88:91]
  s_add_u32 s45, s33, 106496
  buffer_load_dwordx4 v11, s[8:11], s45 offen lds
  v_mfma_f32_16x16x32_bf16 v[68:71], v[148:151], a[64:67], v[68:71]
  ds_read_b128 v[148:151], v8 offset:59392
  s_waitcnt lgkmcnt(6)
  v_mfma_f32_16x16x32_bf16 v[92:95], v[152:155], a[68:71], v[92:95]
  buffer_load_dwordx4 v11, s[8:11], s45 offen offset:1024 lds
  v_mfma_f32_16x16x32_bf16 v[72:75], v[152:155], a[64:67], v[72:75]
  v_mfma_f32_16x16x32_bf16 v[96:99], v[156:159], a[68:71], v[96:99]
  s_add_u32 m0, s30, 24576
  s_add_u32 s45, s33, 114688
  v_mfma_f32_16x16x32_bf16 v[76:79], v[156:159], a[64:67], v[76:79]
  buffer_load_dwordx4 v11, s[8:11], s45 offen lds
  s_waitcnt vmcnt(10) lgkmcnt(4)
  v_mfma_f32_16x16x32_bf16 v[100:103], v[128:131], a[68:71], v[100:103]
  v_mfma_f32_16x16x32_bf16 v[80:83], v[128:131], a[64:67], v[80:83]
  buffer_load_dwordx4 v11, s[8:11], s45 offen offset:1024 lds
  v_mfma_f32_16x16x32_bf16 v[84:87], v[132:135], a[76:79], v[84:87]
  v_mfma_f32_16x16x32_bf16 v[64:67], v[132:135], a[72:75], v[64:67]
  s_waitcnt lgkmcnt(2)
  v_mfma_f32_16x16x32_bf16 v[88:91], v[136:139], a[76:79], v[88:91]
  v_mfma_f32_16x16x32_bf16 v[68:71], v[136:139], a[72:75], v[68:71]
  v_mfma_f32_16x16x32_bf16 v[92:95], v[140:143], a[76:79], v[92:95]
  s_barrier
  v_mfma_f32_16x16x32_bf16 v[72:75], v[140:143], a[72:75], v[72:75]
  s_waitcnt lgkmcnt(0)
  v_mfma_f32_16x16x32_bf16 v[96:99], v[144:147], a[76:79], v[96:99]
  v_mfma_f32_16x16x32_bf16 v[76:79], v[144:147], a[72:75], v[76:79]
  v_mfma_f32_16x16x32_bf16 v[100:103], v[148:151], a[76:79], v[100:103]
  v_mfma_f32_16x16x32_bf16 v[80:83], v[148:151], a[72:75], v[80:83]
  ds_write_b128 v200, v[84:87]
  ds_write_b128 v200, v[88:91] offset:1024
  ds_write_b128 v200, v[92:95] offset:2048
  s_nop 1
  ds_write_b128 v200, v[96:99] offset:3072
  s_nop 0
  ds_write_b128 v200, v[100:103] offset:4096
  s_waitcnt lgkmcnt(0)
  s_barrier
  ds_read_b128 v[204:207], v201
  ds_read_b128 v[208:211], v201 offset:1024
  ds_read_b128 v[212:215], v201 offset:2048
  ds_read_b128 v[216:219], v201 offset:3072
  ds_read_b128 v[220:223], v201 offset:4096
  s_waitcnt lgkmcnt(4)
  v_pk_add_f32 v[64:65], v[64:65], v[204:205]
  v_pk_add_f32 v[66:67], v[66:67], v[206:207]
  s_waitcnt lgkmcnt(3)
  v_pk_add_f32 v[68:69], v[68:69], v[208:209]
  v_pk_add_f32 v[70:71], v[70:71], v[210:211]
  s_waitcnt lgkmcnt(2)
  v_pk_add_f32 v[72:73], v[72:73], v[212:213]
  v_pk_add_f32 v[74:75], v[74:75], v[214:215]
  s_waitcnt lgkmcnt(1)
  v_pk_add_f32 v[76:77], v[76:77], v[216:217]
  v_pk_add_f32 v[78:79], v[78:79], v[218:219]
  s_waitcnt lgkmcnt(0)
  v_pk_add_f32 v[80:81], v[80:81], v[220:221]
  v_pk_add_f32 v[82:83], v[82:83], v[222:223]
  v_cvt_pk_bf16_f32 v224, v64, v68
  v_cvt_pk_bf16_f32 v225, v65, v69
  v_cvt_pk_bf16_f32 v226, v66, v70
  v_cvt_pk_bf16_f32 v227, v67, v71
  v_cvt_pk_bf16_f32 v228, v72, v76
  v_cvt_pk_bf16_f32 v229, v73, v77
  v_cvt_pk_bf16_f32 v230, v74, v78
  v_cvt_pk_bf16_f32 v231, v75, v79
  v_cvt_pk_bf16_f32 v232, v80, v81
  v_cvt_pk_bf16_f32 v233, v82, v83
  s_cmp_eq_u32 s47, 0
  s_cbranch_scc1 st_safe_72
  buffer_store_dwordx4 v[224:227], v32, s[8:11], s41 offen
  buffer_store_dwordx4 v[228:231], v32, s[8:11], s41 offen offset:1024
  buffer_store_dwordx2 v[232:233], v33, s[8:11], s42 offen
  s_branch st_end_73
st_safe_72:
  buffer_store_dwordx4 v[224:227], v32, s[8:11], s41 offen sc1
  buffer_store_dwordx4 v[228:231], v32, s[8:11], s41 offen offset:1024 sc1
  buffer_store_dwordx2 v[232:233], v33, s[8:11], s42 offen sc1
st_end_73:
  v_mov_b32 v236, 0
  v_mov_b32 v237, 0
  v_dot2c_f32_bf16 v236, v224, v30
  v_dot2c_f32_bf16 v237, v224, v224
  v_dot2c_f32_bf16 v236, v225, v30
  v_dot2c_f32_bf16 v237, v225, v225
  v_dot2c_f32_bf16 v236, v226, v30
  v_dot2c_f32_bf16 v237, v226, v226
  v_dot2c_f32_bf16 v236, v227, v30
  v_dot2c_f32_bf16 v237, v227, v227
  v_dot2c_f32_bf16 v236, v228, v30
  v_dot2c_f32_bf16 v237, v228, v228
  v_dot2c_f32_bf16 v236, v229, v30
  v_dot2c_f32_bf16 v237, v229, v229
  v_dot2c_f32_bf16 v236, v230, v30
  v_dot2c_f32_bf16 v237, v230, v230
  v_dot2c_f32_bf16 v236, v231, v30
  v_dot2c_f32_bf16 v237, v231, v231
  v_dot2c_f32_bf16 v236, v232, v30
  v_dot2c_f32_bf16 v237, v232, v232
  v_dot2c_f32_bf16 v236, v233, v30
  v_dot2c_f32_bf16 v237, v233, v233
  s_nop 2
  v_permlane32_swap_b32 v236, v237
  v_add_f32 v236, v236, v237
  v_mov_b32 v238, v236
  s_nop 1
  v_permlane16_swap_b32 v236, v238
  v_add_f32 v236, v236, v238
  s_cmp_eq_u32 s47, 0
  s_cbranch_scc1 st_safe_74
  buffer_store_dword v236, v19, s[8:11], s43 offen
  s_branch st_end_75
st_safe_74:
  buffer_store_dword v236, v19, s[8:11], s43 offen sc1
st_end_75:
  v_add_u32 v55, 131072, v11
  ds_write_b128 v55, v[180:183]
  ds_write_b128 v55, v[184:187] offset:1024
  v_add_u32 v55, 139264, v11
  ds_write_b128 v55, v[188:191]
  ds_write_b128 v55, v[192:195] offset:1024
  s_waitcnt lgkmcnt(0)
  s_waitcnt vmcnt(0)
  s_barrier
  s_lshl_b32 s41, s47, 2
  s_add_u32 s41, s41, s24
  s_cmp_lg_u32 s41, 1
  s_cbranch_scc1 noflag_76
  s_lshl_b32 s41, s26, 2
  v_mov_b32 v237, s41
  s_add_u32 s41, s92, 7
  v_mov_b32 v238, s41
  s_mov_b64 exec, 1
  buffer_store_dword v238, v237, s[8:11], s39 offen sc1
  s_mov_b64 exec, -1
noflag_76:
  s_cmp_lg_u32 s24, 2
  s_cbranch_scc1 noflag_77
  s_lshl_b32 s41, s26, 2
  v_mov_b32 v237, s41
  s_add_u32 s41, s92, 7
  v_mov_b32 v238, s41
  s_mov_b64 exec, 1
  buffer_store_dword v238, v237, s[8:11], s38 offen
  s_mov_b64 exec, -1
noflag_77:
  s_add_u32 m0, s30, 32768
  s_add_u32 s45, s33, 122880
  buffer_load_dwordx4 v11, s[8:11], s45 offen lds
  buffer_load_dwordx4 v11, s[8:11], s45 offen offset:1024 lds
  s_add_u32 m0, s30, 40960
  s_add_u32 s45, s33, 131072
  buffer_load_dwordx4 v11, s[8:11], s45 offen lds
  buffer_load_dwordx4 v11, s[8:11], s45 offen offset:1024 lds
  ds_read_b128 v[152:155], v6
  ds_read_b128 v[156:159], v6 offset:1024
  ds_read_b128 v[128:131], v6 offset:2048
  ds_read_b128 v[132:135], v6 offset:3072
  ds_read_b128 v[136:139], v6 offset:4096
  ds_read_b128 v[140:143], v6 offset:5120
  ds_read_b128 v[144:147], v6 offset:6144
  ds_read_b128 v[148:151], v6 offset:7168
  v_add_u32 v55, 147456, v11
  ds_write_b128 v55, v[196:199]
  ds_write_b128 v55, v[240:243] offset:1024
  v_add_u32 v55, 155648, v11
  ds_write_b128 v55, v[244:247]
  ds_write_b128 v55, v[248:251] offset:1024
  v_lshlrev_b32 v160, 16, v224
  v_and_b32 v164, 0xffff0000, v224
  v_lshlrev_b32 v161, 16, v225
  v_and_b32 v165, 0xffff0000, v225
  v_lshlrev_b32 v162, 16, v226
  v_and_b32 v166, 0xffff0000, v226
  v_lshlrev_b32 v163, 16, v227
  v_and_b32 v167, 0xffff0000, v227
  v_lshlrev_b32 v168, 16, v228
  v_and_b32 v172, 0xffff0000, v228
  v_lshlrev_b32 v169, 16, v229
  v_and_b32 v173, 0xffff0000, v229
  v_lshlrev_b32 v170, 16, v230
  v_and_b32 v174, 0xffff0000, v230
  v_lshlrev_b32 v171, 16, v231
  v_and_b32 v175, 0xffff0000, v231
  v_lshlrev_b32 v176, 16, v232
  v_and_b32 v177, 0xffff0000, v232
  v_lshlrev_b32 v178, 16, v233
  v_and_b32 v179, 0xffff0000, v233
  v_lshlrev_b32 v84, 16, v104
  v_and_b32 v88, 0xffff0000, v104
  v_lshlrev_b32 v85, 16, v105
  v_and_b32 v89, 0xffff0000, v105
  v_lshlrev_b32 v86, 16, v106
  v_and_b32 v90, 0xffff0000, v106
  v_lshlrev_b32 v87, 16, v107
  v_and_b32 v91, 0xffff0000, v107
  v_lshlrev_b32 v92, 16, v108
  v_and_b32 v96, 0xffff0000, v108
  v_lshlrev_b32 v93, 16, v109
  v_and_b32 v97, 0xffff0000, v109
  v_lshlrev_b32 v94, 16, v110
  v_and_b32 v98, 0xffff0000, v110
  v_lshlrev_b32 v95, 16, v111
  v_and_b32 v99, 0xffff0000, v111
  v_lshlrev_b32 v100, 16, v112
  v_and_b32 v101, 0xffff0000, v112
  v_lshlrev_b32 v102, 16, v113
  v_and_b32 v103, 0xffff0000, v113
  v_pk_add_f32 v[160:161], v[160:161], v[84:85]
  v_pk_add_f32 v[162:163], v[162:163], v[86:87]
  v_pk_add_f32 v[164:165], v[164:165], v[88:89]
  v_pk_add_f32 v[166:167], v[166:167], v[90:91]
  v_pk_add_f32 v[168:169], v[168:169], v[92:93]
  v_pk_add_f32 v[170:171], v[170:171], v[94:95]
  v_pk_add_f32 v[172:173], v[172:173], v[96:97]
  v_pk_add_f32 v[174:175], v[174:175], v[98:99]
  v_pk_add_f32 v[176:177], v[176:177], v[100:101]
  v_pk_add_f32 v[178:179], v[178:179], v[102:103]
  s_cmp_lg_u32 s24, 0
  s_cbranch_scc1 nopoll_78
  s_mov_b32 s50, 0
  s_mov_b64 s[94:95], 0
  s_add_u32 s42, s92, 7
  s_cmp_eq_u32 s47, 0
  s_cselect_b32 s43, 3, -1
poll_79:
  buffer_load_dword v238, v36, s[8:11], s38 offen sc1
  s_add_u32 s50, s50, 1
  s_waitcnt vmcnt(0)
  v_subrev_u32 v238, s42, v238
  v_cmp_ge_u32 vcc, 1, v238
  s_or_b64 s[94:95], s[94:95], vcc
  s_cmp_eq_u64 s[94:95], -1
  s_cbranch_scc1 nopoll_78
  s_and_b32 s41, s50, s43
  s_cbranch_scc1 pollnext_80
  buffer_load_dword v238, v36, s[8:11], s39 offen sc1
  s_waitcnt vmcnt(0)
  v_subrev_u32 v238, s42, v238
  v_cmp_ge_u32 vcc, 1, v238
  s_or_b64 s[94:95], s[94:95], vcc
  s_cmp_eq_u64 s[94:95], -1
  s_cbranch_scc1 nopoll_78
pollnext_80:
  s_cmp_lt_u32 s50, 0x80000
  s_cbranch_scc1 poll_79
nopoll_78:
  s_barrier
  s_add_u32 s46, s35, 8388608
  buffer_load_dwordx4 a[0:3], v12, s[8:11], s46 offen sc1
  buffer_load_dwordx4 a[4:7], v13, s[8:11], s46 offen sc1
  buffer_load_dwordx4 a[8:11], v12, s[8:11], s46 offen offset:1024 sc1
  buffer_load_dwordx4 a[12:15], v13, s[8:11], s46 offen offset:1024 sc1
  buffer_load_dwordx4 a[16:19], v12, s[8:11], s46 offen offset:2048 sc1
  buffer_load_dwordx4 a[20:23], v13, s[8:11], s46 offen offset:2048 sc1
  buffer_load_dwordx4 a[24:27], v12, s[8:11], s46 offen offset:3072 sc1
  buffer_load_dwordx4 a[28:31], v13, s[8:11], s46 offen offset:3072 sc1
  s_add_u32 s41, s37, 11010048
  buffer_load_dwordx2 v[200:201], v18, s[8:11], s41 offen sc1
  buffer_load_dwordx2 v[202:203], v18, s[8:11], s41 offen offset:1024 sc1
  buffer_load_dwordx2 v[204:205], v18, s[8:11], s41 offen offset:128 sc1
  buffer_load_dwordx2 v[206:207], v18, s[8:11], s41 offen offset:1152 sc1
  s_waitcnt vmcnt(10) lgkmcnt(10)
  v_mfma_f32_16x16x32_bf16 v[64:67], v[152:155], a[0:3], 0
  s_add_u32 s46, s35, 8392704
  buffer_load_dwordx4 a[32:35], v12, s[8:11], s46 offen sc1
  v_mfma_f32_16x16x32_bf16 v[68:71], v[152:155], a[4:7], 0
  ds_read_b128 v[152:155], v6 offset:8192
  buffer_load_dwordx4 a[36:39], v13, s[8:11], s46 offen sc1
  v_mfma_f32_16x16x32_bf16 v[72:75], v[156:159], a[0:3], 0
  buffer_load_dwordx4 a[40:43], v12, s[8:11], s46 offen offset:1024 sc1
  buffer_load_dwordx4 a[44:47], v13, s[8:11], s46 offen offset:1024 sc1
  v_mfma_f32_16x16x32_bf16 v[76:79], v[156:159], a[4:7], 0
  ds_read_b128 v[156:159], v6 offset:9216
  s_waitcnt lgkmcnt(10)
  v_mfma_f32_16x16x32_bf16 v[80:83], v[128:131], a[0:3], 0
  buffer_load_dwordx4 a[48:51], v12, s[8:11], s46 offen offset:2048 sc1
  buffer_load_dwordx4 a[52:55], v13, s[8:11], s46 offen offset:2048 sc1
  v_mfma_f32_16x16x32_bf16 v[84:87], v[128:131], a[4:7], 0
  ds_read_b128 v[128:131], v6 offset:10240
  buffer_load_dwordx4 a[56:59], v12, s[8:11], s46 offen offset:3072 sc1
  v_mfma_f32_16x16x32_bf16 v[88:91], v[132:135], a[0:3], 0
  buffer_load_dwordx4 a[60:63], v13, s[8:11], s46 offen offset:3072 sc1
  s_add_u32 s46, s35, 8396800
  v_mfma_f32_16x16x32_bf16 v[92:95], v[132:135], a[4:7], 0
  ds_read_b128 v[132:135], v6 offset:11264
  s_waitcnt vmcnt(16) lgkmcnt(10)
  v_mfma_f32_16x16x32_bf16 v[64:67], v[136:139], a[8:11], v[64:67]
  buffer_load_dwordx4 a[64:67], v12, s[8:11], s46 offen sc1
  buffer_load_dwordx4 a[68:71], v13, s[8:11], s46 offen sc1
  v_mfma_f32_16x16x32_bf16 v[68:71], v[136:139], a[12:15], v[68:71]
  ds_read_b128 v[136:139], v6 offset:12288
  v_mfma_f32_16x16x32_bf16 v[72:75], v[140:143], a[8:11], v[72:75]
  buffer_load_dwordx4 a[72:75], v12, s[8:11], s46 offen offset:1024 sc1
  v_mfma_f32_16x16x32_bf16 v[76:79], v[140:143], a[12:15], v[76:79]
  ds_read_b128 v[140:143], v6 offset:13312
  s_waitcnt lgkmcnt(10)
  v_mfma_f32_16x16x32_bf16 v[80:83], v[144:147], a[8:11], v[80:83]
  buffer_load_dwordx4 a[76:79], v13, s[8:11], s46 offen offset:1024 sc1
  v_mfma_f32_16x16x32_bf16 v[84:87], v[144:147], a[12:15], v[84:87]
  ds_read_b128 v[144:147], v6 offset:14336
  v_mfma_f32_16x16x32_bf16 v[88:91], v[148:151], a[8:11], v[88:91]
  buffer_load_dwordx4 a[80:83], v12, s[8:11], s46 offen offset:2048 sc1
  v_mfma_f32_16x16x32_bf16 v[92:95], v[148:151], a[12:15], v[92:95]
  ds_read_b128 v[148:151], v6 offset:15360
  s_waitcnt vmcnt(19) lgkmcnt(6)
  v_mfma_f32_16x16x32_bf16 v[64:67], v[152:155], a[16:19], v[64:67]
  v_mfma_f32_16x16x32_bf16 v[68:71], v[152:155], a[20:23], v[68:71]
  ds_read_b128 v[152:155], v6 offset:16384
  v_mfma_f32_16x16x32_bf16 v[72:75], v[156:159], a[16:19], v[72:75]
  v_mfma_f32_16x16x32_bf16 v[76:79], v[156:159], a[20:23], v[76:79]
  ds_read_b128 v[156:159], v6 offset:17408
  s_waitcnt lgkmcnt(6)
  v_mfma_f32_16x16x32_bf16 v[80:83], v[128:131], a[16:19], v[80:83]
  buffer_load_dwordx4 a[84:87], v13, s[8:11], s46 offen offset:2048 sc1
  v_mfma_f32_16x16x32_bf16 v[84:87], v[128:131], a[20:23], v[84:87]
  ds_read_b128 v[128:131], v6 offset:18432
  v_mfma_f32_16x16x32_bf16 v[88:91], v[132:135], a[16:19], v[88:91]
  v_mfma_f32_16x16x32_bf16 v[92:95], v[132:135], a[20:23], v[92:95]
  ds_read_b128 v[132:135], v6 offset:19456
  s_waitcnt vmcnt(18) lgkmcnt(6)
  v_mfma_f32_16x16x32_bf16 v[64:67], v[136:139], a[24:27], v[64:67]
  buffer_load_dwordx4 a[88:91], v12, s[8:11], s46 offen offset:3072 sc1
  v_mfma_f32_16x16x32_bf16 v[68:71], v[136:139], a[28:31], v[68:71]
  ds_read_b128 v[136:139], v6 offset:20480
  v_mfma_f32_16x16x32_bf16 v[72:75], v[140:143], a[24:27], v[72:75]
  v_mfma_f32_16x16x32_bf16 v[76:79], v[140:143], a[28:31], v[76:79]
  ds_read_b128 v[140:143], v6 offset:21504
  s_waitcnt lgkmcnt(6)
  v_mfma_f32_16x16x32_bf16 v[80:83], v[144:147], a[24:27], v[80:83]
  buffer_load_dwordx4 a[92:95], v13, s[8:11], s46 offen offset:3072 sc1
  v_mfma_f32_16x16x32_bf16 v[84:87], v[144:147], a[28:31], v[84:87]
  ds_read_b128 v[144:147], v6 offset:22528
  v_mfma_f32_16x16x32_bf16 v[88:91], v[148:151], a[24:27], v[88:91]
  v_mfma_f32_16x16x32_bf16 v[92:95], v[148:151], a[28:31], v[92:95]
  ds_read_b128 v[148:151], v6 offset:23552
  s_waitcnt vmcnt(14) lgkmcnt(6)
  v_mfma_f32_16x16x32_bf16 v[64:67], v[152:155], a[32:35], v[64:67]
  s_barrier
  v_mfma_f32_16x16x32_bf16 v[68:71], v[152:155], a[36:39], v[68:71]
  ds_read_b128 v[152:155], v6 offset:24576
  s_add_u32 s46, s35, 8400896
  v_mfma_f32_16x16x32_bf16 v[72:75], v[156:159], a[32:35], v[72:75]
  buffer_load_dwordx4 a[96:99], v12, s[8:11], s46 offen sc1
  v_mfma_f32_16x16x32_bf16 v[76:79], v[156:159], a[36:39], v[76:79]
  ds_read_b128 v[156:159], v6 offset:25600
  s_waitcnt lgkmcnt(6)
  v_mfma_f32_16x16x32_bf16 v[80:83], v[128:131], a[32:35], v[80:83]
  buffer_load_dwordx4 a[100:103], v13, s[8:11], s46 offen sc1
  v_mfma_f32_16x16x32_bf16 v[84:87], v[128:131], a[36:39], v[84:87]
  ds_read_b128 v[128:131], v6 offset:26624
  v_mfma_f32_16x16x32_bf16 v[88:91], v[132:135], a[32:35], v[88:91]
  v_mfma_f32_16x16x32_bf16 v[92:95], v[132:135], a[36:39], v[92:95]
  ds_read_b128 v[132:135], v6 offset:27648
  s_waitcnt vmcnt(14) lgkmcnt(6)
  v_mfma_f32_16x16x32_bf16 v[64:67], v[136:139], a[40:43], v[64:67]
  v_mfma_f32_16x16x32_bf16 v[68:71], v[136:139], a[44:47], v[68:71]
  ds_read_b128 v[136:139], v6 offset:28672
  buffer_load_dwordx4 a[104:107], v12, s[8:11], s46 offen offset:1024 sc1
  v_mfma_f32_16x16x32_bf16 v[72:75], v[140:143], a[40:43], v[72:75]
  v_mfma_f32_16x16x32_bf16 v[76:79], v[140:143], a[44:47], v[76:79]
  ds_read_b128 v[140:143], v6 offset:29696
  s_waitcnt lgkmcnt(6)
  v_mfma_f32_16x16x32_bf16 v[80:83], v[144:147], a[40:43], v[80:83]
  buffer_load_dwordx4 a[108:111], v13, s[8:11], s46 offen offset:1024 sc1
  v_mfma_f32_16x16x32_bf16 v[84:87], v[144:147], a[44:47], v[84:87]
  ds_read_b128 v[144:147], v6 offset:30720
  v_add_f32 v200, v200, v202
  v_mfma_f32_16x16x32_bf16 v[88:91], v[148:151], a[40:43], v[88:91]
  v_add_f32 v201, v201, v203
  v_mov_b32 v202, v200
  v_mfma_f32_16x16x32_bf16 v[92:95], v[148:151], a[44:47], v[92:95]
  ds_read_b128 v[148:151], v6 offset:31744
  s_waitcnt vmcnt(14) lgkmcnt(6)
  v_mfma_f32_16x16x32_bf16 v[64:67], v[152:155], a[48:51], v[64:67]
  v_mov_b32 v203, v201
  v_permlane32_swap_b32 v200, v202
  v_mfma_f32_16x16x32_bf16 v[68:71], v[152:155], a[52:55], v[68:71]
  ds_read_b128 v[152:155], v6 offset:32768
  buffer_load_dwordx4 a[112:115], v12, s[8:11], s46 offen offset:2048 sc1
  v_mfma_f32_16x16x32_bf16 v[72:75], v[156:159], a[48:51], v[72:75]
  v_permlane32_swap_b32 v201, v203
  v_add_f32 v200, v200, v202
  v_mfma_f32_16x16x32_bf16 v[76:79], v[156:159], a[52:55], v[76:79]
  ds_read_b128 v[156:159], v6 offset:33792
  s_waitcnt lgkmcnt(6)
  v_mfma_f32_16x16x32_bf16 v[80:83], v[128:131], a[48:51], v[80:83]
  buffer_load_dwordx4 a[116:119], v13, s[8:11], s46 offen offset:2048 sc1
  v_add_f32 v201, v201, v203
  v_mfma_f32_16x16x32_bf16 v[84:87], v[128:131], a[52:55], v[84:87]
  ds_read_b128 v[128:131], v6 offset:34816
  v_mov_b32 v202, v200
  v_mfma_f32_16x16x32_bf16 v[88:91], v[132:135], a[48:51], v[88:91]
  v_mov_b32 v203, v201
  v_permlane16_swap_b32 v200, v202
  v_mfma_f32_16x16x32_bf16 v[92:95], v[132:135], a[52:55], v[92:95]
  ds_read_b128 v[132:135], v6 offset:35840
  s_waitcnt vmcnt(14) lgkmcnt(6)
  v_mfma_f32_16x16x32_bf16 v[64:67], v[136:139], a[56:59], v[64:67]
  v_permlane16_swap_b32 v201, v203
  v_add_f32 v200, v200, v202
  v_mfma_f32_16x16x32_bf16 v[68:71], v[136:139], a[60:63], v[68:71]
  ds_read_b128 v[136:139], v6 offset:36864
  buffer_load_dwordx4 a[120:123], v12, s[8:11], s46 offen offset:3072 sc1
  v_mfma_f32_16x16x32_bf16 v[72:75], v[140:143], a[56:59], v[72:75]
  v_add_f32 v201, v201, v203
  v_mul_f32 v200, 0x3acccccd, v200
  v_mfma_f32_16x16x32_bf16 v[76:79], v[140:143], a[60:63], v[76:79]
  ds_read_b128 v[140:143], v6 offset:37888
  s_waitcnt lgkmcnt(6)
  v_mfma_f32_16x16x32_bf16 v[80:83], v[144:147], a[56:59], v[80:83]
  buffer_load_dwordx4 a[124:127], v13, s[8:11], s46 offen offset:3072 sc1
  v_mul_f32 v202, v200, v200
  v_mfma_f32_16x16x32_bf16 v[84:87], v[144:147], a[60:63], v[84:87]
  ds_read_b128 v[144:147], v6 offset:38912
  v_fma_f32 v201, v201, s63, -v202
  v_mfma_f32_16x16x32_bf16 v[88:91], v[148:151], a[56:59], v[88:91]
  v_max_f32 v201, 0, v201
  v_add_f32 v201, 0x3727c5ac, v201
  v_mfma_f32_16x16x32_bf16 v[92:95], v[148:151], a[60:63], v[92:95]
  ds_read_b128 v[148:151], v6 offset:39936
  s_waitcnt vmcnt(14) lgkmcnt(6)
  v_mfma_f32_16x16x32_bf16 v[64:67], v[152:155], a[64:67], v[64:67]
  v_rsq_f32 v202, v201
  v_cvt_pk_bf16_f32 v40, v200, v200
  v_mfma_f32_16x16x32_bf16 v[68:71], v[152:155], a[68:71], v[68:71]
  ds_read_b128 v[152:155], v6 offset:40960
  s_add_u32 s46, s35, 8404992
  v_mfma_f32_16x16x32_bf16 v[72:75], v[156:159], a[64:67], v[72:75]
  buffer_load_dwordx4 a[128:131], v12, s[8:11], s46 offen sc1
  v_mul_f32 v201, v201, v202
  v_mfma_f32_16x16x32_bf16 v[76:79], v[156:159], a[68:71], v[76:79]
  ds_read_b128 v[156:159], v6 offset:41984
  s_waitcnt lgkmcnt(6)
  v_mfma_f32_16x16x32_bf16 v[80:83], v[128:131], a[64:67], v[80:83]
  buffer_load_dwordx4 a[132:135], v13, s[8:11], s46 offen sc1
  ds_write_b32 v26, v202
  v_mfma_f32_16x16x32_bf16 v[84:87], v[128:131], a[68:71], v[84:87]
  ds_read_b128 v[128:131], v6 offset:43008
  v_mul_f32 v48, 0x3fb8aa3b, v202
  v_mfma_f32_16x16x32_bf16 v[88:91], v[132:135], a[64:67], v[88:91]
  v_lshlrev_b32 v203, 16, v40
  v_sub_f32 v200, v200, v203
  v_mfma_f32_16x16x32_bf16 v[92:95], v[132:135], a[68:71], v[92:95]
  ds_read_b128 v[132:135], v6 offset:44032
  s_waitcnt vmcnt(14) lgkmcnt(7)
  v_mfma_f32_16x16x32_bf16 v[64:67], v[136:139], a[72:75], v[64:67]
  v_cvt_pk_bf16_f32 v41, v200, v201
  v_and_b32 v203, 0xffff0000, v41
  v_mfma_f32_16x16x32_bf16 v[68:71], v[136:139], a[76:79], v[68:71]
  ds_read_b128 v[136:139], v6 offset:45056
  buffer_load_dwordx4 a[136:139], v12, s[8:11], s46 offen offset:1024 sc1
  v_mfma_f32_16x16x32_bf16 v[72:75], v[140:143], a[72:75], v[72:75]
  v_sub_f32 v203, v201, v203
  v_cvt_pk_bf16_f32 v43, v200, v203
  v_mfma_f32_16x16x32_bf16 v[76:79], v[140:143], a[76:79], v[76:79]
  ds_read_b128 v[140:143], v6 offset:46080
  s_waitcnt lgkmcnt(7)
  v_mfma_f32_16x16x32_bf16 v[80:83], v[144:147], a[72:75], v[80:83]
  buffer_load_dwordx4 a[140:143], v13, s[8:11], s46 offen offset:1024 sc1
  v_mov_b32 v42, v40
  v_mfma_f32_16x16x32_bf16 v[84:87], v[144:147], a[76:79], v[84:87]
  ds_read_b128 v[144:147], v6 offset:47104
  v_add_f32 v204, v204, v206
  v_mfma_f32_16x16x32_bf16 v[88:91], v[148:151], a[72:75], v[88:91]
  v_add_f32 v205, v205, v207
  v_mov_b32 v206, v204
  v_mfma_f32_16x16x32_bf16 v[92:95], v[148:151], a[76:79], v[92:95]
  ds_read_b128 v[148:151], v6 offset:48128
  s_waitcnt vmcnt(14) lgkmcnt(7)
  v_mfma_f32_16x16x32_bf16 v[64:67], v[152:155], a[80:83], v[64:67]
  s_barrier
  v_mfma_f32_16x16x32_bf16 v[68:71], v[152:155], a[84:87], v[68:71]
  ds_read_b128 v[152:155], v6 offset:49152
  buffer_load_dwordx4 a[144:147], v12, s[8:11], s46 offen offset:2048 sc1
  v_mfma_f32_16x16x32_bf16 v[72:75], v[156:159], a[80:83], v[72:75]
  v_mov_b32 v207, v205
  v_permlane32_swap_b32 v204, v206
  v_mfma_f32_16x16x32_bf16 v[76:79], v[156:159], a[84:87], v[76:79]
  ds_read_b128 v[156:159], v6 offset:50176
  s_waitcnt lgkmcnt(6)
  v_mfma_f32_16x16x32_bf16 v[80:83], v[128:131], a[80:83], v[80:83]
  buffer_load_dwordx4 a[148:151], v13, s[8:11], s46 offen offset:2048 sc1
  v_permlane32_swap_b32 v205, v207
  v_mfma_f32_16x16x32_bf16 v[84:87], v[128:131], a[84:87], v[84:87]
  ds_read_b128 v[128:131], v6 offset:51200
  v_add_f32 v204, v204, v206
  v_mfma_f32_16x16x32_bf16 v[88:91], v[132:135], a[80:83], v[88:91]
  v_add_f32 v205, v205, v207
  v_mov_b32 v206, v204
  v_mfma_f32_16x16x32_bf16 v[92:95], v[132:135], a[84:87], v[92:95]
  ds_read_b128 v[132:135], v6 offset:52224
  s_waitcnt vmcnt(14) lgkmcnt(6)
  v_mfma_f32_16x16x32_bf16 v[64:67], v[136:139], a[88:91], v[64:67]
  v_mov_b32 v207, v205
  v_permlane16_swap_b32 v204, v206
  v_mfma_f32_16x16x32_bf16 v[68:71], v[136:139], a[92:95], v[68:71]
  ds_read_b128 v[136:139], v6 offset:53248
  buffer_load_dwordx4 a[152:155], v12, s[8:11], s46 offen offset:3072 sc1
  v_mfma_f32_16x16x32_bf16 v[72:75], v[140:143], a[88:91], v[72:75]
  v_permlane16_swap_b32 v205, v207
  v_add_f32 v204, v204, v206
  v_mfma_f32_16x16x32_bf16 v[76:79], v[140:143], a[92:95], v[76:79]
  ds_read_b128 v[140:143], v6 offset:54272
  s_waitcnt lgkmcnt(6)
  v_mfma_f32_16x16x32_bf16 v[80:83], v[144:147], a[88:91], v[80:83]
  buffer_load_dwordx4 a[156:159], v13, s[8:11], s46 offen offset:3072 sc1
  v_add_f32 v205, v205, v207
  v_mfma_f32_16x16x32_bf16 v[84:87], v[144:147], a[92:95], v[84:87]
  ds_read_b128 v[144:147], v6 offset:55296
  v_mul_f32 v204, 0x3acccccd, v204
  v_mfma_f32_16x16x32_bf16 v[88:91], v[148:151], a[88:91], v[88:91]
  v_mul_f32 v206, v204, v204
  v_fma_f32 v205, v205, s63, -v206
  v_mfma_f32_16x16x32_bf16 v[92:95], v[148:151], a[92:95], v[92:95]
  ds_read_b128 v[148:151], v6 offset:56320
  s_waitcnt vmcnt(14) lgkmcnt(6)
  v_mfma_f32_16x16x32_bf16 v[64:67], v[152:155], a[96:99], v[64:67]
  v_max_f32 v205, 0, v205
  v_add_f32 v205, 0x3727c5ac, v205
  v_mfma_f32_16x16x32_bf16 v[68:71], v[152:155], a[100:103], v[68:71]
  ds_read_b128 v[152:155], v6 offset:57344
  s_add_u32 m0, s30, 49152
  v_mfma_f32_16x16x32_bf16 v[72:75], v[156:159], a[96:99], v[72:75]
  s_add_u32 s45, s33, 139264
  buffer_load_dwordx4 v11, s[8:11], s45 offen lds
  v_mfma_f32_16x16x32_bf16 v[76:79], v[156:159], a[100:103], v[76:79]
  ds_read_b128 v[156:159], v6 offset:58368
  s_waitcnt lgkmcnt(6)
  v_mfma_f32_16x16x32_bf16 v[80:83], v[128:131], a[96:99], v[80:83]
  v_rsq_f32 v206, v205
  v_cvt_pk_bf16_f32 v44, v204, v204
  v_mfma_f32_16x16x32_bf16 v[84:87], v[128:131], a[100:103], v[84:87]
  ds_read_b128 v[128:131], v6 offset:59392
  v_mul_f32 v205, v205, v206
  v_mfma_f32_16x16x32_bf16 v[88:91], v[132:135], a[96:99], v[88:91]
  buffer_load_dwordx4 v11, s[8:11], s45 offen offset:1024 lds
  ds_write_b32 v26, v206 offset:64
  v_mfma_f32_16x16x32_bf16 v[92:95], v[132:135], a[100:103], v[92:95]
  ds_read_b128 v[132:135], v6 offset:60416
  s_waitcnt vmcnt(14) lgkmcnt(7)
  v_mfma_f32_16x16x32_bf16 v[64:67], v[136:139], a[104:107], v[64:67]
  v_mul_f32 v50, 0x3fb8aa3b, v206
  v_lshlrev_b32 v207, 16, v44
  v_mfma_f32_16x16x32_bf16 v[68:71], v[136:139], a[108:111], v[68:71]
  ds_read_b128 v[136:139], v6 offset:61440
  v_sub_f32 v204, v204, v207
  v_mfma_f32_16x16x32_bf16 v[72:75], v[140:143], a[104:107], v[72:75]
  v_cvt_pk_bf16_f32 v45, v204, v205
  s_add_u32 m0, s30, 57344
  v_mfma_f32_16x16x32_bf16 v[76:79], v[140:143], a[108:111], v[76:79]
  ds_read_b128 v[140:143], v6 offset:62464
  s_waitcnt lgkmcnt(7)
  v_mfma_f32_16x16x32_bf16 v[80:83], v[144:147], a[104:107], v[80:83]
  s_add_u32 s45, s33, 147456
  s_cmp_ge_u32 s24, 2
  s_cbranch_scc1 nopad_81
  buffer_load_dwordx4 v11, s[8:11], s45 offen lds
nopad_81:
  v_mfma_f32_16x16x32_bf16 v[84:87], v[144:147], a[108:111], v[84:87]
  ds_read_b128 v[144:147], v6 offset:63488
here_82:
  v_add_u32 v51, here_82-interleave_layers__linear_attn_block__dense_activation_squared_relu__prompt_kernel+1024, v38
  v_min_u32 v51, 57340, v51
  global_load_dword v49, v51, s[96:97]
  v_mfma_f32_16x16x32_bf16 v[88:91], v[148:151], a[104:107], v[88:91]
  v_and_b32 v207, 0xffff0000, v45
  s_cmp_ge_u32 s24, 1
  s_cbranch_scc1 nopad_83
  buffer_load_dwordx4 v11, s[8:11], s45 offen offset:1024 lds
nopad_83:
  v_mfma_f32_16x16x32_bf16 v[92:95], v[148:151], a[108:111], v[92:95]
  ds_read_b128 v[148:151], v6 offset:64512
  s_waitcnt vmcnt(13) lgkmcnt(7)
  v_mfma_f32_16x16x32_bf16 v[64:67], v[152:155], a[112:115], v[64:67]
  s_add_u32 m0, s30, 65536
  s_add_u32 s45, s34, 0
  v_mfma_f32_16x16x32_bf16 v[68:71], v[152:155], a[116:119], v[68:71]
  ds_read_b128 v[152:155], v7
  buffer_load_dwordx4 v11, s[8:11], s45 offen lds
  v_mfma_f32_16x16x32_bf16 v[72:75], v[156:159], a[112:115], v[72:75]
  v_sub_f32 v207, v205, v207
  v_cvt_pk_bf16_f32 v47, v204, v207
  v_mfma_f32_16x16x32_bf16 v[76:79], v[156:159], a[116:119], v[76:79]
  ds_read_b128 v[156:159], v7 offset:1024
  s_waitcnt lgkmcnt(6)
  v_mfma_f32_16x16x32_bf16 v[80:83], v[128:131], a[112:115], v[80:83]
  buffer_load_dwordx4 v11, s[8:11], s45 offen offset:1024 lds
  v_mov_b32 v46, v44
  v_mfma_f32_16x16x32_bf16 v[84:87], v[128:131], a[116:119], v[84:87]
  ds_read_b128 v[128:131], v7 offset:2048
  v_mfma_f32_16x16x32_bf16 v[88:91], v[132:135], a[112:115], v[88:91]
  v_mfma_f32_16x16x32_bf16 v[92:95], v[132:135], a[116:119], v[92:95]
  ds_read_b128 v[132:135], v7 offset:3072
  s_waitcnt vmcnt(13) lgkmcnt(6)
  v_mfma_f32_16x16x32_bf16 v[64:67], v[136:139], a[120:123], v[64:67]
  s_add_u32 m0, s30, 73728
  s_add_u32 s45, s34, 8192
  v_mfma_f32_16x16x32_bf16 v[68:71], v[136:139], a[124:127], v[68:71]
  ds_read_b128 v[136:139], v7 offset:4096
  buffer_load_dwordx4 v11, s[8:11], s45 offen lds
  v_mfma_f32_16x16x32_bf16 v[72:75], v[140:143], a[120:123], v[72:75]
  v_mfma_f32_16x16x32_bf16 v[76:79], v[140:143], a[124:127], v[76:79]
  ds_read_b128 v[140:143], v7 offset:5120
  s_waitcnt lgkmcnt(6)
  v_mfma_f32_16x16x32_bf16 v[80:83], v[144:147], a[120:123], v[80:83]
  v_mfma_f32_16x16x32_bf16 v[84:87], v[144:147], a[124:127], v[84:87]
  ds_read_b128 v[144:147], v7 offset:6144
  buffer_load_dwordx4 v11, s[8:11], s45 offen offset:1024 lds
  v_mfma_f32_16x16x32_bf16 v[88:91], v[148:151], a[120:123], v[88:91]
  v_mfma_f32_16x16x32_bf16 v[92:95], v[148:151], a[124:127], v[92:95]
  ds_read_b128 v[148:151], v7 offset:7168
  s_waitcnt vmcnt(13) lgkmcnt(6)
  v_mfma_f32_16x16x32_bf16 v[64:67], v[152:155], a[128:131], v[64:67]
  s_barrier
  v_mfma_f32_16x16x32_bf16 v[68:71], v[152:155], a[132:135], v[68:71]
  ds_read_b128 v[152:155], v7 offset:8192
  s_add_u32 m0, s30, 81920
  v_mfma_f32_16x16x32_bf16 v[72:75], v[156:159], a[128:131], v[72:75]
  s_add_u32 s45, s34, 16384
  buffer_load_dwordx4 v11, s[8:11], s45 offen lds
  v_mfma_f32_16x16x32_bf16 v[76:79], v[156:159], a[132:135], v[76:79]
  ds_read_b128 v[156:159], v7 offset:9216
  s_waitcnt lgkmcnt(6)
  v_mfma_f32_16x16x32_bf16 v[80:83], v[128:131], a[128:131], v[80:83]
  v_mfma_f32_16x16x32_bf16 v[84:87], v[128:131], a[132:135], v[84:87]
  ds_read_b128 v[128:131], v7 offset:10240
  buffer_load_dwordx4 v11, s[8:11], s45 offen offset:1024 lds
  v_mfma_f32_16x16x32_bf16 v[88:91], v[132:135], a[128:131], v[88:91]
  v_mfma_f32_16x16x32_bf16 v[92:95], v[132:135], a[132:135], v[92:95]
  ds_read_b128 v[132:135], v7 offset:11264
  s_waitcnt vmcnt(13) lgkmcnt(6)
  v_mfma_f32_16x16x32_bf16 v[64:67], v[136:139], a[136:139], v[64:67]
  v_mfma_f32_16x16x32_bf16 v[68:71], v[136:139], a[140:143], v[68:71]
  ds_read_b128 v[136:139], v7 offset:12288
  v_mfma_f32_16x16x32_bf16 v[72:75], v[140:143], a[136:139], v[72:75]
  s_add_u32 m0, s30, 90112
  s_add_u32 s45, s34, 24576
  v_mfma_f32_16x16x32_bf16 v[76:79], v[140:143], a[140:143], v[76:79]
  ds_read_b128 v[140:143], v7 offset:13312
  s_waitcnt lgkmcnt(6)
  v_mfma_f32_16x16x32_bf16 v[80:83], v[144:147], a[136:139], v[80:83]
  buffer_load_dwordx4 v11, s[8:11], s45 offen lds
  v_mfma_f32_16x16x32_bf16 v[84:87], v[144:147], a[140:143], v[84:87]
  ds_read_b128 v[144:147], v7 offset:14336
  v_mfma_f32_16x16x32_bf16 v[88:91], v[148:151], a[136:139], v[88:91]
  v_mfma_f32_16x16x32_bf16 v[92:95], v[148:151], a[140:143], v[92:95]
  ds_read_b128 v[148:151], v7 offset:15360
  s_waitcnt vmcnt(12) lgkmcnt(6)
  v_mfma_f32_16x16x32_bf16 v[64:67], v[152:155], a[144:147], v[64:67]
  buffer_load_dwordx4 v11, s[8:11], s45 offen offset:1024 lds
  v_mfma_f32_16x16x32_bf16 v[68:71], v[152:155], a[148:151], v[68:71]
  ds_read_b128 v[152:155], v7 offset:16384
  v_mfma_f32_16x16x32_bf16 v[72:75], v[156:159], a[144:147], v[72:75]
  v_mfma_f32_16x16x32_bf16 v[76:79], v[156:159], a[148:151], v[76:79]
  ds_read_b128 v[156:159], v7 offset:17408
  s_waitcnt lgkmcnt(6)
  v_mfma_f32_16x16x32_bf16 v[80:83], v[128:131], a[144:147], v[80:83]
  s_add_u32 m0, s30, 98304
  s_add_u32 s45, s34, 32768
  v_mfma_f32_16x16x32_bf16 v[84:87], v[128:131], a[148:151], v[84:87]
  ds_read_b128 v[128:131], v7 offset:18432
  buffer_load_dwordx4 v11, s[8:11], s45 offen lds
  v_mfma_f32_16x16x32_bf16 v[88:91], v[132:135], a[144:147], v[88:91]
  v_mfma_f32_16x16x32_bf16 v[92:95], v[132:135], a[148:151], v[92:95]
  ds_read_b128 v[132:135], v7 offset:19456
  s_waitcnt vmcnt(12) lgkmcnt(6)
  v_mfma_f32_16x16x32_bf16 v[64:67], v[136:139], a[152:155], v[64:67]
  buffer_load_dwordx4 v11, s[8:11], s45 offen offset:1024 lds
  v_mfma_f32_16x16x32_bf16 v[68:71], v[136:139], a[156:159], v[68:71]
  ds_read_b128 v[136:139], v7 offset:20480
  v_mfma_f32_16x16x32_bf16 v[72:75], v[140:143], a[152:155], v[72:75]
  v_mfma_f32_16x16x32_bf16 v[76:79], v[140:143], a[156:159], v[76:79]
  ds_read_b128 v[140:143], v7 offset:21504
  s_waitcnt lgkmcnt(6)
  v_mfma_f32_16x16x32_bf16 v[80:83], v[144:147], a[152:155], v[80:83]
  v_mfma_f32_16x16x32_bf16 v[84:87], v[144:147], a[156:159], v[84:87]
  ds_read_b128 v[144:147], v7 offset:22528
  s_add_u32 m0, s30, 106496
  v_mfma_f32_16x16x32_bf16 v[88:91], v[148:151], a[152:155], v[88:91]
  s_add_u32 s45, s34, 40960
  buffer_load_dwordx4 v11, s[8:11], s45 offen lds
  v_mfma_f32_16x16x32_bf16 v[92:95], v[148:151], a[156:159], v[92:95]
  ds_read_b128 v[148:151], v7 offset:23552
  s_waitcnt lgkmcnt(6)
  v_mfma_f32_16x16x32_bf16 v[64:67], v[152:155], v[40:43], v[64:67]
  v_mfma_f32_16x16x32_bf16 v[68:71], v[152:155], v[44:47], v[68:71]
  ds_read_b128 v[152:155], v7 offset:24576
  v_mfma_f32_16x16x32_bf16 v[72:75], v[156:159], v[40:43], v[72:75]
  buffer_load_dwordx4 v11, s[8:11], s45 offen offset:1024 lds
  v_mfma_f32_16x16x32_bf16 v[76:79], v[156:159], v[44:47], v[76:79]
  ds_read_b128 v[156:159], v7 offset:25600
  s_waitcnt lgkmcnt(6)
  v_mfma_f32_16x16x32_bf16 v[80:83], v[128:131], v[40:43], v[80:83]
  v_mfma_f32_16x16x32_bf16 v[84:87], v[128:131], v[44:47], v[84:87]
  ds_read_b128 v[128:131], v7 offset:26624
  v_mfma_f32_16x16x32_bf16 v[88:91], v[132:135], v[40:43], v[88:91]
  v_mfma_f32_16x16x32_bf16 v[92:95], v[132:135], v[44:47], v[92:95]
  ds_read_b128 v[132:135], v7 offset:27648
  s_waitcnt lgkmcnt(6)
  v_mfma_f32_16x16x32_bf16 v[96:99], v[136:139], a[0:3], 0
  s_add_u32 s43, s59, 13762560
  v_mul_f32_e64 v64, v64, |v64|
  v_mfma_f32_16x16x32_bf16 v[100:103], v[136:139], a[4:7], 0
  ds_read_b128 v[136:139], v7 offset:28672
  v_mul_f32_e64 v72, v72, |v72|
  v_mfma_f32_16x16x32_bf16 v[104:107], v[140:143], a[0:3], 0
  v_cvt_pk_bf16_f32 v216, v64, v72
  v_pk_max_i16 v216, v216, 0
  v_mfma_f32_16x16x32_bf16 v[108:111], v[140:143], a[4:7], 0
  ds_read_b128 v[140:143], v7 offset:29696
  s_waitcnt lgkmcnt(6)
  v_mfma_f32_16x16x32_bf16 v[112:115], v[144:147], a[0:3], 0
  v_mul_f32_e64 v65, v65, |v65|
  v_mul_f32_e64 v73, v73, |v73|
  v_mfma_f32_16x16x32_bf16 v[116:119], v[144:147], a[4:7], 0
  ds_read_b128 v[144:147], v7 offset:30720
  v_cvt_pk_bf16_f32 v217, v65, v73
  v_mfma_f32_16x16x32_bf16 v[96:99], v[148:151], a[8:11], v[96:99]
  v_pk_max_i16 v217, v217, 0
  s_add_u32 m0, s30, 114688
  v_mfma_f32_16x16x32_bf16 v[100:103], v[148:151], a[12:15], v[100:103]
  ds_read_b128 v[148:151], v7 offset:31744
  s_waitcnt lgkmcnt(6)
  v_mfma_f32_16x16x32_bf16 v[104:107], v[152:155], a[8:11], v[104:107]
  s_add_u32 s45, s34, 49152
  buffer_load_dwordx4 v11, s[8:11], s45 offen lds
  buffer_load_dwordx4 v11, s[8:11], s45 offen offset:1024 lds
  s_barrier
  v_mfma_f32_16x16x32_bf16 v[108:111], v[152:155], a[12:15], v[108:111]
  ds_read_b128 v[152:155], v5 offset:8192
  v_mul_f32_e64 v66, v66, |v66|
  v_mfma_f32_16x16x32_bf16 v[112:115], v[156:159], a[8:11], v[112:115]
  v_mul_f32_e64 v74, v74, |v74|
  v_cvt_pk_bf16_f32 v218, v66, v74
  v_mfma_f32_16x16x32_bf16 v[116:119], v[156:159], a[12:15], v[116:119]
  ds_read_b128 v[156:159], v5 offset:9216
  s_waitcnt lgkmcnt(6)
  v_mfma_f32_16x16x32_bf16 v[96:99], v[128:131], a[16:19], v[96:99]
  v_pk_max_i16 v218, v218, 0
  v_mul_f32_e64 v67, v67, |v67|
  v_mfma_f32_16x16x32_bf16 v[100:103], v[128:131], a[20:23], v[100:103]
  ds_read_b128 v[128:131], v5 offset:10240
  s_add_u32 m0, s30, 122880
  v_mfma_f32_16x16x32_bf16 v[104:107], v[132:135], a[16:19], v[104:107]
  s_add_u32 s45, s34, 57344
  buffer_load_dwordx4 v11, s[8:11], s45 offen lds
  v_mfma_f32_16x16x32_bf16 v[108:111], v[132:135], a[20:23], v[108:111]
  ds_read_b128 v[132:135], v5 offset:11264
  s_waitcnt lgkmcnt(6)
  v_mfma_f32_16x16x32_bf16 v[112:115], v[136:139], a[16:19], v[112:115]
  v_mul_f32_e64 v75, v75, |v75|
  v_cvt_pk_bf16_f32 v219, v67, v75
  v_mfma_f32_16x16x32_bf16 v[116:119], v[136:139], a[20:23], v[116:119]
  ds_read_b128 v[136:139], v5 offset:12288
  v_pk_max_i16 v219, v219, 0
  v_mfma_f32_16x16x32_bf16 v[96:99], v[140:143], a[24:27], v[96:99]
  buffer_store_dwordx4 v[216:219], v34, s[8:11], s43 offen sc1
  v_mul_f32_e64 v80, v80, |v80|
  v_mfma_f32_16x16x32_bf16 v[100:103], v[140:143], a[28:31], v[100:103]
  ds_read_b128 v[140:143], v5 offset:13312
  s_waitcnt lgkmcnt(6)
  v_mfma_f32_16x16x32_bf16 v[104:107], v[144:147], a[24:27], v[104:107]
  v_mul_f32_e64 v88, v88, |v88|
  v_cvt_pk_bf16_f32 v220, v80, v88
  v_mfma_f32_16x16x32_bf16 v[108:111], v[144:147], a[28:31], v[108:111]
  ds_read_b128 v[144:147], v5 offset:14336
  v_pk_max_i16 v220, v220, 0
  v_mfma_f32_16x16x32_bf16 v[112:115], v[148:151], a[24:27], v[112:115]
  v_mul_f32_e64 v81, v81, |v81|
  v_mul_f32_e64 v89, v89, |v89|
  v_mfma_f32_16x16x32_bf16 v[116:119], v[148:151], a[28:31], v[116:119]
  ds_read_b128 v[148:151], v5 offset:15360
  s_waitcnt lgkmcnt(6)
  v_mfma_f32_16x16x32_bf16 v[96:99], v[152:155], a[32:35], v[96:99]
  buffer_load_dwordx4 v11, s[8:11], s45 offen offset:1024 lds
  v_cvt_pk_bf16_f32 v221, v81, v89
  v_mfma_f32_16x16x32_bf16 v[100:103], v[152:155], a[36:39], v[100:103]
  ds_read_b128 v[152:155], v5 offset:16384
  v_pk_max_i16 v221, v221, 0
  v_mfma_f32_16x16x32_bf16 v[104:107], v[156:159], a[32:35], v[104:107]
  v_mul_f32_e64 v82, v82, |v82|
  v_mul_f32_e64 v90, v90, |v90|
  v_mfma_f32_16x16x32_bf16 v[108:111], v[156:159], a[36:39], v[108:111]
  ds_read_b128 v[156:159], v5 offset:17408
  s_waitcnt lgkmcnt(6)
  v_mfma_f32_16x16x32_bf16 v[112:115], v[128:131], a[32:35], v[112:115]
  v_cvt_pk_bf16_f32 v222, v82, v90
  v_pk_max_i16 v222, v222, 0
  v_mfma_f32_16x16x32_bf16 v[116:119], v[128:131], a[36:39], v[116:119]
  ds_read_b128 v[128:131], v5 offset:18432
  s_add_u32 m0, s30, 131072
  v_mfma_f32_16x16x32_bf16 v[96:99], v[132:135], a[40:43], v[96:99]
  s_add_u32 s45, s34, 65536
  buffer_load_dwordx4 v11, s[8:11], s45 offen lds
  v_mfma_f32_16x16x32_bf16 v[100:103], v[132:135], a[44:47], v[100:103]
  ds_read_b128 v[132:135], v5 offset:19456
  s_waitcnt lgkmcnt(6)
  v_mfma_f32_16x16x32_bf16 v[104:107], v[136:139], a[40:43], v[104:107]
  v_mul_f32_e64 v83, v83, |v83|
  v_mul_f32_e64 v91, v91, |v91|
  v_mfma_f32_16x16x32_bf16 v[108:111], v[136:139], a[44:47], v[108:111]
  ds_read_b128 v[136:139], v5 offset:20480
  v_cvt_pk_bf16_f32 v223, v83, v91
  v_mfma_f32_16x16x32_bf16 v[112:115], v[140:143], a[40:43], v[112:115]
  v_pk_max_i16 v223, v223, 0
  buffer_store_dwordx4 v[220:223], v34, s[8:11], s43 offen offset:1024 sc1
  v_mfma_f32_16x16x32_bf16 v[116:119], v[140:143], a[44:47], v[116:119]
  ds_read_b128 v[140:143], v5 offset:21504
  s_waitcnt lgkmcnt(6)
  v_mfma_f32_16x16x32_bf16 v[96:99], v[144:147], a[48:51], v[96:99]
  s_add_u32 s44, s59, 13817856
  v_mul_f32_e64 v68, v68, |v68|
  v_mfma_f32_16x16x32_bf16 v[100:103], v[144:147], a[52:55], v[100:103]
  ds_read_b128 v[144:147], v5 offset:22528
  v_mul_f32_e64 v76, v76, |v76|
  v_mfma_f32_16x16x32_bf16 v[104:107], v[148:151], a[48:51], v[104:107]
  v_cvt_pk_bf16_f32 v224, v68, v76
  v_pk_max_i16 v224, v224, 0
  v_mfma_f32_16x16x32_bf16 v[108:111], v[148:151], a[52:55], v[108:111]
  ds_read_b128 v[148:151], v5 offset:23552
  s_waitcnt lgkmcnt(6)
  v_mfma_f32_16x16x32_bf16 v[112:115], v[152:155], a[48:51], v[112:115]
  buffer_load_dwordx4 v11, s[8:11], s45 offen offset:1024 lds
  v_mul_f32_e64 v69, v69, |v69|
  v_mfma_f32_16x16x32_bf16 v[116:119], v[152:155], a[52:55], v[116:119]
  ds_read_b128 v[152:155], v5 offset:24576
  v_mul_f32_e64 v77, v77, |v77|
  v_mfma_f32_16x16x32_bf16 v[96:99], v[156:159], a[56:59], v[96:99]
  v_cvt_pk_bf16_f32 v225, v69, v77
  v_pk_max_i16 v225, v225, 0
  v_mfma_f32_16x16x32_bf16 v[100:103], v[156:159], a[60:63], v[100:103]
  ds_read_b128 v[156:159], v5 offset:25600
  s_waitcnt lgkmcnt(6)
  v_mfma_f32_16x16x32_bf16 v[104:107], v[128:131], a[56:59], v[104:107]
  v_mul_f32_e64 v70, v70, |v70|
  v_mul_f32_e64 v78, v78, |v78|
  v_mfma_f32_16x16x32_bf16 v[108:111], v[128:131], a[60:63], v[108:111]
  ds_read_b128 v[128:131], v5 offset:26624
  v_cvt_pk_bf16_f32 v226, v70, v78
  v_mfma_f32_16x16x32_bf16 v[112:115], v[132:135], a[56:59], v[112:115]
  s_add_u32 m0, s30, 139264
  s_add_u32 s45, s34, 73728
  v_mfma_f32_16x16x32_bf16 v[116:119], v[132:135], a[60:63], v[116:119]
  ds_read_b128 v[132:135], v5 offset:27648
  s_waitcnt lgkmcnt(6)
  v_mfma_f32_16x16x32_bf16 v[96:99], v[136:139], a[64:67], v[96:99]
  buffer_load_dwordx4 v11, s[8:11], s45 offen lds
  v_pk_max_i16 v226, v226, 0
  v_mfma_f32_16x16x32_bf16 v[100:103], v[136:139], a[68:71], v[100:103]
  ds_read_b128 v[136:139], v5 offset:28672
  v_mul_f32_e64 v71, v71, |v71|
  v_mfma_f32_16x16x32_bf16 v[104:107], v[140:143], a[64:67], v[104:107]
  v_mul_f32_e64 v79, v79, |v79|
  v_cvt_pk_bf16_f32 v227, v71, v79
  v_mfma_f32_16x16x32_bf16 v[108:111], v[140:143], a[68:71], v[108:111]
  ds_read_b128 v[140:143], v5 offset:29696
  s_waitcnt lgkmcnt(6)
  v_mfma_f32_16x16x32_bf16 v[112:115], v[144:147], a[64:67], v[112:115]
  buffer_load_dwordx4 v11, s[8:11], s45 offen offset:1024 lds
  v_pk_max_i16 v227, v227, 0
  v_mfma_f32_16x16x32_bf16 v[116:119], v[144:147], a[68:71], v[116:119]
  ds_read_b128 v[144:147], v5 offset:30720
  buffer_store_dwordx4 v[224:227], v34, s[8:11], s44 offen sc1
  v_mfma_f32_16x16x32_bf16 v[96:99], v[148:151], a[72:75], v[96:99]
  v_mul_f32_e64 v84, v84, |v84|
  v_mul_f32_e64 v92, v92, |v92|
  v_mfma_f32_16x16x32_bf16 v[100:103], v[148:151], a[76:79], v[100:103]
  ds_read_b128 v[148:151], v5 offset:31744
  s_waitcnt lgkmcnt(6)
  v_mfma_f32_16x16x32_bf16 v[104:107], v[152:155], a[72:75], v[104:107]
  s_waitcnt vmcnt(24)
  s_barrier
  v_mfma_f32_16x16x32_bf16 v[108:111], v[152:155], a[76:79], v[108:111]
  ds_read_b128 v[152:155], v5 offset:32768
  v_cvt_pk_bf16_f32 v228, v84, v92
  v_mfma_f32_16x16x32_bf16 v[112:115], v[156:159], a[72:75], v[112:115]
  v_pk_max_i16 v228, v228, 0
  s_add_u32 m0, s30, 147456
  v_mfma_f32_16x16x32_bf16 v[116:119], v[156:159], a[76:79], v[116:119]
  ds_read_b128 v[156:159], v5 offset:33792
  s_waitcnt lgkmcnt(6)
  v_mfma_f32_16x16x32_bf16 v[96:99], v[128:131], a[80:83], v[96:99]
  s_add_u32 s45, s34, 81920
  buffer_load_dwordx4 v11, s[8:11], s45 offen lds
  v_mfma_f32_16x16x32_bf16 v[100:103], v[128:131], a[84:87], v[100:103]
  ds_read_b128 v[128:131], v5 offset:34816
  v_mul_f32_e64 v85, v85, |v85|
  v_mfma_f32_16x16x32_bf16 v[104:107], v[132:135], a[80:83], v[104:107]
  v_mul_f32_e64 v93, v93, |v93|
  v_cvt_pk_bf16_f32 v229, v85, v93
  v_mfma_f32_16x16x32_bf16 v[108:111], v[132:135], a[84:87], v[108:111]
  ds_read_b128 v[132:135], v5 offset:35840
  s_waitcnt lgkmcnt(6)
  v_mfma_f32_16x16x32_bf16 v[112:115], v[136:139], a[80:83], v[112:115]
  buffer_load_dwordx4 v11, s[8:11], s45 offen offset:1024 lds
  v_pk_max_i16 v229, v229, 0
  v_mfma_f32_16x16x32_bf16 v[116:119], v[136:139], a[84:87], v[116:119]
  ds_read_b128 v[136:139], v5 offset:36864
  v_mul_f32_e64 v86, v86, |v86|
  v_mfma_f32_16x16x32_bf16 v[96:99], v[140:143], a[88:91], v[96:99]
  v_mul_f32_e64 v94, v94, |v94|
  v_cvt_pk_bf16_f32 v230, v86, v94
  v_mfma_f32_16x16x32_bf16 v[100:103], v[140:143], a[92:95], v[100:103]
  ds_read_b128 v[140:143], v5 offset:37888
  s_waitcnt lgkmcnt(6)
  v_mfma_f32_16x16x32_bf16 v[104:107], v[144:147], a[88:91], v[104:107]
  v_pk_max_i16 v230, v230, 0
  v_mul_f32_e64 v87, v87, |v87|
  v_mfma_f32_16x16x32_bf16 v[108:111], v[144:147], a[92:95], v[108:111]
  ds_read_b128 v[144:147], v5 offset:38912
  s_add_u32 m0, s30, 155648
  v_mfma_f32_16x16x32_bf16 v[112:115], v[148:151], a[88:91], v[112:115]
  s_add_u32 s45, s34, 90112
  buffer_load_dwordx4 v11, s[8:11], s45 offen lds
  v_mfma_f32_16x16x32_bf16 v[116:119], v[148:151], a[92:95], v[116:119]
  ds_read_b128 v[148:151], v5 offset:39936
  s_waitcnt lgkmcnt(6)
  v_mfma_f32_16x16x32_bf16 v[96:99], v[152:155], a[96:99], v[96:99]
  v_mul_f32_e64 v95, v95, |v95|
  v_cvt_pk_bf16_f32 v231, v87, v95
  v_mfma_f32_16x16x32_bf16 v[100:103], v[152:155], a[100:103], v[100:103]
  ds_read_b128 v[152:155], v5 offset:40960
  v_pk_max_i16 v231, v231, 0
  v_mfma_f32_16x16x32_bf16 v[104:107], v[156:159], a[96:99], v[104:107]
  buffer_store_dwordx4 v[228:231], v34, s[8:11], s44 offen offset:1024 sc1
  v_mfma_f32_16x16x32_bf16 v[108:111], v[156:159], a[100:103], v[108:111]
  ds_read_b128 v[156:159], v5 offset:41984
  s_waitcnt lgkmcnt(6)
  v_mfma_f32_16x16x32_bf16 v[112:115], v[128:131], a[96:99], v[112:115]
  v_mfma_f32_16x16x32_bf16 v[116:119], v[128:131], a[100:103], v[116:119]
  ds_read_b128 v[128:131], v5 offset:43008
  v_mfma_f32_16x16x32_bf16 v[96:99], v[132:135], a[104:107], v[96:99]
  v_mfma_f32_16x16x32_bf16 v[100:103], v[132:135], a[108:111], v[100:103]
  ds_read_b128 v[132:135], v5 offset:44032
  s_waitcnt lgkmcnt(6)
  v_mfma_f32_16x16x32_bf16 v[104:107], v[136:139], a[104:107], v[104:107]
here_84:
  v_add_u32 v51, here_84-interleave_layers__linear_attn_block__dense_activation_squared_relu__prompt_kernel+1024, v38
  v_min_u32 v51, 57340, v51
  global_load_dword v49, v51, s[96:97]
  v_mfma_f32_16x16x32_bf16 v[108:111], v[136:139], a[108:111], v[108:111]
  ds_read_b128 v[136:139], v5 offset:45056
  v_mfma_f32_16x16x32_bf16 v[112:115], v[140:143], a[104:107], v[112:115]
  v_mfma_f32_16x16x32_bf16 v[116:119], v[140:143], a[108:111], v[116:119]
  ds_read_b128 v[140:143], v5 offset:46080
  s_waitcnt lgkmcnt(6)
  v_mfma_f32_16x16x32_bf16 v[96:99], v[144:147], a[112:115], v[96:99]
  v_mfma_f32_16x16x32_bf16 v[100:103], v[144:147], a[116:119], v[100:103]
  ds_read_b128 v[144:147], v5 offset:47104
  buffer_load_dwordx4 v11, s[8:11], s45 offen offset:1024 lds
  v_mfma_f32_16x16x32_bf16 v[104:107], v[148:151], a[112:115], v[104:107]
  v_mfma_f32_16x16x32_bf16 v[108:111], v[148:151], a[116:119], v[108:111]
  ds_read_b128 v[148:151], v5 offset:48128
  s_waitcnt lgkmcnt(6)
  v_mfma_f32_16x16x32_bf16 v[112:115], v[152:155], a[112:115], v[112:115]
  v_mfma_f32_16x16x32_bf16 v[116:119], v[152:155], a[116:119], v[116:119]
  ds_read_b128 v[152:155], v5 offset:49152
  v_mfma_f32_16x16x32_bf16 v[96:99], v[156:159], a[120:123], v[96:99]
  s_add_u32 m0, s30, 8192
  s_add_u32 s45, s34, 98304
  v_mfma_f32_16x16x32_bf16 v[100:103], v[156:159], a[124:127], v[100:103]
  ds_read_b128 v[156:159], v5 offset:50176
  s_waitcnt lgkmcnt(6)
  v_mfma_f32_16x16x32_bf16 v[104:107], v[128:131], a[120:123], v[104:107]
  buffer_load_dwordx4 v11, s[8:11], s45 offen lds
  v_mfma_f32_16x16x32_bf16 v[108:111], v[128:131], a[124:127], v[108:111]
  ds_read_b128 v[128:131], v5 offset:51200
  v_mfma_f32_16x16x32_bf16 v[112:115], v[132:135], a[120:123], v[112:115]
  v_mfma_f32_16x16x32_bf16 v[116:119], v[132:135], a[124:127], v[116:119]
  ds_read_b128 v[132:135], v5 offset:52224
  s_waitcnt lgkmcnt(6)
  v_mfma_f32_16x16x32_bf16 v[96:99], v[136:139], a[128:131], v[96:99]
  buffer_load_dwordx4 v11, s[8:11], s45 offen offset:1024 lds
  v_mfma_f32_16x16x32_bf16 v[100:103], v[136:139], a[132:135], v[100:103]
  ds_read_b128 v[136:139], v5 offset:53248
  v_mfma_f32_16x16x32_bf16 v[104:107], v[140:143], a[128:131], v[104:107]
  v_mfma_f32_16x16x32_bf16 v[108:111], v[140:143], a[132:135], v[108:111]
  ds_read_b128 v[140:143], v5 offset:54272
  s_waitcnt lgkmcnt(6)
  v_mfma_f32_16x16x32_bf16 v[112:115], v[144:147], a[128:131], v[112:115]
  s_add_u32 m0, s30, 16384
  s_add_u32 s45, s34, 106496
  v_mfma_f32_16x16x32_bf16 v[116:119], v[144:147], a[132:135], v[116:119]
  ds_read_b128 v[144:147], v5 offset:55296
  buffer_load_dwordx4 v11, s[8:11], s45 offen lds
  v_mfma_f32_16x16x32_bf16 v[96:99], v[148:151], a[136:139], v[96:99]
  v_mfma_f32_16x16x32_bf16 v[100:103], v[148:151], a[140:143], v[100:103]
  ds_read_b128 v[148:151], v5 offset:56320
  s_waitcnt lgkmcnt(6)
  v_mfma_f32_16x16x32_bf16 v[104:107], v[152:155], a[136:139], v[104:107]
  buffer_load_dwordx4 v11, s[8:11], s45 offen offset:1024 lds
  s_waitcnt vmcnt(33)
  s_barrier
  v_mfma_f32_16x16x32_bf16 v[108:111], v[152:155], a[140:143], v[108:111]
  ds_read_b128 v[152:155], v5 offset:57344
  v_mfma_f32_16x16x32_bf16 v[112:115], v[156:159], a[136:139], v[112:115]
  v_mfma_f32_16x16x32_bf16 v[116:119], v[156:159], a[140:143], v[116:119]
  ds_read_b128 v[156:159], v5 offset:58368
  s_waitcnt lgkmcnt(6)
  v_mfma_f32_16x16x32_bf16 v[96:99], v[128:131], a[144:147], v[96:99]
  v_mfma_f32_16x16x32_bf16 v[100:103], v[128:131], a[148:151], v[100:103]
  ds_read_b128 v[128:131], v5 offset:59392
  s_add_u32 m0, s30, 24576
  v_mfma_f32_16x16x32_bf16 v[104:107], v[132:135], a[144:147], v[104:107]
  s_add_u32 s45, s34, 114688
  buffer_load_dwordx4 v11, s[8:11], s45 offen lds
  v_mfma_f32_16x16x32_bf16 v[108:111], v[132:135], a[148:151], v[108:111]
  s_waitcnt lgkmcnt(5)
  v_mfma_f32_16x16x32_bf16 v[112:115], v[136:139], a[144:147], v[112:115]
  v_mfma_f32_16x16x32_bf16 v[116:119], v[136:139], a[148:151], v[116:119]
  v_mfma_f32_16x16x32_bf16 v[96:99], v[140:143], a[152:155], v[96:99]
  v_mfma_f32_16x16x32_bf16 v[100:103], v[140:143], a[156:159], v[100:103]
  buffer_load_dwordx4 v11, s[8:11], s45 offen offset:1024 lds
  s_waitcnt lgkmcnt(3)
  v_mfma_f32_16x16x32_bf16 v[104:107], v[144:147], a[152:155], v[104:107]
  v_mfma_f32_16x16x32_bf16 v[108:111], v[144:147], a[156:159], v[108:111]
  v_mfma_f32_16x16x32_bf16 v[112:115], v[148:151], a[152:155], v[112:115]
  v_mfma_f32_16x16x32_bf16 v[116:119], v[148:151], a[156:159], v[116:119]
  s_add_u32 m0, s30, 32768
  s_waitcnt lgkmcnt(1)
  v_mfma_f32_16x16x32_bf16 v[96:99], v[152:155], v[40:43], v[96:99]
  s_add_u32 s45, s34, 122880
  buffer_load_dwordx4 v11, s[8:11], s45 offen lds
  v_mfma_f32_16x16x32_bf16 v[100:103], v[152:155], v[44:47], v[100:103]
  v_mfma_f32_16x16x32_bf16 v[104:107], v[156:159], v[40:43], v[104:107]
  buffer_load_dwordx4 v11, s[8:11], s45 offen offset:1024 lds
  s_barrier
  v_mfma_f32_16x16x32_bf16 v[108:111], v[156:159], v[44:47], v[108:111]
  s_waitcnt lgkmcnt(0)
  v_mfma_f32_16x16x32_bf16 v[112:115], v[128:131], v[40:43], v[112:115]
  v_mfma_f32_16x16x32_bf16 v[116:119], v[128:131], v[44:47], v[116:119]
  s_add_u32 s43, s59, 13762560
  v_mul_f32_e64 v96, v96, |v96|
  v_mul_f32_e64 v104, v104, |v104|
  v_cvt_pk_bf16_f32 v216, v96, v104
  v_pk_max_i16 v216, v216, 0
  v_mul_f32_e64 v97, v97, |v97|
  v_mul_f32_e64 v105, v105, |v105|
  v_cvt_pk_bf16_f32 v217, v97, v105
  v_pk_max_i16 v217, v217, 0
  v_mul_f32_e64 v98, v98, |v98|
  v_mul_f32_e64 v106, v106, |v106|
  v_cvt_pk_bf16_f32 v218, v98, v106
  v_pk_max_i16 v218, v218, 0
  v_mul_f32_e64 v99, v99, |v99|
  v_mul_f32_e64 v107, v107, |v107|
  v_cvt_pk_bf16_f32 v219, v99, v107
  v_pk_max_i16 v219, v219, 0
  buffer_store_dwordx4 v[216:219], v34, s[8:11], s43 offen offset:2048 sc1
  s_add_u32 s44, s59, 13817856
  v_mul_f32_e64 v100, v100, |v100|
  v_mul_f32_e64 v108, v108, |v108|
  v_cvt_pk_bf16_f32 v220, v100, v108
  v_pk_max_i16 v220, v220, 0
  v_mul_f32_e64 v101, v101, |v101|
  v_mul_f32_e64 v109, v109, |v109|
  v_cvt_pk_bf16_f32 v221, v101, v109
  v_pk_max_i16 v221, v221, 0
  v_mul_f32_e64 v102, v102, |v102|
  v_mul_f32_e64 v110, v110, |v110|
  v_cvt_pk_bf16_f32 v222, v102, v110
  v_pk_max_i16 v222, v222, 0
  v_mul_f32_e64 v103, v103, |v103|
  v_mul_f32_e64 v111, v111, |v111|
  v_cvt_pk_bf16_f32 v223, v103, v111
  v_pk_max_i16 v223, v223, 0
  buffer_store_dwordx4 v[220:223], v34, s[8:11], s44 offen offset:2048 sc1
  v_mul_f32_e64 v112, v112, |v112|
  v_mul_f32_e64 v113, v113, |v113|
  v_mul_f32_e64 v114, v114, |v114|
  v_mul_f32_e64 v115, v115, |v115|
  v_cvt_pk_bf16_f32 v232, v112, v113
  v_pk_max_i16 v232, v232, 0
  v_cvt_pk_bf16_f32 v233, v114, v115
  v_pk_max_i16 v233, v233, 0
  v_mul_f32_e64 v116, v116, |v116|
  v_mul_f32_e64 v117, v117, |v117|
  v_mul_f32_e64 v118, v118, |v118|
  v_mul_f32_e64 v119, v119, |v119|
  v_cvt_pk_bf16_f32 v234, v116, v117
  v_pk_max_i16 v234, v234, 0
  v_cvt_pk_bf16_f32 v235, v118, v119
  v_pk_max_i16 v235, v235, 0
  s_add_u32 s41, s60, 13762560
  s_add_u32 s42, s60, 13817856
  buffer_store_dwordx2 v[232:233], v35, s[8:11], s41 offen sc1
  buffer_store_dwordx2 v[234:235], v35, s[8:11], s42 offen sc1
  s_waitcnt vmcnt(0)
  s_barrier
  s_lshl_b32 s41, s47, 2
  s_add_u32 s41, s41, s24
  s_cmp_lg_u32 s41, 1
  s_cbranch_scc1 noflag_85
  s_lshl_b32 s41, s26, 2
  v_mov_b32 v237, s41
  s_add_u32 s41, s92, 8
  v_mov_b32 v238, s41
  s_mov_b64 exec, 1
  buffer_store_dword v238, v237, s[8:11], s39 offen sc1
  s_mov_b64 exec, -1
noflag_85:
  s_cmp_lg_u32 s24, 2
  s_cbranch_scc1 noflag_86
  s_lshl_b32 s41, s26, 2
  v_mov_b32 v237, s41
  s_add_u32 s41, s92, 8
  v_mov_b32 v238, s41
  s_mov_b64 exec, 1
  buffer_store_dword v238, v237, s[8:11], s38 offen
  s_mov_b64 exec, -1
noflag_86:
  s_add_u32 m0, s30, 40960
  s_add_u32 s45, s34, 131072
  buffer_load_dwordx4 v11, s[8:11], s45 offen lds
  buffer_load_dwordx4 v11, s[8:11], s45 offen offset:1024 lds
  s_add_u32 m0, s30, 49152
  s_add_u32 s45, s34, 139264
  buffer_load_dwordx4 v11, s[8:11], s45 offen lds
  buffer_load_dwordx4 v11, s[8:11], s45 offen offset:1024 lds
  s_add_u32 m0, s30, 57344
  s_add_u32 s45, s34, 147456
  buffer_load_dwordx4 v11, s[8:11], s45 offen lds
  buffer_load_dwordx4 v11, s[8:11], s45 offen offset:1024 lds
  ds_read_b128 v[132:135], v9
  ds_read_b128 v[136:139], v9 offset:2048
  ds_read_b128 v[140:143], v9 offset:4096
  ds_read_b128 v[144:147], v9 offset:6144
  ds_read_b128 v[148:151], v9 offset:8192
  ds_read_b128 v[152:155], v9 offset:10240
  ds_read_b128 v[156:159], v9 offset:12288
  ds_read_b128 v[128:131], v9 offset:14336
  s_cmp_lg_u32 s24, 0
  s_cbranch_scc1 nopoll_87
  s_mov_b32 s50, 0
  s_mov_b64 s[94:95], 0
  s_add_u32 s42, s92, 8
  s_cmp_eq_u32 s47, 0
  s_cselect_b32 s43, 3, -1
poll_88:
  buffer_load_dword v238, v36, s[8:11], s38 offen sc1
  s_add_u32 s50, s50, 1
  s_waitcnt vmcnt(0)
  v_subrev_u32 v238, s42, v238
  v_cmp_ge_u32 vcc, 1, v238
  s_or_b64 s[94:95], s[94:95], vcc
  s_cmp_eq_u64 s[94:95], -1
  s_cbranch_scc1 nopoll_87
  s_and_b32 s41, s50, s43
  s_cbranch_scc1 pollnext_89
  buffer_load_dword v238, v36, s[8:11], s39 offen sc1
  s_waitcnt vmcnt(0)
  v_subrev_u32 v238, s42, v238
  v_cmp_ge_u32 vcc, 1, v238
  s_or_b64 s[94:95], s[94:95], vcc
  s_cmp_eq_u64 s[94:95], -1
  s_cbranch_scc1 nopoll_87
pollnext_89:
  s_cmp_lt_u32 s50, 0x80000
  s_cbranch_scc1 poll_88
nopoll_87:
  s_barrier
  s_add_u32 s46, s36, 13762560
  buffer_load_dwordx4 a[0:3], v16, s[8:11], s46 offen sc1
  buffer_load_dwordx4 a[4:7], v17, s[8:11], s46 offen sc1
  buffer_load_dwordx4 a[8:11], v16, s[8:11], s46 offen offset:1024 sc1
  buffer_load_dwordx4 a[12:15], v17, s[8:11], s46 offen offset:1024 sc1
  buffer_load_dwordx4 a[16:19], v16, s[8:11], s46 offen offset:2048 sc1
  buffer_load_dwordx4 a[20:23], v17, s[8:11], s46 offen offset:2048 sc1
  buffer_load_dwordx4 a[24:27], v16, s[8:11], s46 offen offset:3072 sc1
  buffer_load_dwordx4 a[28:31], v17, s[8:11], s46 offen offset:3072 sc1
  ds_read_b32 v202, v27
  s_waitcnt vmcnt(6) lgkmcnt(7)
  v_mfma_f32_16x16x32_bf16 v[84:87], v[132:135], a[4:7], 0
  s_add_u32 s46, s36, 13766656
  buffer_load_dwordx4 a[32:35], v16, s[8:11], s46 offen sc1
  v_mfma_f32_16x16x32_bf16 v[64:67], v[132:135], a[0:3], 0
  ds_read_b128 v[132:135], v9 offset:16384
  buffer_load_dwordx4 a[36:39], v17, s[8:11], s46 offen sc1
  v_mfma_f32_16x16x32_bf16 v[88:91], v[136:139], a[4:7], 0
  buffer_load_dwordx4 a[40:43], v16, s[8:11], s46 offen offset:1024 sc1
  buffer_load_dwordx4 a[44:47], v17, s[8:11], s46 offen offset:1024 sc1
  v_mfma_f32_16x16x32_bf16 v[68:71], v[136:139], a[0:3], 0
  ds_read_b128 v[136:139], v9 offset:18432
  s_waitcnt lgkmcnt(7)
  v_mfma_f32_16x16x32_bf16 v[92:95], v[140:143], a[4:7], 0
  buffer_load_dwordx4 a[48:51], v16, s[8:11], s46 offen offset:2048 sc1
  buffer_load_dwordx4 a[52:55], v17, s[8:11], s46 offen offset:2048 sc1
  v_mfma_f32_16x16x32_bf16 v[72:75], v[140:143], a[0:3], 0
  ds_read_b128 v[140:143], v9 offset:20480
  v_mfma_f32_16x16x32_bf16 v[96:99], v[144:147], a[4:7], 0
  buffer_load_dwordx4 a[56:59], v16, s[8:11], s46 offen offset:3072 sc1
  v_mfma_f32_16x16x32_bf16 v[76:79], v[144:147], a[0:3], 0
  ds_read_b128 v[144:147], v9 offset:22528
  s_waitcnt vmcnt(11) lgkmcnt(7)
  v_mfma_f32_16x16x32_bf16 v[100:103], v[148:151], a[4:7], 0
  s_barrier
  v_mfma_f32_16x16x32_bf16 v[80:83], v[148:151], a[0:3], 0
  ds_read_b128 v[148:151], v9 offset:24576
  buffer_load_dwordx4 a[60:63], v17, s[8:11], s46 offen offset:3072 sc1
  v_mfma_f32_16x16x32_bf16 v[84:87], v[152:155], a[12:15], v[84:87]
  v_mfma_f32_16x16x32_bf16 v[64:67], v[152:155], a[8:11], v[64:67]
  ds_read_b128 v[152:155], v9 offset:26624
  s_waitcnt lgkmcnt(7)
  v_mfma_f32_16x16x32_bf16 v[88:91], v[156:159], a[12:15], v[88:91]
  s_add_u32 s46, s36, 13770752
  buffer_load_dwordx4 a[64:67], v16, s[8:11], s46 offen sc1
  v_mfma_f32_16x16x32_bf16 v[68:71], v[156:159], a[8:11], v[68:71]
  ds_read_b128 v[156:159], v9 offset:28672
  v_mfma_f32_16x16x32_bf16 v[92:95], v[128:131], a[12:15], v[92:95]
  buffer_load_dwordx4 a[68:71], v17, s[8:11], s46 offen sc1
  v_mfma_f32_16x16x32_bf16 v[72:75], v[128:131], a[8:11], v[72:75]
  ds_read_b128 v[128:131], v9 offset:30720
  s_waitcnt lgkmcnt(6)
  v_mfma_f32_16x16x32_bf16 v[96:99], v[132:135], a[12:15], v[96:99]
  buffer_load_dwordx4 a[72:75], v16, s[8:11], s46 offen offset:1024 sc1
  v_mfma_f32_16x16x32_bf16 v[76:79], v[132:135], a[8:11], v[76:79]
  ds_read_b128 v[132:135], v9 offset:32768
  v_mfma_f32_16x16x32_bf16 v[100:103], v[136:139], a[12:15], v[100:103]
  v_mfma_f32_16x16x32_bf16 v[80:83], v[136:139], a[8:11], v[80:83]
  ds_read_b128 v[136:139], v9 offset:34816
  s_waitcnt vmcnt(13) lgkmcnt(6)
  v_mfma_f32_16x16x32_bf16 v[84:87], v[140:143], a[20:23], v[84:87]
  v_mfma_f32_16x16x32_bf16 v[64:67], v[140:143], a[16:19], v[64:67]
  ds_read_b128 v[140:143], v9 offset:36864
  buffer_load_dwordx4 a[76:79], v17, s[8:11], s46 offen offset:1024 sc1
  v_mfma_f32_16x16x32_bf16 v[88:91], v[144:147], a[20:23], v[88:91]
  v_mfma_f32_16x16x32_bf16 v[68:71], v[144:147], a[16:19], v[68:71]
  ds_read_b128 v[144:147], v9 offset:38912
  s_waitcnt lgkmcnt(6)
  v_mfma_f32_16x16x32_bf16 v[92:95], v[148:151], a[20:23], v[92:95]
  v_mfma_f32_16x16x32_bf16 v[72:75], v[148:151], a[16:19], v[72:75]
  ds_read_b128 v[148:151], v9 offset:40960
  v_mfma_f32_16x16x32_bf16 v[96:99], v[152:155], a[20:23], v[96:99]
  buffer_load_dwordx4 a[80:83], v16, s[8:11], s46 offen offset:2048 sc1
  v_mfma_f32_16x16x32_bf16 v[76:79], v[152:155], a[16:19], v[76:79]
  ds_read_b128 v[152:155], v9 offset:43008
  s_waitcnt vmcnt(13) lgkmcnt(6)
  v_mfma_f32_16x16x32_bf16 v[100:103], v[156:159], a[20:23], v[100:103]
  v_mfma_f32_16x16x32_bf16 v[80:83], v[156:159], a[16:19], v[80:83]
  ds_read_b128 v[156:159], v9 offset:45056
  v_mfma_f32_16x16x32_bf16 v[84:87], v[128:131], a[28:31], v[84:87]
  v_mfma_f32_16x16x32_bf16 v[64:67], v[128:131], a[24:27], v[64:67]
  ds_read_b128 v[128:131], v9 offset:47104
  s_waitcnt lgkmcnt(6)
  v_mfma_f32_16x16x32_bf16 v[88:91], v[132:135], a[28:31], v[88:91]
  s_barrier
  v_mfma_f32_16x16x32_bf16 v[68:71], v[132:135], a[24:27], v[68:71]
  ds_read_b128 v[132:135], v9 offset:49152
  v_mfma_f32_16x16x32_bf16 v[92:95], v[136:139], a[28:31], v[92:95]
  v_mfma_f32_16x16x32_bf16 v[72:75], v[136:139], a[24:27], v[72:75]
  ds_read_b128 v[136:139], v9 offset:51200
  s_waitcnt lgkmcnt(6)
  v_mfma_f32_16x16x32_bf16 v[96:99], v[140:143], a[28:31], v[96:99]
  v_mfma_f32_16x16x32_bf16 v[76:79], v[140:143], a[24:27], v[76:79]
  ds_read_b128 v[140:143], v9 offset:53248
  buffer_load_dwordx4 a[84:87], v17, s[8:11], s46 offen offset:2048 sc1
  v_mfma_f32_16x16x32_bf16 v[100:103], v[144:147], a[28:31], v[100:103]
  v_mfma_f32_16x16x32_bf16 v[80:83], v[144:147], a[24:27], v[80:83]
  ds_read_b128 v[144:147], v9 offset:55296
  s_waitcnt vmcnt(12) lgkmcnt(6)
  v_mfma_f32_16x16x32_bf16 v[84:87], v[148:151], a[36:39], v[84:87]
  buffer_load_dwordx4 a[88:91], v16, s[8:11], s46 offen offset:3072 sc1
  v_add_u32 v200, 143360, v39
  v_mfma_f32_16x16x32_bf16 v[64:67], v[148:151], a[32:35], v[64:67]
  ds_read_b128 v[148:151], v9 offset:57344
  s_xor_b32 s41, s24, 1
  v_mfma_f32_16x16x32_bf16 v[88:91], v[152:155], a[36:39], v[88:91]
  s_mul_i32 s41, s41, 5120
  s_add_u32 s41, s41, 143360
  v_mfma_f32_16x16x32_bf16 v[68:71], v[152:155], a[32:35], v[68:71]
  ds_read_b128 v[152:155], v9 offset:59392
  s_waitcnt lgkmcnt(6)
  v_mfma_f32_16x16x32_bf16 v[92:95], v[156:159], a[36:39], v[92:95]
  buffer_load_dwordx4 a[92:95], v17, s[8:11], s46 offen offset:3072 sc1
  v_add_u32 v201, s41, v4
  v_mfma_f32_16x16x32_bf16 v[72:75], v[156:159], a[32:35], v[72:75]
  ds_read_b128 v[156:159], v9 offset:61440
  v_mul_f32 v202, v202, v202
  v_mfma_f32_16x16x32_bf16 v[96:99], v[128:131], a[36:39], v[96:99]
  v_add_u32 v55, 65536, v11
  ds_write_b128 v55, a[160:163]
  v_mfma_f32_16x16x32_bf16 v[76:79], v[128:131], a[32:35], v[76:79]
  ds_read_b128 v[128:131], v9 offset:63488
  s_waitcnt vmcnt(12) lgkmcnt(7)
  v_mfma_f32_16x16x32_bf16 v[100:103], v[132:135], a[36:39], v[100:103]
  ds_write_b128 v55, a[164:167] offset:1024
  s_add_u32 s46, s36, 13774848
  v_mfma_f32_16x16x32_bf16 v[80:83], v[132:135], a[32:35], v[80:83]
  ds_read_b128 v[132:135], v10
  buffer_load_dwordx4 a[96:99], v16, s[8:11], s46 offen sc1
  v_mfma_f32_16x16x32_bf16 v[84:87], v[136:139], a[44:47], v[84:87]
  v_mfma_f32_16x16x32_bf16 v[64:67], v[136:139], a[40:43], v[64:67]
  ds_read_b128 v[136:139], v10 offset:2048
  s_waitcnt lgkmcnt(8)
  v_mfma_f32_16x16x32_bf16 v[88:91], v[140:143], a[44:47], v[88:91]
  buffer_load_dwordx4 a[100:103], v17, s[8:11], s46 offen sc1
  v_mfma_f32_16x16x32_bf16 v[68:71], v[140:143], a[40:43], v[68:71]
  ds_read_b128 v[140:143], v10 offset:4096
  v_mfma_f32_16x16x32_bf16 v[92:95], v[144:147], a[44:47], v[92:95]
  v_add_u32 v55, 73728, v11
  ds_write_b128 v55, a[168:171]
  v_mfma_f32_16x16x32_bf16 v[72:75], v[144:147], a[40:43], v[72:75]
  ds_read_b128 v[144:147], v10 offset:6144
  s_waitcnt lgkmcnt(9)
  v_mfma_f32_16x16x32_bf16 v[96:99], v[148:151], a[44:47], v[96:99]
  ds_write_b128 v55, a[172:175] offset:1024
  s_barrier
  v_mfma_f32_16x16x32_bf16 v[76:79], v[148:151], a[40:43], v[76:79]
  ds_read_b128 v[148:151], v10 offset:8192
  v_add_u32 v55, 81920, v11
  v_mfma_f32_16x16x32_bf16 v[100:103], v[152:155], a[44:47], v[100:103]
  ds_write_b128 v55, a[176:179]
  ds_write_b128 v55, a[180:183] offset:1024
  v_mfma_f32_16x16x32_bf16 v[80:83], v[152:155], a[40:43], v[80:83]
  ds_read_b128 v[152:155], v10 offset:10240
  s_waitcnt vmcnt(12) lgkmcnt(11)
  v_mfma_f32_16x16x32_bf16 v[84:87], v[156:159], a[52:55], v[84:87]
  buffer_load_dwordx4 a[104:107], v16, s[8:11], s46 offen offset:1024 sc1
  v_mfma_f32_16x16x32_bf16 v[64:67], v[156:159], a[48:51], v[64:67]
  ds_read_b128 v[156:159], v10 offset:12288
  v_mfma_f32_16x16x32_bf16 v[88:91], v[128:131], a[52:55], v[88:91]
  buffer_load_dwordx4 a[108:111], v17, s[8:11], s46 offen offset:1024 sc1
  v_mfma_f32_16x16x32_bf16 v[68:71], v[128:131], a[48:51], v[68:71]
  ds_read_b128 v[128:131], v10 offset:14336
  s_waitcnt lgkmcnt(10)
  v_mfma_f32_16x16x32_bf16 v[92:95], v[132:135], a[52:55], v[92:95]
  v_add_u32 v55, 90112, v11
  ds_write_b128 v55, a[184:187]
  v_mfma_f32_16x16x32_bf16 v[72:75], v[132:135], a[48:51], v[72:75]
  ds_read_b128 v[132:135], v10 offset:16384
  ds_write_b128 v55, a[188:191] offset:1024
  v_mfma_f32_16x16x32_bf16 v[96:99], v[136:139], a[52:55], v[96:99]
  buffer_load_dwordx4 a[112:115], v16, s[8:11], s46 offen offset:2048 sc1
  v_mfma_f32_16x16x32_bf16 v[76:79], v[136:139], a[48:51], v[76:79]
  ds_read_b128 v[136:139], v10 offset:18432
  s_waitcnt vmcnt(13) lgkmcnt(11)
  v_mfma_f32_16x16x32_bf16 v[100:103], v[140:143], a[52:55], v[100:103]
  buffer_load_dwordx4 a[116:119], v17, s[8:11], s46 offen offset:2048 sc1
  v_mfma_f32_16x16x32_bf16 v[80:83], v[140:143], a[48:51], v[80:83]
  ds_read_b128 v[140:143], v10 offset:20480
  v_mfma_f32_16x16x32_bf16 v[84:87], v[144:147], a[60:63], v[84:87]
  v_add_u32 v55, 98304, v11
  ds_write_b128 v55, a[192:195]
  v_mfma_f32_16x16x32_bf16 v[64:67], v[144:147], a[56:59], v[64:67]
  ds_read_b128 v[144:147], v10 offset:22528
  s_waitcnt lgkmcnt(9)
  v_mfma_f32_16x16x32_bf16 v[88:91], v[148:151], a[60:63], v[88:91]
  ds_write_b128 v55, a[196:199] offset:1024
  buffer_load_dwordx4 a[120:123], v16, s[8:11], s46 offen offset:3072 sc1
  v_mfma_f32_16x16x32_bf16 v[68:71], v[148:151], a[56:59], v[68:71]
  ds_read_b128 v[148:151], v10 offset:24576
  v_mfma_f32_16x16x32_bf16 v[92:95], v[152:155], a[60:63], v[92:95]
  buffer_load_dwordx4 a[124:127], v17, s[8:11], s46 offen offset:3072 sc1
  v_mfma_f32_16x16x32_bf16 v[72:75], v[152:155], a[56:59], v[72:75]
  ds_read_b128 v[152:155], v10 offset:26624
  s_waitcnt lgkmcnt(10)
  v_mfma_f32_16x16x32_bf16 v[96:99], v[156:159], a[60:63], v[96:99]
  v_add_u32 v55, 106496, v11
  ds_write_b128 v55, a[200:203]
  v_mfma_f32_16x16x32_bf16 v[76:79], v[156:159], a[56:59], v[76:79]
  ds_read_b128 v[156:159], v10 offset:28672
  ds_write_b128 v55, a[204:207] offset:1024
  v_mfma_f32_16x16x32_bf16 v[100:103], v[128:131], a[60:63], v[100:103]
  s_add_u32 s46, s36, 13778944
  buffer_load_dwordx4 a[128:131], v16, s[8:11], s46 offen sc1
  v_mfma_f32_16x16x32_bf16 v[80:83], v[128:131], a[56:59], v[80:83]
  ds_read_b128 v[128:131], v10 offset:30720
  s_waitcnt vmcnt(15) lgkmcnt(10)
  v_mfma_f32_16x16x32_bf16 v[84:87], v[132:135], a[68:71], v[84:87]
  s_barrier
  v_mfma_f32_16x16x32_bf16 v[64:67], v[132:135], a[64:67], v[64:67]
  ds_read_b128 v[132:135], v8 offset:8192
  buffer_load_dwordx4 a[132:135], v17, s[8:11], s46 offen sc1
  v_mfma_f32_16x16x32_bf16 v[88:91], v[136:139], a[68:71], v[88:91]
  v_mfma_f32_16x16x32_bf16 v[68:71], v[136:139], a[64:67], v[68:71]
  ds_read_b128 v[136:139], v8 offset:10240
  s_waitcnt lgkmcnt(9)
  v_mfma_f32_16x16x32_bf16 v[92:95], v[140:143], a[68:71], v[92:95]
  v_add_u32 v55, 114688, v11
  ds_write_b128 v55, a[208:211]
  v_mfma_f32_16x16x32_bf16 v[72:75], v[140:143], a[64:67], v[72:75]
  ds_read_b128 v[140:143], v8 offset:12288
  ds_write_b128 v55, a[212:215] offset:1024
  v_mfma_f32_16x16x32_bf16 v[96:99], v[144:147], a[68:71], v[96:99]
  v_add_u32 v55, 122880, v11
  ds_write_b128 v55, a[216:219]
  v_mfma_f32_16x16x32_bf16 v[76:79], v[144:147], a[64:67], v[76:79]
  ds_read_b128 v[144:147], v8 offset:14336
  s_waitcnt vmcnt(14) lgkmcnt(11)
  v_mfma_f32_16x16x32_bf16 v[100:103], v[148:151], a[68:71], v[100:103]
  ds_write_b128 v55, a[220:223] offset:1024
  buffer_load_dwordx4 a[136:139], v16, s[8:11], s46 offen offset:1024 sc1
  v_mfma_f32_16x16x32_bf16 v[80:83], v[148:151], a[64:67], v[80:83]
  ds_read_b128 v[148:151], v8 offset:16384
  v_mfma_f32_16x16x32_bf16 v[84:87], v[152:155], a[76:79], v[84:87]
  buffer_load_dwordx4 a[140:143], v17, s[8:11], s46 offen offset:1024 sc1
  v_mfma_f32_16x16x32_bf16 v[64:67], v[152:155], a[72:75], v[64:67]
  ds_read_b128 v[152:155], v8 offset:18432
  s_waitcnt lgkmcnt(10)
  v_mfma_f32_16x16x32_bf16 v[88:91], v[156:159], a[76:79], v[88:91]
  v_add_u32 v55, 131072, v11
  ds_write_b128 v55, a[224:227]
  v_mfma_f32_16x16x32_bf16 v[68:71], v[156:159], a[72:75], v[68:71]
  ds_read_b128 v[156:159], v8 offset:20480
  ds_write_b128 v55, a[228:231] offset:1024
  v_mfma_f32_16x16x32_bf16 v[92:95], v[128:131], a[76:79], v[92:95]
  buffer_load_dwordx4 a[144:147], v16, s[8:11], s46 offen offset:2048 sc1
  v_mfma_f32_16x16x32_bf16 v[72:75], v[128:131], a[72:75], v[72:75]
  ds_read_b128 v[128:131], v8 offset:22528
  s_waitcnt lgkmcnt(12)
  v_mfma_f32_16x16x32_bf16 v[96:99], v[132:135], a[76:79], v[96:99]
  buffer_load_dwordx4 a[148:151], v17, s[8:11], s46 offen offset:2048 sc1
  v_mfma_f32_16x16x32_bf16 v[76:79], v[132:135], a[72:75], v[76:79]
  ds_read_b128 v[132:135], v8 offset:24576
  v_mfma_f32_16x16x32_bf16 v[100:103], v[136:139], a[76:79], v[100:103]
  v_add_u32 v55, 139264, v11
  ds_write_b128 v55, a[232:235]
  v_mfma_f32_16x16x32_bf16 v[80:83], v[136:139], a[72:75], v[80:83]
  ds_read_b128 v[136:139], v8 offset:26624
  s_waitcnt vmcnt(16) lgkmcnt(10)
  v_mfma_f32_16x16x32_bf16 v[84:87], v[140:143], a[84:87], v[84:87]
  ds_write_b128 v55, a[236:239] offset:1024
  buffer_load_dwordx4 a[152:155], v16, s[8:11], s46 offen offset:3072 sc1
  v_mfma_f32_16x16x32_bf16 v[64:67], v[140:143], a[80:83], v[64:67]
  ds_read_b128 v[140:143], v8 offset:28672
  v_mfma_f32_16x16x32_bf16 v[88:91], v[144:147], a[84:87], v[88:91]
  buffer_load_dwordx4 a[156:159], v17, s[8:11], s46 offen offset:3072 sc1
  v_mfma_f32_16x16x32_bf16 v[68:71], v[144:147], a[80:83], v[68:71]
  ds_read_b128 v[144:147], v8 offset:30720
  s_waitcnt lgkmcnt(10)
  v_mfma_f32_16x16x32_bf16 v[92:95], v[148:151], a[84:87], v[92:95]
  s_barrier
  v_mfma_f32_16x16x32_bf16 v[72:75], v[148:151], a[80:83], v[72:75]
  ds_read_b128 v[148:151], v8 offset:32768
  v_add_u32 v55, 147456, v11
  v_mfma_f32_16x16x32_bf16 v[96:99], v[152:155], a[84:87], v[96:99]
  ds_write_b128 v55, a[240:243]
  ds_write_b128 v55, a[244:247] offset:1024
  v_mfma_f32_16x16x32_bf16 v[76:79], v[152:155], a[80:83], v[76:79]
  ds_read_b128 v[152:155], v8 offset:34816
  s_waitcnt vmcnt(16) lgkmcnt(10)
  v_mfma_f32_16x16x32_bf16 v[100:103], v[156:159], a[84:87], v[100:103]
  s_add_u32 s46, s36, 13783040
  buffer_load_dwordx4 a[0:3], v16, s[8:11], s46 offen sc1
  v_mfma_f32_16x16x32_bf16 v[80:83], v[156:159], a[80:83], v[80:83]
  ds_read_b128 v[156:159], v8 offset:36864
  v_mfma_f32_16x16x32_bf16 v[84:87], v[128:131], a[92:95], v[84:87]
  buffer_load_dwordx4 a[4:7], v17, s[8:11], s46 offen sc1
  v_mfma_f32_16x16x32_bf16 v[64:67], v[128:131], a[88:91], v[64:67]
  ds_read_b128 v[128:131], v8 offset:38912
  s_waitcnt lgkmcnt(9)
  v_mfma_f32_16x16x32_bf16 v[88:91], v[132:135], a[92:95], v[88:91]
  s_add_u32 m0, s30, 155648
  s_add_u32 s45, s34, 245760
  v_mfma_f32_16x16x32_bf16 v[68:71], v[132:135], a[88:91], v[68:71]
  ds_read_b128 v[132:135], v8 offset:40960
  buffer_load_dwordx4 v11, s[8:11], s45 offen lds
  v_mfma_f32_16x16x32_bf16 v[92:95], v[136:139], a[92:95], v[92:95]
  v_mfma_f32_16x16x32_bf16 v[72:75], v[136:139], a[88:91], v[72:75]
  ds_read_b128 v[136:139], v8 offset:43008
  s_waitcnt lgkmcnt(8)
  v_mfma_f32_16x16x32_bf16 v[96:99], v[140:143], a[92:95], v[96:99]
  buffer_load_dwordx4 v11, s[8:11], s45 offen offset:1024 lds
  v_mfma_f32_16x16x32_bf16 v[76:79], v[140:143], a[88:91], v[76:79]
  ds_read_b128 v[140:143], v8 offset:45056
  v_mfma_f32_16x16x32_bf16 v[100:103], v[144:147], a[92:95], v[100:103]
  s_add_u32 m0, s30, 8192
  s_add_u32 s45, s34, 253952
  v_mfma_f32_16x16x32_bf16 v[80:83], v[144:147], a[88:91], v[80:83]
  ds_read_b128 v[144:147], v8 offset:47104
  s_waitcnt vmcnt(18) lgkmcnt(6)
  v_mfma_f32_16x16x32_bf16 v[84:87], v[148:151], a[100:103], v[84:87]
  buffer_load_dwordx4 v11, s[8:11], s45 offen lds
  v_mfma_f32_16x16x32_bf16 v[64:67], v[148:151], a[96:99], v[64:67]
  ds_read_b128 v[148:151], v8 offset:49152
  v_mfma_f32_16x16x32_bf16 v[88:91], v[152:155], a[100:103], v[88:91]
  buffer_load_dwordx4 v11, s[8:11], s45 offen offset:1024 lds
  v_mfma_f32_16x16x32_bf16 v[68:71], v[152:155], a[96:99], v[68:71]
  ds_read_b128 v[152:155], v8 offset:51200
  s_waitcnt lgkmcnt(6)
  v_mfma_f32_16x16x32_bf16 v[92:95], v[156:159], a[100:103], v[92:95]
  buffer_load_dwordx4 a[8:11], v16, s[8:11], s46 offen offset:1024 sc1
  v_mfma_f32_16x16x32_bf16 v[72:75], v[156:159], a[96:99], v[72:75]
  ds_read_b128 v[156:159], v8 offset:53248
  v_mfma_f32_16x16x32_bf16 v[96:99], v[128:131], a[100:103], v[96:99]
  buffer_load_dwordx4 a[12:15], v17, s[8:11], s46 offen offset:1024 sc1
  v_mfma_f32_16x16x32_bf16 v[76:79], v[128:131], a[96:99], v[76:79]
  ds_read_b128 v[128:131], v8 offset:55296
  s_waitcnt vmcnt(20) lgkmcnt(6)
  v_mfma_f32_16x16x32_bf16 v[100:103], v[132:135], a[100:103], v[100:103]
  s_barrier
  v_mfma_f32_16x16x32_bf16 v[80:83], v[132:135], a[96:99], v[80:83]
  ds_read_b128 v[132:135], v8 offset:57344
  s_add_u32 m0, s30, 16384
  v_mfma_f32_16x16x32_bf16 v[84:87], v[136:139], a[108:111], v[84:87]
  s_add_u32 s45, s34, 262144
  buffer_load_dwordx4 v11, s[8:11], s45 offen lds
  v_mfma_f32_16x16x32_bf16 v[64:67], v[136:139], a[104:107], v[64:67]
  ds_read_b128 v[136:139], v8 offset:59392
  s_waitcnt lgkmcnt(6)
  v_mfma_f32_16x16x32_bf16 v[88:91], v[140:143], a[108:111], v[88:91]
  buffer_load_dwordx4 v11, s[8:11], s45 offen offset:1024 lds
  v_mfma_f32_16x16x32_bf16 v[68:71], v[140:143], a[104:107], v[68:71]
  ds_read_b128 v[140:143], v8 offset:61440
  v_mfma_f32_16x16x32_bf16 v[92:95], v[144:147], a[108:111], v[92:95]
  buffer_load_dwordx4 a[16:19], v16, s[8:11], s46 offen offset:2048 sc1
  v_mfma_f32_16x16x32_bf16 v[72:75], v[144:147], a[104:107], v[72:75]
  ds_read_b128 v[144:147], v8 offset:63488
  s_waitcnt lgkmcnt(6)
  v_mfma_f32_16x16x32_bf16 v[96:99], v[148:151], a[108:111], v[96:99]
  buffer_load_dwordx4 a[20:23], v17, s[8:11], s46 offen offset:2048 sc1
  v_mfma_f32_16x16x32_bf16 v[76:79], v[148:151], a[104:107], v[76:79]
  ds_read_b128 v[148:151], v9
  v_mfma_f32_16x16x32_bf16 v[100:103], v[152:155], a[108:111], v[100:103]
  v_mfma_f32_16x16x32_bf16 v[80:83], v[152:155], a[104:107], v[80:83]
  ds_read_b128 v[152:155], v9 offset:2048
  s_waitcnt vmcnt(22) lgkmcnt(6)
  v_mfma_f32_16x16x32_bf16 v[84:87], v[156:159], a[116:119], v[84:87]
  s_add_u32 m0, s30, 24576
  s_add_u32 s45, s34, 270336
  v_mfma_f32_16x16x32_bf16 v[64:67], v[156:159], a[112:115], v[64:67]
  ds_read_b128 v[156:159], v9 offset:4096
  s_cmp_ge_u32 s24, 3
  s_cbranch_scc1 nopad_90
  buffer_load_dwordx4 v11, s[8:11], s45 offen lds
nopad_90:
  v_mfma_f32_16x16x32_bf16 v[88:91], v[128:131], a[116:119], v[88:91]
  v_mfma_f32_16x16x32_bf16 v[68:71], v[128:131], a[112:115], v[68:71]
  ds_read_b128 v[128:131], v9 offset:6144
  s_waitcnt lgkmcnt(6)
  v_mfma_f32_16x16x32_bf16 v[92:95], v[132:135], a[116:119], v[92:95]
  s_cmp_ge_u32 s24, 3
  s_cbranch_scc1 nopad_91
  buffer_load_dwordx4 v11, s[8:11], s45 offen offset:1024 lds
nopad_91:
  v_mfma_f32_16x16x32_bf16 v[72:75], v[132:135], a[112:115], v[72:75]
  ds_read_b128 v[132:135], v9 offset:8192
  v_mfma_f32_16x16x32_bf16 v[96:99], v[136:139], a[116:119], v[96:99]
  buffer_load_dwordx4 a[24:27], v16, s[8:11], s46 offen offset:3072 sc1
  v_mfma_f32_16x16x32_bf16 v[76:79], v[136:139], a[112:115], v[76:79]
  ds_read_b128 v[136:139], v9 offset:10240
  s_waitcnt vmcnt(21) lgkmcnt(6)
  v_mfma_f32_16x16x32_bf16 v[100:103], v[140:143], a[116:119], v[100:103]
  buffer_load_dwordx4 a[28:31], v17, s[8:11], s46 offen offset:3072 sc1
  v_mfma_f32_16x16x32_bf16 v[80:83], v[140:143], a[112:115], v[80:83]
  ds_read_b128 v[140:143], v9 offset:12288
  v_mfma_f32_16x16x32_bf16 v[84:87], v[144:147], a[124:127], v[84:87]
  v_mfma_f32_16x16x32_bf16 v[64:67], v[144:147], a[120:123], v[64:67]
  ds_read_b128 v[144:147], v9 offset:14336
  s_waitcnt lgkmcnt(6)
  v_mfma_f32_16x16x32_bf16 v[88:91], v[148:151], a[124:127], v[88:91]
  s_barrier
  v_mfma_f32_16x16x32_bf16 v[68:71], v[148:151], a[120:123], v[68:71]
  ds_read_b128 v[148:151], v9 offset:16384
  s_add_u32 s46, s36, 13787136
  v_mfma_f32_16x16x32_bf16 v[92:95], v[152:155], a[124:127], v[92:95]
  buffer_load_dwordx4 a[32:35], v16, s[8:11], s46 offen sc1
  v_mfma_f32_16x16x32_bf16 v[72:75], v[152:155], a[120:123], v[72:75]
  ds_read_b128 v[152:155], v9 offset:18432
  s_waitcnt lgkmcnt(6)
  v_mfma_f32_16x16x32_bf16 v[96:99], v[156:159], a[124:127], v[96:99]
  v_mfma_f32_16x16x32_bf16 v[76:79], v[156:159], a[120:123], v[76:79]
  ds_read_b128 v[156:159], v9 offset:20480
  v_mfma_f32_16x16x32_bf16 v[100:103], v[128:131], a[124:127], v[100:103]
  v_mfma_f32_16x16x32_bf16 v[80:83], v[128:131], a[120:123], v[80:83]
  ds_read_b128 v[128:131], v9 offset:22528
  s_waitcnt vmcnt(21) lgkmcnt(6)
  v_mfma_f32_16x16x32_bf16 v[84:87], v[132:135], a[132:135], v[84:87]
  v_mfma_f32_16x16x32_bf16 v[64:67], v[132:135], a[128:131], v[64:67]
  ds_read_b128 v[132:135], v9 offset:24576
  v_mfma_f32_16x16x32_bf16 v[88:91], v[136:139], a[132:135], v[88:91]
  v_mfma_f32_16x16x32_bf16 v[68:71], v[136:139], a[128:131], v[68:71]
  ds_read_b128 v[136:139], v9 offset:26624
  s_waitcnt lgkmcnt(6)
  v_mfma_f32_16x16x32_bf16 v[92:95], v[140:143], a[132:135], v[92:95]
  buffer_load_dwordx4 a[36:39], v17, s[8:11], s46 offen sc1
  v_mfma_f32_16x16x32_bf16 v[72:75], v[140:143], a[128:131], v[72:75]
  ds_read_b128 v[140:143], v9 offset:28672
  v_mfma_f32_16x16x32_bf16 v[96:99], v[144:147], a[132:135], v[96:99]
  v_mfma_f32_16x16x32_bf16 v[76:79], v[144:147], a[128:131], v[76:79]
  ds_read_b128 v[144:147], v9 offset:30720
  s_waitcnt vmcnt(20) lgkmcnt(6)
  v_mfma_f32_16x16x32_bf16 v[100:103], v[148:151], a[132:135], v[100:103]
  v_mfma_f32_16x16x32_bf16 v[80:83], v[148:151], a[128:131], v[80:83]
  ds_read_b128 v[148:151], v9 offset:32768
  buffer_load_dwordx4 a[40:43], v16, s[8:11], s46 offen offset:1024 sc1
  v_mfma_f32_16x16x32_bf16 v[84:87], v[152:155], a[140:143], v[84:87]
  v_mfma_f32_16x16x32_bf16 v[64:67], v[152:155], a[136:139], v[64:67]
  ds_read_b128 v[152:155], v9 offset:34816
  s_waitcnt lgkmcnt(6)
  v_mfma_f32_16x16x32_bf16 v[88:91], v[156:159], a[140:143], v[88:91]
  v_mfma_f32_16x16x32_bf16 v[68:71], v[156:159], a[136:139], v[68:71]
  ds_read_b128 v[156:159], v9 offset:36864
  v_mfma_f32_16x16x32_bf16 v[92:95], v[128:131], a[140:143], v[92:95]
here_92:
  v_add_u32 v51, here_92-interleave_layers__linear_attn_block__dense_activation_squared_relu__prompt_kernel+1024, v38
  v_min_u32 v51, 57340, v51
  global_load_dword v49, v51, s[96:97]
  v_mfma_f32_16x16x32_bf16 v[72:75], v[128:131], a[136:139], v[72:75]
  ds_read_b128 v[128:131], v9 offset:38912
  s_waitcnt lgkmcnt(6)
  v_mfma_f32_16x16x32_bf16 v[96:99], v[132:135], a[140:143], v[96:99]
  s_barrier
  v_mfma_f32_16x16x32_bf16 v[76:79], v[132:135], a[136:139], v[76:79]
  ds_read_b128 v[132:135], v9 offset:40960
  v_mfma_f32_16x16x32_bf16 v[100:103], v[136:139], a[140:143], v[100:103]
  v_mfma_f32_16x16x32_bf16 v[80:83], v[136:139], a[136:139], v[80:83]
  ds_read_b128 v[136:139], v9 offset:43008
  s_waitcnt vmcnt(20) lgkmcnt(6)
  v_mfma_f32_16x16x32_bf16 v[84:87], v[140:143], a[148:151], v[84:87]
  buffer_load_dwordx4 a[44:47], v17, s[8:11], s46 offen offset:1024 sc1
  v_mfma_f32_16x16x32_bf16 v[64:67], v[140:143], a[144:147], v[64:67]
  ds_read_b128 v[140:143], v9 offset:45056
  v_mfma_f32_16x16x32_bf16 v[88:91], v[144:147], a[148:151], v[88:91]
  v_mfma_f32_16x16x32_bf16 v[68:71], v[144:147], a[144:147], v[68:71]
  ds_read_b128 v[144:147], v9 offset:47104
  s_waitcnt lgkmcnt(6)
  v_mfma_f32_16x16x32_bf16 v[92:95], v[148:151], a[148:151], v[92:95]
  v_mfma_f32_16x16x32_bf16 v[72:75], v[148:151], a[144:147], v[72:75]
  ds_read_b128 v[148:151], v9 offset:49152
  buffer_load_dwordx4 a[48:51], v16, s[8:11], s46 offen offset:2048 sc1
  v_mfma_f32_16x16x32_bf16 v[96:99], v[152:155], a[148:151], v[96:99]
  v_mfma_f32_16x16x32_bf16 v[76:79], v[152:155], a[144:147], v[76:79]
  ds_read_b128 v[152:155], v9 offset:51200
  s_waitcnt vmcnt(20) lgkmcnt(6)
  v_mfma_f32_16x16x32_bf16 v[100:103], v[156:159], a[148:151], v[100:103]
  v_mfma_f32_16x16x32_bf16 v[80:83], v[156:159], a[144:147], v[80:83]
  ds_read_b128 v[156:159], v9 offset:53248
  buffer_load_dwordx4 a[52:55], v17, s[8:11], s46 offen offset:2048 sc1
  v_mfma_f32_16x16x32_bf16 v[84:87], v[128:131], a[156:159], v[84:87]
  v_mfma_f32_16x16x32_bf16 v[64:67], v[128:131], a[152:155], v[64:67]
  ds_read_b128 v[128:131], v9 offset:55296
  s_waitcnt lgkmcnt(6)
  v_mfma_f32_16x16x32_bf16 v[88:91], v[132:135], a[156:159], v[88:91]
  v_mfma_f32_16x16x32_bf16 v[68:71], v[132:135], a[152:155], v[68:71]
  ds_read_b128 v[132:135], v9 offset:57344
  v_mfma_f32_16x16x32_bf16 v[92:95], v[136:139], a[156:159], v[92:95]
  v_mfma_f32_16x16x32_bf16 v[72:75], v[136:139], a[152:155], v[72:75]
  ds_read_b128 v[136:139], v9 offset:59392
  s_waitcnt lgkmcnt(6)
  v_mfma_f32_16x16x32_bf16 v[96:99], v[140:143], a[156:159], v[96:99]
  v_mfma_f32_16x16x32_bf16 v[76:79], v[140:143], a[152:155], v[76:79]
  ds_read_b128 v[140:143], v9 offset:61440
  v_mfma_f32_16x16x32_bf16 v[100:103], v[144:147], a[156:159], v[100:103]
  v_mfma_f32_16x16x32_bf16 v[80:83], v[144:147], a[152:155], v[80:83]
  ds_read_b128 v[144:147], v9 offset:63488
  s_waitcnt vmcnt(19) lgkmcnt(6)
  v_mfma_f32_16x16x32_bf16 v[84:87], v[148:151], a[4:7], v[84:87]
  s_barrier
  v_mfma_f32_16x16x32_bf16 v[64:67], v[148:151], a[0:3], v[64:67]
  ds_read_b128 v[148:151], v10
  v_mfma_f32_16x16x32_bf16 v[88:91], v[152:155], a[4:7], v[88:91]
  v_mfma_f32_16x16x32_bf16 v[68:71], v[152:155], a[0:3], v[68:71]
  ds_read_b128 v[152:155], v10 offset:2048
  s_waitcnt lgkmcnt(6)
  v_mfma_f32_16x16x32_bf16 v[92:95], v[156:159], a[4:7], v[92:95]
  v_mfma_f32_16x16x32_bf16 v[72:75], v[156:159], a[0:3], v[72:75]
  ds_read_b128 v[156:159], v10 offset:4096
  v_mfma_f32_16x16x32_bf16 v[96:99], v[128:131], a[4:7], v[96:99]
  v_mfma_f32_16x16x32_bf16 v[76:79], v[128:131], a[0:3], v[76:79]
  ds_read_b128 v[128:131], v10 offset:6144
  s_waitcnt vmcnt(13) lgkmcnt(6)
  v_mfma_f32_16x16x32_bf16 v[100:103], v[132:135], a[4:7], v[100:103]
  v_mfma_f32_16x16x32_bf16 v[80:83], v[132:135], a[0:3], v[80:83]
  ds_read_b128 v[132:135], v10 offset:8192
  v_mfma_f32_16x16x32_bf16 v[84:87], v[136:139], a[12:15], v[84:87]
  v_mfma_f32_16x16x32_bf16 v[64:67], v[136:139], a[8:11], v[64:67]
  ds_read_b128 v[136:139], v10 offset:10240
  s_waitcnt lgkmcnt(6)
  v_mfma_f32_16x16x32_bf16 v[88:91], v[140:143], a[12:15], v[88:91]
  v_mfma_f32_16x16x32_bf16 v[68:71], v[140:143], a[8:11], v[68:71]
  ds_read_b128 v[140:143], v10 offset:12288
  v_mfma_f32_16x16x32_bf16 v[92:95], v[144:147], a[12:15], v[92:95]
  v_mfma_f32_16x16x32_bf16 v[72:75], v[144:147], a[8:11], v[72:75]
  ds_read_b128 v[144:147], v10 offset:14336
  s_waitcnt lgkmcnt(6)
  v_mfma_f32_16x16x32_bf16 v[96:99], v[148:151], a[12:15], v[96:99]
  v_mfma_f32_16x16x32_bf16 v[76:79], v[148:151], a[8:11], v[76:79]
  ds_read_b128 v[148:151], v10 offset:16384
  v_mfma_f32_16x16x32_bf16 v[100:103], v[152:155], a[12:15], v[100:103]
  v_mfma_f32_16x16x32_bf16 v[80:83], v[152:155], a[8:11], v[80:83]
  ds_read_b128 v[152:155], v10 offset:18432
  s_waitcnt vmcnt(9) lgkmcnt(6)
  v_mfma_f32_16x16x32_bf16 v[84:87], v[156:159], a[20:23], v[84:87]
  v_mfma_f32_16x16x32_bf16 v[64:67], v[156:159], a[16:19], v[64:67]
  ds_read_b128 v[156:159], v10 offset:20480
  v_mfma_f32_16x16x32_bf16 v[88:91], v[128:131], a[20:23], v[88:91]
  v_mfma_f32_16x16x32_bf16 v[68:71], v[128:131], a[16:19], v[68:71]
  ds_read_b128 v[128:131], v10 offset:22528
  s_waitcnt lgkmcnt(6)
  v_mfma_f32_16x16x32_bf16 v[92:95], v[132:135], a[20:23], v[92:95]
  s_barrier
  v_mfma_f32_16x16x32_bf16 v[72:75], v[132:135], a[16:19], v[72:75]
  ds_read_b128 v[132:135], v10 offset:24576
  v_mfma_f32_16x16x32_bf16 v[96:99], v[136:139], a[20:23], v[96:99]
  v_mfma_f32_16x16x32_bf16 v[76:79], v[136:139], a[16:19], v[76:79]
  ds_read_b128 v[136:139], v10 offset:26624
  s_waitcnt vmcnt(7) lgkmcnt(6)
  v_mfma_f32_16x16x32_bf16 v[100:103], v[140:143], a[20:23], v[100:103]
  v_mfma_f32_16x16x32_bf16 v[80:83], v[140:143], a[16:19], v[80:83]
  ds_read_b128 v[140:143], v10 offset:28672
  v_mfma_f32_16x16x32_bf16 v[84:87], v[144:147], a[28:31], v[84:87]
  v_mfma_f32_16x16x32_bf16 v[64:67], v[144:147], a[24:27], v[64:67]
  ds_read_b128 v[144:147], v10 offset:30720
  s_waitcnt lgkmcnt(6)
  v_mfma_f32_16x16x32_bf16 v[88:91], v[148:151], a[28:31], v[88:91]
  v_mfma_f32_16x16x32_bf16 v[68:71], v[148:151], a[24:27], v[68:71]
  ds_read_b128 v[148:151], v8 offset:8192
  v_mfma_f32_16x16x32_bf16 v[92:95], v[152:155], a[28:31], v[92:95]
  v_mfma_f32_16x16x32_bf16 v[72:75], v[152:155], a[24:27], v[72:75]
  ds_read_b128 v[152:155], v8 offset:10240
  s_waitcnt lgkmcnt(6)
  v_mfma_f32_16x16x32_bf16 v[96:99], v[156:159], a[28:31], v[96:99]
  v_mfma_f32_16x16x32_bf16 v[76:79], v[156:159], a[24:27], v[76:79]
  ds_read_b128 v[156:159], v8 offset:12288
  v_mfma_f32_16x16x32_bf16 v[100:103], v[128:131], a[28:31], v[100:103]
  v_mfma_f32_16x16x32_bf16 v[80:83], v[128:131], a[24:27], v[80:83]
  ds_read_b128 v[128:131], v8 offset:14336
  s_waitcnt vmcnt(5) lgkmcnt(6)
  v_mfma_f32_16x16x32_bf16 v[84:87], v[132:135], a[36:39], v[84:87]
  v_mfma_f32_16x16x32_bf16 v[64:67], v[132:135], a[32:35], v[64:67]
  ds_read_b128 v[132:135], v8 offset:16384
  v_mfma_f32_16x16x32_bf16 v[88:91], v[136:139], a[36:39], v[88:91]
  v_mfma_f32_16x16x32_bf16 v[68:71], v[136:139], a[32:35], v[68:71]
  ds_read_b128 v[136:139], v8 offset:18432
  s_waitcnt lgkmcnt(6)
  v_mfma_f32_16x16x32_bf16 v[92:95], v[140:143], a[36:39], v[92:95]
  v_mfma_f32_16x16x32_bf16 v[72:75], v[140:143], a[32:35], v[72:75]
  ds_read_b128 v[140:143], v8 offset:20480
  v_mfma_f32_16x16x32_bf16 v[96:99], v[144:147], a[36:39], v[96:99]
  v_mfma_f32_16x16x32_bf16 v[76:79], v[144:147], a[32:35], v[76:79]
  ds_read_b128 v[144:147], v8 offset:22528
  s_waitcnt vmcnt(2) lgkmcnt(6)
  v_mfma_f32_16x16x32_bf16 v[100:103], v[148:151], a[36:39], v[100:103]
  s_barrier
  v_mfma_f32_16x16x32_bf16 v[80:83], v[148:151], a[32:35], v[80:83]
  ds_read_b128 v[148:151], v8 offset:24576
  v_mfma_f32_16x16x32_bf16 v[84:87], v[152:155], a[44:47], v[84:87]
  v_mfma_f32_16x16x32_bf16 v[64:67], v[152:155], a[40:43], v[64:67]
  ds_read_b128 v[152:155], v8 offset:26624
  s_waitcnt lgkmcnt(6)
  v_mfma_f32_16x16x32_bf16 v[88:91], v[156:159], a[44:47], v[88:91]
  v_mfma_f32_16x16x32_bf16 v[68:71], v[156:159], a[40:43], v[68:71]
  ds_read_b128 v[156:159], v8 offset:28672
  v_mfma_f32_16x16x32_bf16 v[92:95], v[128:131], a[44:47], v[92:95]
  v_mfma_f32_16x16x32_bf16 v[72:75], v[128:131], a[40:43], v[72:75]
  s_waitcnt lgkmcnt(5)
  v_mfma_f32_16x16x32_bf16 v[96:99], v[132:135], a[44:47], v[96:99]
  v_mfma_f32_16x16x32_bf16 v[76:79], v[132:135], a[40:43], v[76:79]
  v_mfma_f32_16x16x32_bf16 v[100:103], v[136:139], a[44:47], v[100:103]
  v_mfma_f32_16x16x32_bf16 v[80:83], v[136:139], a[40:43], v[80:83]
  s_waitcnt vmcnt(0) lgkmcnt(3)
  v_mfma_f32_16x16x32_bf16 v[84:87], v[140:143], a[52:55], v[84:87]
  v_mfma_f32_16x16x32_bf16 v[64:67], v[140:143], a[48:51], v[64:67]
  v_mfma_f32_16x16x32_bf16 v[88:91], v[144:147], a[52:55], v[88:91]
  v_mfma_f32_16x16x32_bf16 v[68:71], v[144:147], a[48:51], v[68:71]
  s_waitcnt lgkmcnt(1)
  v_mfma_f32_16x16x32_bf16 v[92:95], v[148:151], a[52:55], v[92:95]
  s_barrier
  v_mfma_f32_16x16x32_bf16 v[72:75], v[148:151], a[48:51], v[72:75]
  v_mfma_f32_16x16x32_bf16 v[96:99], v[152:155], a[52:55], v[96:99]
  v_mfma_f32_16x16x32_bf16 v[76:79], v[152:155], a[48:51], v[76:79]
  s_waitcnt lgkmcnt(0)
  v_mfma_f32_16x16x32_bf16 v[100:103], v[156:159], a[52:55], v[100:103]
  v_mfma_f32_16x16x32_bf16 v[80:83], v[156:159], a[48:51], v[80:83]
  ds_write_b128 v200, v[84:87]
  ds_write_b128 v200, v[88:91] offset:1024
  ds_write_b128 v200, v[92:95] offset:2048
  s_nop 0
  ds_write_b128 v200, v[96:99] offset:3072
  s_nop 1
  ds_write_b128 v200, v[100:103] offset:4096
  s_waitcnt lgkmcnt(0)
  s_barrier
  ds_read_b128 v[204:207], v201
  ds_read_b128 v[208:211], v201 offset:1024
  ds_read_b128 v[212:215], v201 offset:2048
  ds_read_b128 v[216:219], v201 offset:3072
  ds_read_b128 v[220:223], v201 offset:4096
  s_waitcnt lgkmcnt(4)
  v_pk_add_f32 v[64:65], v[64:65], v[204:205]
  v_pk_fma_f32 v[64:65], v[64:65], v[202:203], v[160:161] op_sel_hi:[1,0,1]
  v_pk_add_f32 v[66:67], v[66:67], v[206:207]
  v_pk_fma_f32 v[66:67], v[66:67], v[202:203], v[162:163] op_sel_hi:[1,0,1]
  s_waitcnt lgkmcnt(3)
  v_pk_add_f32 v[68:69], v[68:69], v[208:209]
  v_pk_fma_f32 v[68:69], v[68:69], v[202:203], v[164:165] op_sel_hi:[1,0,1]
  v_pk_add_f32 v[70:71], v[70:71], v[210:211]
  v_pk_fma_f32 v[70:71], v[70:71], v[202:203], v[166:167] op_sel_hi:[1,0,1]
  s_waitcnt lgkmcnt(2)
  v_pk_add_f32 v[72:73], v[72:73], v[212:213]
  v_pk_fma_f32 v[72:73], v[72:73], v[202:203], v[168:169] op_sel_hi:[1,0,1]
  v_pk_add_f32 v[74:75], v[74:75], v[214:215]
  v_pk_fma_f32 v[74:75], v[74:75], v[202:203], v[170:171] op_sel_hi:[1,0,1]
  s_waitcnt lgkmcnt(1)
  v_pk_add_f32 v[76:77], v[76:77], v[216:217]
  v_pk_fma_f32 v[76:77], v[76:77], v[202:203], v[172:173] op_sel_hi:[1,0,1]
  v_pk_add_f32 v[78:79], v[78:79], v[218:219]
  v_pk_fma_f32 v[78:79], v[78:79], v[202:203], v[174:175] op_sel_hi:[1,0,1]
  s_waitcnt lgkmcnt(0)
  v_pk_add_f32 v[80:81], v[80:81], v[220:221]
  v_pk_fma_f32 v[80:81], v[80:81], v[202:203], v[176:177] op_sel_hi:[1,0,1]
  v_pk_add_f32 v[82:83], v[82:83], v[222:223]
  v_pk_fma_f32 v[82:83], v[82:83], v[202:203], v[178:179] op_sel_hi:[1,0,1]
  v_cvt_pk_bf16_f32 v224, v64, v68
  v_cvt_pk_bf16_f32 v225, v65, v69
  v_cvt_pk_bf16_f32 v226, v66, v70
  v_cvt_pk_bf16_f32 v227, v67, v71
  v_cvt_pk_bf16_f32 v228, v72, v76
  v_cvt_pk_bf16_f32 v229, v73, v77
  v_cvt_pk_bf16_f32 v230, v74, v78
  v_cvt_pk_bf16_f32 v231, v75, v79
  v_cvt_pk_bf16_f32 v232, v80, v81
  v_cvt_pk_bf16_f32 v233, v82, v83
  buffer_store_dwordx4 v[224:227], v28, s[12:15], 0 offen
  buffer_store_dwordx4 v[228:231], v28, s[12:15], 0 offen offset:64
  buffer_store_dwordx2 v[232:233], v29, s[12:15], 0 offen offset:128
  s_add_u32 s41, s2, s24
  s_cmp_lg_u32 s41, 0
  s_cbranch_scc1 main_end
  s_add_u32 s41, s92, 16
  v_mov_b32 v200, s41
  v_mov_b32 v201, 16384
  s_mov_b64 exec, 1
  buffer_store_dword v200, v201, s[8:11], 0 offen sc1
main_end:
  s_endpgm

main_code_end:
.section .rodata,"a"
.p2align 6
.amdhsa_kernel interleave_layers__linear_attn_block__dense_activation_squared_relu__prompt_kernel
  .amdhsa_next_free_vgpr 512
  .amdhsa_next_free_sgpr 102
  .amdhsa_accum_offset 256
  .amdhsa_group_segment_fixed_size 0
  .amdhsa_kernarg_size 88
  .amdhsa_user_sgpr_count 2
  .amdhsa_user_sgpr_kernarg_segment_ptr 1
  .amdhsa_system_sgpr_workgroup_id_x 1
  .amdhsa_float_denorm_mode_32 3
.end_amdhsa_kernel
```
